```python
import torch

def _softmax(x, axis=-1):
    return torch.softmax(x, dim=axis)
def _gelu(x):
    return torch.nn.functional.gelu(x, approximate="tanh")
def _silu(x):
    return torch.nn.functional.silu(x)
def _sigmoid(x):
    return torch.sigmoid(x)
def _layernorm(x, axis=-1, eps=1e-5):
    m = x.mean(dim=axis, keepdim=True)
    v = x.var(dim=axis, keepdim=True, unbiased=False)
    return (x - m) / torch.sqrt(v + eps)
def _scatter_add(tgt, idx, src, axis=0):
    return tgt.clone().index_add_(axis, idx, src)
def _segment_sum(src, seg, n):
    out = torch.zeros((n,) + src.shape[1:], dtype=src.dtype)
    return out.index_add_(0, seg, src)
def _pad(x, pw):
    flat = tuple(v for pair in reversed(pw) for v in pair)
    return torch.nn.functional.pad(x, flat)

kernel_name = 'parallel_sum__ssm_conv_h3__dense_activation_gelu__prompt'

def setup_inputs():

    _w = (lambda a: (lambda t: t.to(torch.bfloat16) if t.is_floating_point() else t)(torch.as_tensor(a)))
    def _A_setup():
        B, S, D = 1, 2048, 576
        ks = 4
        return {
            "q": _w((lambda *s: torch.randn(*s, dtype=torch.bfloat16) * 0.05)(B, S, D)),
            "k": _w((lambda *s: torch.randn(*s, dtype=torch.bfloat16) * 0.2)(B, S, D)),
            "v": _w((lambda *s: torch.randn(*s, dtype=torch.bfloat16) * 0.2)(B, S, D)),
            "shift_k": _w((lambda *s: torch.randn(*s, dtype=torch.bfloat16) * 0.2)(D, ks) * 0.5),
            "ssm_k": _w((lambda *s: torch.randn(*s, dtype=torch.bfloat16) * 0.8)(D, S) * (1.0 / S ** 0.5)),
            "ssm_D": _w((lambda *s: torch.randn(*s, dtype=torch.bfloat16) * 0.2)(D)),
        }
    _A_in = _A_setup()

    def _B_setup():
        B, S, D, F = 1, 2048, 576, 4608
        return {
            "x": _w((lambda *s: torch.randn(*s, dtype=torch.bfloat16) * 0.05)(B, S, D)),
            "w1": _w((lambda *s: torch.randn(*s, dtype=torch.bfloat16) * 0.4)(D, F) * (D ** -0.5)),
            "b1": _w((lambda *s: torch.randn(*s, dtype=torch.bfloat16) * 12.8)(F) * 0.01),
            "w2": _w((lambda *s: torch.randn(*s, dtype=torch.bfloat16) * 0.2)(F, D) * (F ** -0.5)),
            "b2": _w((lambda *s: torch.randn(*s, dtype=torch.bfloat16) * 1.6)(D) * 0.01),
        }
    _B_in = _B_setup()

    return {
        "A_q": _A_in["q"],
        "A_k": _A_in["k"],
        "A_v": _A_in["v"],
        "A_shift_k": _A_in["shift_k"],
        "A_ssm_k": _A_in["ssm_k"],
        "A_ssm_D": _A_in["ssm_D"],
        "B_x": _B_in["x"],
        "B_w1": _B_in["w1"],
        "B_b1": _B_in["b1"],
        "B_w2": _B_in["w2"],
        "B_b2": _B_in["b2"],
    }

def reference(A_q, A_k, A_v, A_shift_k, A_ssm_k, A_ssm_D, B_x, B_w1, B_b1, B_w2, B_b2):
    def _A_ref(q, k, v, shift_k, ssm_k, ssm_D):
        B, S, D = q.shape
        ks = shift_k.shape[-1]
        k_pad = _pad(k, ((0, 0), (ks - 1, 0), (0, 0)))
        k_shift = torch.zeros_like(k)
        for t in range(ks):
            k_shift = k_shift + k_pad[:, t:t + S, :] * shift_k[:, ks - 1 - t][None, None, :]
        kv = k_shift * v
        L = 2 * S
        kv_pad = _pad(kv, ((0, 0), (0, S), (0, 0)))
        kf_pad = _pad(ssm_k, ((0, 0), (0, S)))
        kv_f = (lambda x, axes=(-2,-1): torch.fft.rfft2(x.float(), dim=axes))(kv_pad[:, None, :, :], axes=(1, 2))
        kf_f = (lambda x, axes=(-2,-1): torch.fft.rfft2(x.float(), dim=axes))(kf_pad[:, None, :], axes=(1, 2))
        kf_f = (lambda x, *d: x.permute(*d))(kf_f, 1, 2, 0)
        y_f = kv_f * kf_f[None, :, :, :]
        y = (lambda x, s, axes=(-2,-1): torch.fft.irfft2(x, s=s, dim=axes).to(torch.bfloat16))(y_f, (1, L), axes=(1, 2))[:, 0, :S, :]
        y = y + kv * ssm_D[None, None, :]
        return q * y

    def _B_ref(x, w1, b1, w2, b2):
        h = torch.einsum("bsd,df->bsf", x, w1) + b1
        h = _gelu(h)
        return torch.einsum("bsf,fd->bsd", h, w2) + b2

    x = A_q
    xn = _layernorm(x, axis=-1)
    return x + _A_ref(xn, A_k, A_v, A_shift_k, A_ssm_k, A_ssm_D) + _B_ref(xn, B_w1, B_b1, B_w2, B_b2)
```

```asm
; @launch grid=(256,1,1) block=(512,1,1) lds=163840
.amdgcn_target "amdgcn-amd-amdhsa--gfx950"
.text
.globl parallel_sum__ssm_conv_h3__dense_activation_gelu__prompt_kernel
.p2align 8
.type parallel_sum__ssm_conv_h3__dense_activation_gelu__prompt_kernel,@function
parallel_sum__ssm_conv_h3__dense_activation_gelu__prompt_kernel:
  s_cmp_ge_u32 s2, 256
  s_cbranch_scc1 parallel_sum__ssm_conv_h3__dense_activation_gelu__prompt_kernel_exit
  s_load_dwordx2 s[4:5], s[0:1], 0
  s_lshr_b32 s29, s2, 4
  s_and_b32 s39, s2, 4
  s_lshl2_add_u32 s29, s39, s29
  v_lshrrev_b32 v112, 3, v0
  s_and_b32 s39, s2, 8
  s_lshl_b32 s39, s39, 2
  v_xor_b32 v112, s39, v112
  v_and_b32 v113, 7, v0
  s_mul_i32 s40, s29, 73728
  v_lshl_add_u32 v118, v113, 4, s40
  v_mul_u32_u24 v114, 1152, v112
  v_add_u32 v118, v118, v114
  v_cmp_gt_u32 vcc, 256, v0
  s_mov_b32 s6, 2359296
  s_mov_b32 s7, 0x00020000
  s_waitcnt lgkmcnt(0)
  buffer_load_dwordx4 v[76:79], v118, s[4:7], 0 offen offset:0
  s_cbranch_vccz parallel_sum__ssm_conv_h3__dense_activation_gelu__prompt_kernel_y0
  buffer_load_dwordx4 v[80:83], v118, s[4:7], 0 offen offset:128
  buffer_load_dwordx4 v[84:87], v118, s[4:7], 0 offen offset:256
  buffer_load_dwordx4 v[88:91], v118, s[4:7], 0 offen offset:384
  buffer_load_dwordx4 v[92:95], v118, s[4:7], 0 offen offset:512
  buffer_load_dwordx4 v[96:99], v118, s[4:7], 0 offen offset:640
  buffer_load_dwordx4 v[100:103], v118, s[4:7], 0 offen offset:768
  buffer_load_dwordx4 v[104:107], v118, s[4:7], 0 offen offset:896
  buffer_load_dwordx4 v[108:111], v118, s[4:7], 0 offen offset:1024
  s_getpc_b64 s[56:57]
parallel_sum__ssm_conv_h3__dense_activation_gelu__prompt_kernel_pc:
  s_lshr_b32 s39, s2, 3
  v_lshl_add_u32 v14, v0, 5, s39
  v_lshlrev_b32 v14, 7, v14
  v_min_u32 v14, parallel_sum__ssm_conv_h3__dense_activation_gelu__prompt_kernel_exit-parallel_sum__ssm_conv_h3__dense_activation_gelu__prompt_kernel_pc, v14
  global_load_dword v70, v14, s[56:57]
parallel_sum__ssm_conv_h3__dense_activation_gelu__prompt_kernel_y0:
  s_load_dwordx2 s[8:9], s[0:1], 56
  s_load_dwordx2 s[16:17], s[0:1], 64
  s_load_dwordx2 s[12:13], s[0:1], 72
  s_load_dwordx2 s[24:25], s[0:1], 104
  s_load_dwordx2 s[64:65], s[0:1], 8
  s_load_dwordx2 s[68:69], s[0:1], 16
  s_load_dwordx2 s[72:73], s[0:1], 24
  s_load_dwordx2 s[84:85], s[0:1], 32
  s_load_dwordx2 s[92:93], s[0:1], 40
  s_load_dwordx2 s[94:95], s[0:1], 80
  s_load_dwordx2 s[80:81], s[0:1], 88
  s_load_dwordx2 s[88:89], s[0:1], 96
  v_lshrrev_b32 v14, 6, v0
  v_and_b32 v1, 63, v0
  v_readfirstlane_b32 s31, v14
  s_and_b32 s28, s2, 3
  s_bfe_u32 s39, s2, 65539
  s_lshl1_add_u32 s28, s28, s39
  s_mov_b32 s10, 5308416
  s_mov_b32 s11, 0x00020000
  s_mov_b32 s14, 5308416
  s_mov_b32 s15, 0x00020000
  s_mov_b32 s18, 9216
  s_mov_b32 s19, 0x00020000
  s_mov_b32 s26, 268435456
  s_cbranch_vccnz parallel_sum__ssm_conv_h3__dense_activation_gelu__prompt_kernel_h1
  buffer_load_dwordx4 v[80:83], v118, s[4:7], 0 offen offset:128
parallel_sum__ssm_conv_h3__dense_activation_gelu__prompt_kernel_h1:
  s_mov_b32 s27, 0x00020000
  s_mov_b32 s66, 2359296
  s_mov_b32 s67, 0x00020000
  s_mov_b32 s70, 2359296
  s_mov_b32 s71, 0x00020000
  s_mov_b32 s74, 4608
  s_mov_b32 s75, 0x00020000
  s_mov_b32 s86, 2359296
  s_mov_b32 s87, 0x00020000
  s_mov_b32 s82, 2359296
  s_mov_b32 s83, 0x00020000
  s_mov_b32 s90, 256
  s_mov_b32 s91, 0x00020000
  s_and_b32 s32, s31, 3
  s_lshr_b32 s55, s31, 2
  s_lshl_b32 s33, s31, 10
  s_cbranch_vccnz parallel_sum__ssm_conv_h3__dense_activation_gelu__prompt_kernel_h2
  buffer_load_dwordx4 v[84:87], v118, s[4:7], 0 offen offset:256
parallel_sum__ssm_conv_h3__dense_activation_gelu__prompt_kernel_h2:
  s_lshl2_add_u32 s30, s39, s29
  s_mul_i32 s39, s30, 57
  s_lshr_b32 s39, s39, 9
  s_mul_i32 s39, s39, 9
  s_sub_u32 s30, s30, s39
  s_lshl_b32 s44, s30, 7
  s_add_u32 s45, s44, 128
  s_cmp_eq_u32 s45, 1152
  s_cselect_b32 s45, 0, s45
  s_add_u32 s46, s45, 128
  s_cmp_eq_u32 s46, 1152
  s_cselect_b32 s46, 0, s46
  s_add_u32 s47, s46, 128
  s_cmp_eq_u32 s47, 1152
  s_cselect_b32 s47, 0, s47
  s_add_u32 s48, s47, 128
  s_cmp_eq_u32 s48, 1152
  s_cselect_b32 s48, 0, s48
  s_add_u32 s49, s48, 128
  s_cmp_eq_u32 s49, 1152
  s_cselect_b32 s49, 0, s49
  s_add_u32 s50, s49, 128
  s_cbranch_vccnz parallel_sum__ssm_conv_h3__dense_activation_gelu__prompt_kernel_h3
  buffer_load_dwordx4 v[88:91], v118, s[4:7], 0 offen offset:384
parallel_sum__ssm_conv_h3__dense_activation_gelu__prompt_kernel_h3:
  s_cmp_eq_u32 s50, 1152
  s_cselect_b32 s50, 0, s50
  s_add_u32 s51, s50, 128
  s_cmp_eq_u32 s51, 1152
  s_cselect_b32 s51, 0, s51
  s_add_u32 s52, s51, 128
  s_cmp_eq_u32 s52, 1152
  s_cselect_b32 s52, 0, s52
  v_lshrrev_b32 v115, 3, v0
  v_and_b32 v116, 6, v115
  v_xor_b32 v116, v116, v113
  v_lshlrev_b32 v116, 4, v116
  s_mul_i32 s38, s28, 1152
  v_mul_u32_u24 v8, 9216, v115
  v_add3_u32 v8, v8, v116, s38
  s_mul_i32 s39, s28, 663552
  v_mul_u32_u24 v9, 1152, v115
  v_add3_u32 v9, v9, v116, s39
  s_lshl_b32 s39, s32, 1
  s_sub_u32 s39, s39, s31
  s_cbranch_vccnz parallel_sum__ssm_conv_h3__dense_activation_gelu__prompt_kernel_h4
  buffer_load_dwordx4 v[92:95], v118, s[4:7], 0 offen offset:512
parallel_sum__ssm_conv_h3__dense_activation_gelu__prompt_kernel_h4:
  s_mul_i32 s40, s39, 73728
  v_add_u32 v54, s40, v8
  v_add_u32 v52, 72704, v54
  s_lshl_b32 s56, s32, 11
  v_and_b32 v10, 255, v0
  v_lshl_add_u32 v10, v10, 3, s44
  v_subrev_u32 v14, 1152, v10
  v_min_u32 v10, v10, v14
  v_add_u32 v10, s38, v10
  v_lshrrev_b32 v120, 4, v1
  v_lshrrev_b32 v121, 2, v1
  v_lshlrev_b32 v2, 7, v121
  v_bfe_u32 v121, v1, 3, 2
  v_xor_b32 v121, s32, v121
  v_lshl_add_u32 v2, v121, 5, v2
  v_and_b32 v121, 3, v1
  v_lshl_add_u32 v2, v121, 3, v2
  s_cbranch_vccnz parallel_sum__ssm_conv_h3__dense_activation_gelu__prompt_kernel_h5
  buffer_load_dwordx4 v[96:99], v118, s[4:7], 0 offen offset:640
parallel_sum__ssm_conv_h3__dense_activation_gelu__prompt_kernel_h5:
  v_add_u32 v3, 65536, v2
  v_add_u32 v4, 131072, v2
  s_lshl_b32 s39, s55, 11
  s_add_u32 s39, s39, 90112
  v_lshrrev_b32 v119, 5, v1
  v_mul_u32_u24 v119, 26, v119
  v_and_b32 v5, 15, v1
  v_xor_b32 v5, v5, v119
  v_and_b32 v119, 16, v1
  v_lshl_add_u32 v5, v119, 1, v5
  v_lshl_add_u32 v5, v5, 4, s39
  v_add_u32 v56, 65536, v5
  v_xor_b32 v57, 64, v5
  v_xor_b32 v58, 64, v56
  v_and_b32 v121, 1, v1
  v_mul_u32_u24 v121, 26, v121
  v_and_b32 v114, 15, v112
  s_cbranch_vccnz parallel_sum__ssm_conv_h3__dense_activation_gelu__prompt_kernel_h6
  buffer_load_dwordx4 v[100:103], v118, s[4:7], 0 offen offset:768
parallel_sum__ssm_conv_h3__dense_activation_gelu__prompt_kernel_h6:
  v_xor_b32 v114, v114, v121
  v_and_b32 v121, 48, v112
  v_lshl_add_u32 v114, v121, 2, v114
  v_and_b32 v121, 4, v1
  v_xor_b32 v114, v114, v121
  v_lshl_add_u32 v114, v121, 6, v114
  v_lshlrev_b32 v114, 4, v114
  v_and_b32 v121, 2, v1
  v_lshl_add_u32 v114, v121, 2, v114
  v_add_u32 v114, 90112, v114
  v_mov_b32 v7, 0xc0135761
  s_mov_b32 s34, 0xbdd2d3e8
  v_or_b32 v62, s28, v113
  v_lshlrev_b32 v62, 28, v62
  v_lshl_add_u32 v62, v112, 3, v62
  v_mov_b32 v122, 0
  v_mov_b32 v123, 0
  s_cbranch_vccnz parallel_sum__ssm_conv_h3__dense_activation_gelu__prompt_kernel_h7
  buffer_load_dwordx4 v[104:107], v118, s[4:7], 0 offen offset:896
parallel_sum__ssm_conv_h3__dense_activation_gelu__prompt_kernel_h7:
  v_mov_b32 v60, 0
  v_mov_b32 v61, 0
  v_mov_b32 v126, 0x3f803f80
  s_lshr_b32 s39, s2, 3
  s_mul_i32 s78, s39, 57
  s_lshr_b32 s78, s78, 9
  s_and_b32 s77, s2, 7
  s_sub_u32 s77, s77, s78
  s_mul_i32 s77, s77, 9
  s_add_u32 s77, s77, s39
  s_lshl1_add_u32 s39, s2, -432
  s_min_u32 s39, s39, 70
  s_cmp_eq_u32 s78, 3
  s_cselect_b32 s77, s39, s77
  s_cselect_b32 s79, 16, 0
  s_cmp_ge_u32 s2, 252
  s_cselect_b32 s78, 4, s78
  s_lshl_b32 s39, s77, 4
  s_add_u32 s79, s79, s39
  s_waitcnt lgkmcnt(0)
  s_load_dwordx4 s[96:99], s[94:95], s39
  s_lshl3_add_u32 s39, s55, s39
  s_load_dwordx2 s[20:21], s[92:93], s39
  s_lshl3_add_u32 s39, s55, s79
  s_load_dwordx2 s[22:23], s[92:93], s39
  s_cbranch_vccnz parallel_sum__ssm_conv_h3__dense_activation_gelu__prompt_kernel_h8
  buffer_load_dwordx4 v[108:111], v118, s[4:7], 0 offen offset:1024
parallel_sum__ssm_conv_h3__dense_activation_gelu__prompt_kernel_h8:
  s_or_b32 s39, s2, s31
  s_cbranch_scc0 parallel_sum__ssm_conv_h3__dense_activation_gelu__prompt_kernel_mk
parallel_sum__ssm_conv_h3__dense_activation_gelu__prompt_kernel_mkb:
  s_cbranch_vccnz parallel_sum__ssm_conv_h3__dense_activation_gelu__prompt_kernel_h9
  buffer_load_dwordx2 v[144:145], v10, s[16:19], 0 offen
  s_add_u32 m0, s56, 0
  s_add_u32 s3, s44, 0
  buffer_load_dwordx4 v54, s[8:11], s3 offen lds
parallel_sum__ssm_conv_h3__dense_activation_gelu__prompt_kernel_h9:
  s_load_dwordx4 s[4:7], s[94:95], s79
  s_mul_i32 s16, s44, 576
  s_mul_i32 s17, s45, 576
  s_mul_i32 s18, s46, 576
  s_mul_i32 s19, s47, 576
  s_mul_i32 s36, s48, 576
  s_mul_i32 s37, s49, 576
  s_mul_i32 s41, s50, 576
  s_mul_i32 s42, s51, 576
  s_mul_i32 s43, s52, 576
  v_and_b32 v11, 31, v1
  v_lshlrev_b32 v11, 4, v11
  v_lshrrev_b32 v14, 5, v1
  v_lshl_add_u32 v11, v14, 15, v11
  s_and_b32 s53, s2, 3
  s_mul_i32 s53, s53, 36
  s_add_u32 s53, s53, s32
  s_lshl_b32 s53, s53, 6
  s_add_u32 s53, s53, s29
  s_lshl1_add_u32 s53, s53, s55
  s_lshl_b32 s53, s53, 9
  s_lshl_b32 s38, s31, 11
  v_lshl_add_u32 v6, v1, 4, s38
  v_min_u32 v12, 1, v0
  v_lshlrev_b32 v12, 31, v12
  s_mul_i32 s62, s29, 36
  s_add_u32 s62, s62, s32
  s_lshl1_add_u32 s62, s62, s55
  s_lshl3_add_u32 s62, s62, s28
  s_lshl2_add_u32 s62, s62, 26214400
  s_lshr_b32 s40, s2, 3
  s_and_b32 s63, s2, 7
  s_mul_i32 s79, s40, 576
  s_add_u32 s79, s79, s63
  s_lshl_b32 s79, s79, 7
  s_lshl_b32 s38, s63, 11
  s_add_u32 s38, s38, s40
  s_lshl_b32 s38, s38, 7
  s_and_b32 s40, s2, 31
  s_mul_i32 s39, s40, 73728
  s_lshl_b32 s40, s40, 7
  s_brev_b32 s63, 1
  s_lshr_b32 s30, s2, 5
  s_cmp_eq_u32 s30, 7
  s_cselect_b32 s35, 1024, s63
  s_cselect_b32 s63, 2097152, s63
  s_add_u32 s39, s39, s35
  s_add_u32 s40, s40, s63
  s_sub_u32 s35, s39, s79
  s_sub_u32 s40, s40, s38
  s_lshl_b32 s30, s31, 10
  s_mul_i32 s39, s30, 9
  s_add_u32 s39, s39, s79
  s_add_u32 s30, s30, 73728
  s_mov_b32 s76, 20971520
  v_lshrrev_b32 v14, 3, v1
  v_and_b32 v15, 7, v1
  v_mul_u32_u24 v68, 1152, v14
  v_xor_b32 v74, s31, v15
  v_lshl_add_u32 v68, v74, 4, v68
  v_add_u32 v68, s39, v68
  v_and_b32 v14, 3, v14
  v_lshl_add_u32 v74, v74, 2, v14
  v_lshl_add_u32 v74, v15, 8, v74
  v_bfe_i32 v71, v1, 5, 1
  v_and_b32 v69, 2048, v71
  v_add_u32 v69, 18176, v69
  v_add_lshl_u32 v74, v74, v69, 2
  v_add_u32 v69, -1, v15
  v_xor_b32 v69, v69, v15
  v_and_b32 v69, 7, v69
  v_lshlrev_b32 v69, 4, v69
  v_xor_b32 v69, v69, v74
  v_lshl_add_u32 v14, s31, 2, v14
  v_and_b32 v75, s40, v71
  v_lshl_add_u32 v75, v14, 13, v75
  v_lshl_add_u32 v15, v15, 4, s38
  v_add_u32 v75, v75, v15
  v_and_b32 v53, s35, v71
  s_sub_u32 s38, s79, 3456
  v_lshl_add_u32 v15, v14, 2, s38
  v_add_u32 v53, v53, v15
  v_lshl_add_u32 v14, v14, 1, -1
  v_bfe_i32 v15, v1, 2, 1
  v_and_b32 v14, v14, v15
  v_and_b32 v15, 7, v1
  v_add_u32 v14, v14, v15
  v_mul_u32_u24 v14, 1152, v14
  v_add_u32 v53, v53, v14
  s_lshl3_add_u32 s38, s78, s31
  s_mul_i32 s38, s38, 11
  v_add_u32 v71, s38, v1
  v_min_u32 v71, 255, v71
  s_lshl_b32 s38, s77, 8
  v_add_lshl_u32 v71, v71, s38, 7
  s_mov_b32 s79, 0
  s_cmp_eq_u32 s78, 0
  s_cselect_b32 s79, 135791624, s79
  s_cmp_eq_u32 s78, 1
  s_cselect_b32 s79, 135529484, s79
  s_cmp_eq_u32 s78, 2
  s_cselect_b32 s79, 135268368, s79
  s_cmp_eq_u32 s78, 3
  s_cselect_b32 s79, 284690432, s79
  s_bfe_u32 s38, s79, 524296
  s_bfe_i32 s40, s79, 524304
  s_and_b32 s63, s79, 255
  s_add_u32 s95, s31, 8
  s_cmp_lt_u32 s31, s38
  s_cselect_b32 s92, s63, s40
  s_cmp_lt_u32 s95, s38
  s_cselect_b32 s93, s63, s40
  s_add_u32 s92, s92, s31
  s_add_u32 s93, s93, s95
  s_lshr_b32 s79, s79, 24
  s_cmp_lt_u32 s95, s79
  s_cselect_b32 s57, 0xffff0000, 0
  s_cselect_b32 s93, s93, s92
  s_lshr_b32 s38, s77, 3
  s_add_u32 s38, s38, 36
  s_sub_u32 s40, s38, s93
  s_sub_u32 s38, s38, s92
  s_mul_i32 s63, s38, 57
  s_lshr_b32 s63, s63, 9
  s_mul_i32 s63, s63, 9
  s_sub_u32 s38, s38, s63
  s_cmp_lt_u32 s38, 4
  s_cselect_b32 s63, 11, 0
  s_lshl1_add_u32 s38, s38, s63
  s_mul_i32 s63, s40, 57
  s_lshr_b32 s63, s63, 9
  s_mul_i32 s63, s63, 9
  s_sub_u32 s40, s40, s63
  s_cmp_lt_u32 s40, 4
  s_cselect_b32 s63, 11, 0
  s_lshl1_add_u32 s40, s40, s63
  s_min_u32 s0, s38, s40
  s_max_u32 s1, s38, s40
  s_cmp_gt_u32 s38, s40
  s_cselect_b32 s63, s93, s92
  s_cselect_b32 s93, s92, s93
  s_mov_b32 s92, s63
  s_cselect_b32 s94, s95, s31
  s_cselect_b32 s95, s31, s95
  v_mul_u32_u24 v14, 1152, v1
  s_mul_i32 s38, s92, 73728
  s_lshl4_add_u32 s38, s77, s38
  s_cmp_eq_u32 s78, 4
  s_cselect_b32 s40, 0x80000000, 0
  s_or_b32 s38, s38, s40
  v_add_u32 v72, s38, v14
  s_mul_i32 s38, s93, 73728
  s_lshl4_add_u32 s38, s77, s38
  s_andn2_b32 s40, 0x80000000, s57
  s_or_b32 s38, s38, s40
  s_add_u32 s38, s38, 16
  v_add_u32 v73, s38, v14
  s_cbranch_vccnz parallel_sum__ssm_conv_h3__dense_activation_gelu__prompt_kernel_h10
  buffer_load_dwordx4 v52, s[8:11], s3 offen offset:1024 lds
parallel_sum__ssm_conv_h3__dense_activation_gelu__prompt_kernel_h10:
  s_cbranch_vccz parallel_sum__ssm_conv_h3__dense_activation_gelu__prompt_kernel_sy
  s_waitcnt vmcnt(9)
  v_dot2c_f32_bf16 v122, v76, v126
  v_dot2c_f32_bf16 v60, v76, v76
  v_dot2c_f32_bf16 v123, v77, v126
  v_dot2c_f32_bf16 v61, v77, v77
  v_dot2c_f32_bf16 v122, v78, v126
  v_dot2c_f32_bf16 v60, v78, v78
  v_dot2c_f32_bf16 v123, v79, v126
  v_dot2c_f32_bf16 v61, v79, v79
  s_waitcnt vmcnt(8)
  v_dot2c_f32_bf16 v122, v80, v126
  v_dot2c_f32_bf16 v60, v80, v80
  v_dot2c_f32_bf16 v123, v81, v126
  v_dot2c_f32_bf16 v61, v81, v81
  v_dot2c_f32_bf16 v122, v82, v126
  v_dot2c_f32_bf16 v60, v82, v82
  v_dot2c_f32_bf16 v123, v83, v126
  v_dot2c_f32_bf16 v61, v83, v83
  s_waitcnt vmcnt(7)
  v_dot2c_f32_bf16 v122, v84, v126
  v_dot2c_f32_bf16 v60, v84, v84
  v_dot2c_f32_bf16 v123, v85, v126
  v_dot2c_f32_bf16 v61, v85, v85
  v_dot2c_f32_bf16 v122, v86, v126
  v_dot2c_f32_bf16 v60, v86, v86
  v_dot2c_f32_bf16 v123, v87, v126
  v_dot2c_f32_bf16 v61, v87, v87
  s_waitcnt vmcnt(6)
  v_dot2c_f32_bf16 v122, v88, v126
  v_dot2c_f32_bf16 v60, v88, v88
  v_dot2c_f32_bf16 v123, v89, v126
  v_dot2c_f32_bf16 v61, v89, v89
  v_dot2c_f32_bf16 v122, v90, v126
  v_dot2c_f32_bf16 v60, v90, v90
  v_dot2c_f32_bf16 v123, v91, v126
  v_dot2c_f32_bf16 v61, v91, v91
  s_waitcnt vmcnt(5)
  v_dot2c_f32_bf16 v122, v92, v126
  v_dot2c_f32_bf16 v60, v92, v92
  v_dot2c_f32_bf16 v123, v93, v126
  v_dot2c_f32_bf16 v61, v93, v93
  v_dot2c_f32_bf16 v122, v94, v126
  v_dot2c_f32_bf16 v60, v94, v94
  v_dot2c_f32_bf16 v123, v95, v126
  v_dot2c_f32_bf16 v61, v95, v95
  s_waitcnt vmcnt(4)
  v_dot2c_f32_bf16 v122, v96, v126
  v_dot2c_f32_bf16 v60, v96, v96
  v_dot2c_f32_bf16 v123, v97, v126
  v_dot2c_f32_bf16 v61, v97, v97
  v_dot2c_f32_bf16 v122, v98, v126
  v_dot2c_f32_bf16 v60, v98, v98
  v_dot2c_f32_bf16 v123, v99, v126
  v_dot2c_f32_bf16 v61, v99, v99
  s_waitcnt vmcnt(3)
  v_dot2c_f32_bf16 v122, v100, v126
  v_dot2c_f32_bf16 v60, v100, v100
  v_dot2c_f32_bf16 v123, v101, v126
  v_dot2c_f32_bf16 v61, v101, v101
  v_dot2c_f32_bf16 v122, v102, v126
  v_dot2c_f32_bf16 v60, v102, v102
  v_dot2c_f32_bf16 v123, v103, v126
  v_dot2c_f32_bf16 v61, v103, v103
  s_waitcnt vmcnt(2)
  v_dot2c_f32_bf16 v122, v104, v126
  v_dot2c_f32_bf16 v60, v104, v104
  v_dot2c_f32_bf16 v123, v105, v126
  v_dot2c_f32_bf16 v61, v105, v105
  v_dot2c_f32_bf16 v122, v106, v126
  v_dot2c_f32_bf16 v60, v106, v106
  v_dot2c_f32_bf16 v123, v107, v126
  v_dot2c_f32_bf16 v61, v107, v107
  s_waitcnt vmcnt(1)
  v_dot2c_f32_bf16 v122, v108, v126
  v_dot2c_f32_bf16 v60, v108, v108
  v_dot2c_f32_bf16 v123, v109, v126
  v_dot2c_f32_bf16 v61, v109, v109
  v_dot2c_f32_bf16 v122, v110, v126
  v_dot2c_f32_bf16 v60, v110, v110
  v_dot2c_f32_bf16 v123, v111, v126
  v_dot2c_f32_bf16 v61, v111, v111
  s_branch parallel_sum__ssm_conv_h3__dense_activation_gelu__prompt_kernel_sj
parallel_sum__ssm_conv_h3__dense_activation_gelu__prompt_kernel_sy:
  s_waitcnt vmcnt(11)
  v_dot2c_f32_bf16 v122, v76, v126
  v_dot2c_f32_bf16 v60, v76, v76
  v_dot2c_f32_bf16 v123, v77, v126
  v_dot2c_f32_bf16 v61, v77, v77
  v_dot2c_f32_bf16 v122, v78, v126
  v_dot2c_f32_bf16 v60, v78, v78
  v_dot2c_f32_bf16 v123, v79, v126
  v_dot2c_f32_bf16 v61, v79, v79
  s_waitcnt vmcnt(10)
  v_dot2c_f32_bf16 v122, v80, v126
  v_dot2c_f32_bf16 v60, v80, v80
  v_dot2c_f32_bf16 v123, v81, v126
  v_dot2c_f32_bf16 v61, v81, v81
  v_dot2c_f32_bf16 v122, v82, v126
  v_dot2c_f32_bf16 v60, v82, v82
  v_dot2c_f32_bf16 v123, v83, v126
  v_dot2c_f32_bf16 v61, v83, v83
  s_waitcnt vmcnt(9)
  v_dot2c_f32_bf16 v122, v84, v126
  v_dot2c_f32_bf16 v60, v84, v84
  v_dot2c_f32_bf16 v123, v85, v126
  v_dot2c_f32_bf16 v61, v85, v85
  v_dot2c_f32_bf16 v122, v86, v126
  v_dot2c_f32_bf16 v60, v86, v86
  v_dot2c_f32_bf16 v123, v87, v126
  v_dot2c_f32_bf16 v61, v87, v87
  s_waitcnt vmcnt(8)
  v_dot2c_f32_bf16 v122, v88, v126
  v_dot2c_f32_bf16 v60, v88, v88
  v_dot2c_f32_bf16 v123, v89, v126
  v_dot2c_f32_bf16 v61, v89, v89
  v_dot2c_f32_bf16 v122, v90, v126
  v_dot2c_f32_bf16 v60, v90, v90
  v_dot2c_f32_bf16 v123, v91, v126
  v_dot2c_f32_bf16 v61, v91, v91
  s_waitcnt vmcnt(7)
  v_dot2c_f32_bf16 v122, v92, v126
  v_dot2c_f32_bf16 v60, v92, v92
  v_dot2c_f32_bf16 v123, v93, v126
  v_dot2c_f32_bf16 v61, v93, v93
  v_dot2c_f32_bf16 v122, v94, v126
  v_dot2c_f32_bf16 v60, v94, v94
  v_dot2c_f32_bf16 v123, v95, v126
  v_dot2c_f32_bf16 v61, v95, v95
  s_waitcnt vmcnt(6)
  v_dot2c_f32_bf16 v122, v96, v126
  v_dot2c_f32_bf16 v60, v96, v96
  v_dot2c_f32_bf16 v123, v97, v126
  v_dot2c_f32_bf16 v61, v97, v97
  v_dot2c_f32_bf16 v122, v98, v126
  v_dot2c_f32_bf16 v60, v98, v98
  v_dot2c_f32_bf16 v123, v99, v126
  v_dot2c_f32_bf16 v61, v99, v99
  s_waitcnt vmcnt(5)
  v_dot2c_f32_bf16 v122, v100, v126
  v_dot2c_f32_bf16 v60, v100, v100
  v_dot2c_f32_bf16 v123, v101, v126
  v_dot2c_f32_bf16 v61, v101, v101
  v_dot2c_f32_bf16 v122, v102, v126
  v_dot2c_f32_bf16 v60, v102, v102
  v_dot2c_f32_bf16 v123, v103, v126
  v_dot2c_f32_bf16 v61, v103, v103
  s_waitcnt vmcnt(4)
  v_dot2c_f32_bf16 v122, v104, v126
  v_dot2c_f32_bf16 v60, v104, v104
  v_dot2c_f32_bf16 v123, v105, v126
  v_dot2c_f32_bf16 v61, v105, v105
  v_dot2c_f32_bf16 v122, v106, v126
  v_dot2c_f32_bf16 v60, v106, v106
  v_dot2c_f32_bf16 v123, v107, v126
  v_dot2c_f32_bf16 v61, v107, v107
  s_waitcnt vmcnt(3)
  v_dot2c_f32_bf16 v122, v108, v126
  v_dot2c_f32_bf16 v60, v108, v108
  v_dot2c_f32_bf16 v123, v109, v126
  v_dot2c_f32_bf16 v61, v109, v109
  v_dot2c_f32_bf16 v122, v110, v126
  v_dot2c_f32_bf16 v60, v110, v110
  v_dot2c_f32_bf16 v123, v111, v126
  v_dot2c_f32_bf16 v61, v111, v111
  s_waitcnt vmcnt(2)
parallel_sum__ssm_conv_h3__dense_activation_gelu__prompt_kernel_sj:
  s_cbranch_vccnz parallel_sum__ssm_conv_h3__dense_activation_gelu__prompt_kernel_p0
parallel_sum__ssm_conv_h3__dense_activation_gelu__prompt_kernel_p0b:
  s_nop 2
  v_add_f32 v122, v122, v123
  v_add_f32 v60, v60, v61
  s_nop 0
  v_add_f32 v122, v122, v122 quad_perm:[1,0,3,2] row_mask:0xf bank_mask:0xf
  v_add_f32 v60, v60, v60 quad_perm:[1,0,3,2] row_mask:0xf bank_mask:0xf
  s_nop 0
  v_add_f32 v122, v122, v122 quad_perm:[2,3,0,1] row_mask:0xf bank_mask:0xf
  v_add_f32 v60, v60, v60 quad_perm:[2,3,0,1] row_mask:0xf bank_mask:0xf
  s_nop 0
  v_add_f32 v122, v122, v122 row_half_mirror row_mask:0xf bank_mask:0xf
  v_add_f32 v60, v60, v60 row_half_mirror row_mask:0xf bank_mask:0xf
  v_mul_f32 v122, 0x3ae38e39, v122
  v_mul_f32 v60, 0x3ae38e39, v60
  v_fma_f32 v60, -v122, v122, v60
  v_max_f32 v60, 0, v60
  v_cvt_pk_bf16_f32 v122, v122, v122
  v_and_b32 v122, 0xffff0000, v122
  v_cvt_pk_bf16_f32 v60, v60, v60
  v_and_b32 v60, 0xffff0000, v60
  v_add_f32 v60, 0x3727c5ac, v60
  v_cvt_pk_bf16_f32 v60, v60, v60
  v_and_b32 v60, 0xffff0000, v60
  v_sqrt_f32 v60, v60
  s_nop 0
  v_cvt_pk_bf16_f32 v60, v60, v60
  v_and_b32 v60, 0xffff0000, v60
  v_rcp_f32 v60, v60
  s_nop 0
  v_mul_f32 v61, -v122, v60
  v_lshlrev_b32 v128, 16, v76
  v_and_b32 v129, 0xffff0000, v76
  v_lshlrev_b32 v130, 16, v77
  v_and_b32 v131, 0xffff0000, v77
  v_lshlrev_b32 v132, 16, v78
  v_and_b32 v133, 0xffff0000, v78
  v_lshlrev_b32 v134, 16, v79
  v_and_b32 v135, 0xffff0000, v79
  v_pk_fma_f32 v[128:129], v[128:129], v[60:61], v[60:61] op_sel:[0,0,1] op_sel_hi:[1,0,1]
  v_pk_fma_f32 v[130:131], v[130:131], v[60:61], v[60:61] op_sel:[0,0,1] op_sel_hi:[1,0,1]
  v_pk_fma_f32 v[132:133], v[132:133], v[60:61], v[60:61] op_sel:[0,0,1] op_sel_hi:[1,0,1]
  v_pk_fma_f32 v[134:135], v[134:135], v[60:61], v[60:61] op_sel:[0,0,1] op_sel_hi:[1,0,1]
  v_cvt_pk_bf16_f32 v16, v128, v129
  v_cvt_pk_bf16_f32 v17, v130, v131
  v_cvt_pk_bf16_f32 v18, v132, v133
  v_cvt_pk_bf16_f32 v19, v134, v135
  ds_write2st64_b64 v114, v[16:17], v[18:19] offset0:0 offset1:1
  v_lshlrev_b32 v136, 16, v80
  v_and_b32 v137, 0xffff0000, v80
  v_lshlrev_b32 v138, 16, v81
  v_and_b32 v139, 0xffff0000, v81
  v_lshlrev_b32 v140, 16, v82
  v_and_b32 v141, 0xffff0000, v82
  v_lshlrev_b32 v142, 16, v83
  v_and_b32 v143, 0xffff0000, v83
  v_pk_fma_f32 v[136:137], v[136:137], v[60:61], v[60:61] op_sel:[0,0,1] op_sel_hi:[1,0,1]
  v_pk_fma_f32 v[138:139], v[138:139], v[60:61], v[60:61] op_sel:[0,0,1] op_sel_hi:[1,0,1]
  v_pk_fma_f32 v[140:141], v[140:141], v[60:61], v[60:61] op_sel:[0,0,1] op_sel_hi:[1,0,1]
  v_pk_fma_f32 v[142:143], v[142:143], v[60:61], v[60:61] op_sel:[0,0,1] op_sel_hi:[1,0,1]
  v_cvt_pk_bf16_f32 v20, v136, v137
  v_cvt_pk_bf16_f32 v21, v138, v139
  v_cvt_pk_bf16_f32 v22, v140, v141
  v_cvt_pk_bf16_f32 v23, v142, v143
  ds_write2st64_b64 v114, v[20:21], v[22:23] offset0:16 offset1:17
  s_cbranch_vccnz parallel_sum__ssm_conv_h3__dense_activation_gelu__prompt_kernel_h11
  v_lshlrev_b32 v148, 16, v144
  v_and_b32 v149, 0xffff0000, v144
  v_lshlrev_b32 v150, 16, v145
  v_and_b32 v151, 0xffff0000, v145
  v_lshlrev_b32 v10, 4, v0
  v_add_u32 v10, 80032, v10
  ds_write_b128 v10, v[148:151]
parallel_sum__ssm_conv_h3__dense_activation_gelu__prompt_kernel_h11:
  v_lshlrev_b32 v128, 16, v84
  v_and_b32 v129, 0xffff0000, v84
  v_lshlrev_b32 v130, 16, v85
  v_and_b32 v131, 0xffff0000, v85
  v_lshlrev_b32 v132, 16, v86
  v_and_b32 v133, 0xffff0000, v86
  v_lshlrev_b32 v134, 16, v87
  v_and_b32 v135, 0xffff0000, v87
  v_pk_fma_f32 v[128:129], v[128:129], v[60:61], v[60:61] op_sel:[0,0,1] op_sel_hi:[1,0,1]
  v_pk_fma_f32 v[130:131], v[130:131], v[60:61], v[60:61] op_sel:[0,0,1] op_sel_hi:[1,0,1]
  v_pk_fma_f32 v[132:133], v[132:133], v[60:61], v[60:61] op_sel:[0,0,1] op_sel_hi:[1,0,1]
  v_pk_fma_f32 v[134:135], v[134:135], v[60:61], v[60:61] op_sel:[0,0,1] op_sel_hi:[1,0,1]
  v_cvt_pk_bf16_f32 v24, v128, v129
  v_cvt_pk_bf16_f32 v25, v130, v131
  v_cvt_pk_bf16_f32 v26, v132, v133
  v_cvt_pk_bf16_f32 v27, v134, v135
  ds_write2st64_b64 v114, v[24:25], v[26:27] offset0:32 offset1:33
  s_cbranch_vccnz parallel_sum__ssm_conv_h3__dense_activation_gelu__prompt_kernel_p3
parallel_sum__ssm_conv_h3__dense_activation_gelu__prompt_kernel_p3b:
  v_lshlrev_b32 v136, 16, v88
  v_and_b32 v137, 0xffff0000, v88
  v_lshlrev_b32 v138, 16, v89
  v_and_b32 v139, 0xffff0000, v89
  v_lshlrev_b32 v140, 16, v90
  v_and_b32 v141, 0xffff0000, v90
  v_lshlrev_b32 v142, 16, v91
  v_and_b32 v143, 0xffff0000, v91
  v_pk_fma_f32 v[136:137], v[136:137], v[60:61], v[60:61] op_sel:[0,0,1] op_sel_hi:[1,0,1]
  v_pk_fma_f32 v[138:139], v[138:139], v[60:61], v[60:61] op_sel:[0,0,1] op_sel_hi:[1,0,1]
  v_pk_fma_f32 v[140:141], v[140:141], v[60:61], v[60:61] op_sel:[0,0,1] op_sel_hi:[1,0,1]
  v_pk_fma_f32 v[142:143], v[142:143], v[60:61], v[60:61] op_sel:[0,0,1] op_sel_hi:[1,0,1]
  v_cvt_pk_bf16_f32 v28, v136, v137
  v_cvt_pk_bf16_f32 v29, v138, v139
  v_cvt_pk_bf16_f32 v30, v140, v141
  v_cvt_pk_bf16_f32 v31, v142, v143
  ds_write2st64_b64 v114, v[28:29], v[30:31] offset0:48 offset1:49
  v_lshlrev_b32 v128, 16, v92
  v_and_b32 v129, 0xffff0000, v92
  v_lshlrev_b32 v130, 16, v93
  v_and_b32 v131, 0xffff0000, v93
  v_lshlrev_b32 v132, 16, v94
  v_and_b32 v133, 0xffff0000, v94
  v_lshlrev_b32 v134, 16, v95
  v_and_b32 v135, 0xffff0000, v95
  v_pk_fma_f32 v[128:129], v[128:129], v[60:61], v[60:61] op_sel:[0,0,1] op_sel_hi:[1,0,1]
  v_pk_fma_f32 v[130:131], v[130:131], v[60:61], v[60:61] op_sel:[0,0,1] op_sel_hi:[1,0,1]
  v_pk_fma_f32 v[132:133], v[132:133], v[60:61], v[60:61] op_sel:[0,0,1] op_sel_hi:[1,0,1]
  v_pk_fma_f32 v[134:135], v[134:135], v[60:61], v[60:61] op_sel:[0,0,1] op_sel_hi:[1,0,1]
  v_cvt_pk_bf16_f32 v32, v128, v129
  v_cvt_pk_bf16_f32 v33, v130, v131
  v_cvt_pk_bf16_f32 v34, v132, v133
  v_cvt_pk_bf16_f32 v35, v134, v135
  ds_write2st64_b64 v114, v[32:33], v[34:35] offset0:64 offset1:65
  s_cbranch_vccnz parallel_sum__ssm_conv_h3__dense_activation_gelu__prompt_kernel_p5
parallel_sum__ssm_conv_h3__dense_activation_gelu__prompt_kernel_p5b:
  v_lshlrev_b32 v136, 16, v96
  v_and_b32 v137, 0xffff0000, v96
  v_lshlrev_b32 v138, 16, v97
  v_and_b32 v139, 0xffff0000, v97
  v_lshlrev_b32 v140, 16, v98
  v_and_b32 v141, 0xffff0000, v98
  v_lshlrev_b32 v142, 16, v99
  v_and_b32 v143, 0xffff0000, v99
  v_pk_fma_f32 v[136:137], v[136:137], v[60:61], v[60:61] op_sel:[0,0,1] op_sel_hi:[1,0,1]
  v_pk_fma_f32 v[138:139], v[138:139], v[60:61], v[60:61] op_sel:[0,0,1] op_sel_hi:[1,0,1]
  v_pk_fma_f32 v[140:141], v[140:141], v[60:61], v[60:61] op_sel:[0,0,1] op_sel_hi:[1,0,1]
  v_pk_fma_f32 v[142:143], v[142:143], v[60:61], v[60:61] op_sel:[0,0,1] op_sel_hi:[1,0,1]
  v_cvt_pk_bf16_f32 v36, v136, v137
  v_cvt_pk_bf16_f32 v37, v138, v139
  v_cvt_pk_bf16_f32 v38, v140, v141
  v_cvt_pk_bf16_f32 v39, v142, v143
  ds_write2st64_b64 v114, v[36:37], v[38:39] offset0:80 offset1:81
  v_lshlrev_b32 v128, 16, v100
  v_and_b32 v129, 0xffff0000, v100
  v_lshlrev_b32 v130, 16, v101
  v_and_b32 v131, 0xffff0000, v101
  v_lshlrev_b32 v132, 16, v102
  v_and_b32 v133, 0xffff0000, v102
  v_lshlrev_b32 v134, 16, v103
  v_and_b32 v135, 0xffff0000, v103
  v_pk_fma_f32 v[128:129], v[128:129], v[60:61], v[60:61] op_sel:[0,0,1] op_sel_hi:[1,0,1]
  v_pk_fma_f32 v[130:131], v[130:131], v[60:61], v[60:61] op_sel:[0,0,1] op_sel_hi:[1,0,1]
  v_pk_fma_f32 v[132:133], v[132:133], v[60:61], v[60:61] op_sel:[0,0,1] op_sel_hi:[1,0,1]
  v_pk_fma_f32 v[134:135], v[134:135], v[60:61], v[60:61] op_sel:[0,0,1] op_sel_hi:[1,0,1]
  v_cvt_pk_bf16_f32 v40, v128, v129
  v_cvt_pk_bf16_f32 v41, v130, v131
  v_cvt_pk_bf16_f32 v42, v132, v133
  v_cvt_pk_bf16_f32 v43, v134, v135
  ds_write2st64_b64 v114, v[40:41], v[42:43] offset0:96 offset1:97
  s_cbranch_vccnz parallel_sum__ssm_conv_h3__dense_activation_gelu__prompt_kernel_p7
parallel_sum__ssm_conv_h3__dense_activation_gelu__prompt_kernel_p7b:
  v_lshlrev_b32 v136, 16, v104
  v_and_b32 v137, 0xffff0000, v104
  v_lshlrev_b32 v138, 16, v105
  v_and_b32 v139, 0xffff0000, v105
  v_lshlrev_b32 v140, 16, v106
  v_and_b32 v141, 0xffff0000, v106
  v_lshlrev_b32 v142, 16, v107
  v_and_b32 v143, 0xffff0000, v107
  v_pk_fma_f32 v[136:137], v[136:137], v[60:61], v[60:61] op_sel:[0,0,1] op_sel_hi:[1,0,1]
  v_pk_fma_f32 v[138:139], v[138:139], v[60:61], v[60:61] op_sel:[0,0,1] op_sel_hi:[1,0,1]
  v_pk_fma_f32 v[140:141], v[140:141], v[60:61], v[60:61] op_sel:[0,0,1] op_sel_hi:[1,0,1]
  v_pk_fma_f32 v[142:143], v[142:143], v[60:61], v[60:61] op_sel:[0,0,1] op_sel_hi:[1,0,1]
  v_cvt_pk_bf16_f32 v44, v136, v137
  v_cvt_pk_bf16_f32 v45, v138, v139
  v_cvt_pk_bf16_f32 v46, v140, v141
  v_cvt_pk_bf16_f32 v47, v142, v143
  ds_write2st64_b64 v114, v[44:45], v[46:47] offset0:112 offset1:113
  v_lshlrev_b32 v128, 16, v108
  v_and_b32 v129, 0xffff0000, v108
  v_lshlrev_b32 v130, 16, v109
  v_and_b32 v131, 0xffff0000, v109
  v_lshlrev_b32 v132, 16, v110
  v_and_b32 v133, 0xffff0000, v110
  v_lshlrev_b32 v134, 16, v111
  v_and_b32 v135, 0xffff0000, v111
  v_pk_fma_f32 v[128:129], v[128:129], v[60:61], v[60:61] op_sel:[0,0,1] op_sel_hi:[1,0,1]
  v_pk_fma_f32 v[130:131], v[130:131], v[60:61], v[60:61] op_sel:[0,0,1] op_sel_hi:[1,0,1]
  v_pk_fma_f32 v[132:133], v[132:133], v[60:61], v[60:61] op_sel:[0,0,1] op_sel_hi:[1,0,1]
  v_pk_fma_f32 v[134:135], v[134:135], v[60:61], v[60:61] op_sel:[0,0,1] op_sel_hi:[1,0,1]
  v_cvt_pk_bf16_f32 v48, v128, v129
  v_cvt_pk_bf16_f32 v49, v130, v131
  v_cvt_pk_bf16_f32 v50, v132, v133
  v_cvt_pk_bf16_f32 v51, v134, v135
  ds_write2st64_b64 v114, v[48:49], v[50:51] offset0:128 offset1:129
  s_cbranch_vccnz parallel_sum__ssm_conv_h3__dense_activation_gelu__prompt_kernel_p9
parallel_sum__ssm_conv_h3__dense_activation_gelu__prompt_kernel_p9b:
  s_lshl_b32 s39, s32, 6
  s_add_u32 s39, s39, 84128
  v_lshl_add_u32 v10, v120, 4, s39
  s_cbranch_vccnz parallel_sum__ssm_conv_h3__dense_activation_gelu__prompt_kernel_p10
parallel_sum__ssm_conv_h3__dense_activation_gelu__prompt_kernel_p10b:
  s_cbranch_vccnz parallel_sum__ssm_conv_h3__dense_activation_gelu__prompt_kernel_pe
  s_waitcnt vmcnt(0)
  s_branch parallel_sum__ssm_conv_h3__dense_activation_gelu__prompt_kernel_pe
parallel_sum__ssm_conv_h3__dense_activation_gelu__prompt_kernel_p0:
  s_add_u32 m0, s56, 8192
  s_add_u32 s39, s44, 589824
  buffer_load_dwordx4 v54, s[8:11], s39 offen lds
  buffer_load_dwordx4 v52, s[8:11], s39 offen offset:1024 lds
  s_add_u32 m0, s56, 16384
  s_add_u32 s39, s44, 1179648
  buffer_load_dwordx4 v54, s[8:11], s39 offen lds
  buffer_load_dwordx4 v52, s[8:11], s39 offen offset:1024 lds
  s_add_u32 m0, s56, 24576
  s_add_u32 s39, s44, 1769472
  buffer_load_dwordx4 v54, s[8:11], s39 offen lds
  buffer_load_dwordx4 v52, s[8:11], s39 offen offset:1024 lds
  s_branch parallel_sum__ssm_conv_h3__dense_activation_gelu__prompt_kernel_p0b
parallel_sum__ssm_conv_h3__dense_activation_gelu__prompt_kernel_p3:
  s_add_u32 m0, s56, 32768
  s_add_u32 s39, s44, 2359296
  buffer_load_dwordx4 v54, s[8:11], s39 offen lds
  buffer_load_dwordx4 v52, s[8:11], s39 offen offset:1024 lds
  s_branch parallel_sum__ssm_conv_h3__dense_activation_gelu__prompt_kernel_p3b
parallel_sum__ssm_conv_h3__dense_activation_gelu__prompt_kernel_p5:
  s_add_u32 m0, s56, 40960
  s_add_u32 s39, s44, 2949120
  buffer_load_dwordx4 v54, s[8:11], s39 offen lds
  buffer_load_dwordx4 v52, s[8:11], s39 offen offset:1024 lds
  s_branch parallel_sum__ssm_conv_h3__dense_activation_gelu__prompt_kernel_p5b
parallel_sum__ssm_conv_h3__dense_activation_gelu__prompt_kernel_p7:
  s_add_u32 m0, s56, 49152
  s_add_u32 s39, s44, 3538944
  buffer_load_dwordx4 v54, s[8:11], s39 offen lds
  buffer_load_dwordx4 v52, s[8:11], s39 offen offset:1024 lds
  s_branch parallel_sum__ssm_conv_h3__dense_activation_gelu__prompt_kernel_p7b
parallel_sum__ssm_conv_h3__dense_activation_gelu__prompt_kernel_p9:
  s_add_u32 m0, s56, 57344
  s_add_u32 s39, s44, 4128768
  buffer_load_dwordx4 v54, s[8:11], s39 offen lds
  buffer_load_dwordx4 v52, s[8:11], s39 offen offset:1024 lds
  s_branch parallel_sum__ssm_conv_h3__dense_activation_gelu__prompt_kernel_p9b
parallel_sum__ssm_conv_h3__dense_activation_gelu__prompt_kernel_p10:
  s_add_u32 m0, s56, 65536
  s_add_u32 s39, s44, 4718592
  buffer_load_dwordx4 v54, s[8:11], s39 offen lds
  buffer_load_dwordx4 v52, s[8:11], s39 offen offset:1024 lds
  s_add_u32 m0, s56, 73728
  s_add_u32 s39, s45, 0
  buffer_load_dwordx4 v54, s[8:11], s39 offen lds
  buffer_load_dwordx4 v52, s[8:11], s39 offen offset:1024 lds
  s_branch parallel_sum__ssm_conv_h3__dense_activation_gelu__prompt_kernel_p10b
parallel_sum__ssm_conv_h3__dense_activation_gelu__prompt_kernel_pe:
  s_waitcnt vmcnt(12) lgkmcnt(0)
  s_barrier
  ds_read_b128 v[64:67], v10 offset:0
  ds_read_b64_tr_b16 v[32:33], v2 offset:0
  ds_read_b64_tr_b16 v[34:35], v2 offset:2048
  ds_read_b128 v[112:115], v5 offset:0
  ds_read_b64_tr_b16 v[36:37], v2 offset:4096
  ds_read_b64_tr_b16 v[38:39], v2 offset:6144
  ds_read_b128 v[120:123], v57 offset:4096
  ds_read_b64_tr_b16 v[40:41], v2 offset:8192
  ds_read_b64_tr_b16 v[42:43], v2 offset:10240
  ds_read_b128 v[116:119], v5 offset:1024
  ds_read_b128 v[124:127], v57 offset:5120
  s_waitcnt lgkmcnt(7)
  v_mfma_f32_16x16x32_bf16 v[16:19], v[32:35], v[112:115], v[64:67]
  ds_read_b64_tr_b16 v[44:45], v2 offset:12288
  ds_read_b64_tr_b16 v[46:47], v2 offset:14336
  ds_read_b128 v[132:135], v5 offset:9216
  ds_read_b128 v[140:143], v57 offset:13312
  s_waitcnt lgkmcnt(8)
  v_mfma_f32_16x16x32_bf16 v[16:19], v[36:39], v[120:123], v[16:19]
  ds_read_b64_tr_b16 v[48:49], v2 offset:16384
  ds_read_b64_tr_b16 v[50:51], v2 offset:18432
  ds_read_b128 v[128:131], v5 offset:8192
  s_waitcnt lgkmcnt(8)
  v_mfma_f32_16x16x32_bf16 v[20:23], v[32:35], v[116:119], v[64:67]
  ds_read_b64_tr_b16 v[32:33], v2 offset:20480
  s_add_u32 m0, s33, 90112
  ds_read_b128 v[136:139], v57 offset:12288
  ds_read_b128 v[144:147], v5 offset:16384
  s_waitcnt lgkmcnt(10)
  v_mfma_f32_16x16x32_bf16 v[20:23], v[36:39], v[124:127], v[20:23]
  ds_read_b64_tr_b16 v[34:35], v2 offset:22528
  s_add_u32 s39, s45, 589824
  ds_read_b128 v[152:155], v57 offset:20480
  s_waitcnt lgkmcnt(9)
  v_mfma_f32_16x16x32_bf16 v[20:23], v[40:43], v[132:135], v[20:23]
  ds_read_b64_tr_b16 v[36:37], v2 offset:24576
  ds_read_b128 v[148:151], v5 offset:17408
  ds_read_b128 v[156:159], v57 offset:21504
  s_waitcnt lgkmcnt(11)
  v_mfma_f32_16x16x32_bf16 v[20:23], v[44:47], v[140:143], v[20:23]
  ds_read_b64_tr_b16 v[38:39], v2 offset:26624
  ds_read_b128 v[164:167], v5 offset:25600
  s_waitcnt vmcnt(8) lgkmcnt(8)
  s_barrier
  buffer_load_dwordx4 v8, s[8:11], s39 offen lds
  s_waitcnt lgkmcnt(5)
  v_mfma_f32_16x16x32_bf16 v[16:19], v[40:43], v[128:131], v[16:19]
  ds_read_b64_tr_b16 v[40:41], v2 offset:28672
  s_add_u32 m0, s33, 98304
  ds_read_b128 v[172:175], v57 offset:29696
  ds_read_b128 v[160:163], v5 offset:24576
  v_mfma_f32_16x16x32_bf16 v[16:19], v[44:47], v[136:139], v[16:19]
  ds_read_b64_tr_b16 v[42:43], v2 offset:30720
  s_add_u32 s39, s45, 1179648
  ds_read_b128 v[168:171], v57 offset:28672
  v_mfma_f32_16x16x32_bf16 v[16:19], v[48:51], v[144:147], v[16:19]
  ds_read_b64_tr_b16 v[44:45], v2 offset:32768
  ds_read_b128 v[176:179], v5 offset:32768
  ds_read_b128 v[184:187], v57 offset:36864
  v_mfma_f32_16x16x32_bf16 v[16:19], v[32:35], v[152:155], v[16:19]
  ds_read_b64_tr_b16 v[46:47], v2 offset:34816
  ds_read_b128 v[180:183], v5 offset:33792
  buffer_load_dwordx4 v8, s[8:11], s39 offen lds
  s_waitcnt lgkmcnt(6)
  v_mfma_f32_16x16x32_bf16 v[20:23], v[48:51], v[148:151], v[20:23]
  ds_read_b64_tr_b16 v[48:49], v2 offset:36864
  s_add_u32 m0, s33, 106496
  ds_read_b128 v[188:191], v57 offset:37888
  v_mfma_f32_16x16x32_bf16 v[20:23], v[32:35], v[156:159], v[20:23]
  ds_read_b64_tr_b16 v[50:51], v2 offset:38912
  s_add_u32 s39, s45, 1769472
  ds_read_b128 v[196:199], v5 offset:41984
  ds_read_b128 v[204:207], v57 offset:46080
  v_mfma_f32_16x16x32_bf16 v[20:23], v[36:39], v[164:167], v[20:23]
  ds_read_b64_tr_b16 v[32:33], v2 offset:40960
  ds_read_b128 v[192:195], v5 offset:40960
  v_mfma_f32_16x16x32_bf16 v[20:23], v[40:43], v[172:175], v[20:23]
  ds_read_b64_tr_b16 v[34:35], v2 offset:43008
  ds_read_b128 v[200:203], v57 offset:45056
  ds_read_b128 v[208:211], v5 offset:49152
  s_waitcnt vmcnt(6) lgkmcnt(8)
  s_barrier
  buffer_load_dwordx4 v8, s[8:11], s39 offen lds
  s_lshl_b32 s3, s29, 9
  s_add_u32 s3, s3, 25165824
  buffer_store_dwordx2 v[60:61], v62, s[24:27], s3 offen sc1
  s_waitcnt lgkmcnt(7)
  v_mfma_f32_16x16x32_bf16 v[16:19], v[36:39], v[160:163], v[16:19]
  ds_read_b64_tr_b16 v[36:37], v2 offset:45056
  s_add_u32 m0, s33, 114688
  ds_read_b128 v[216:219], v57 offset:53248
  v_mfma_f32_16x16x32_bf16 v[16:19], v[40:43], v[168:171], v[16:19]
  ds_read_b64_tr_b16 v[38:39], v2 offset:47104
  s_add_u32 s39, s45, 2359296
  ds_read_b128 v[212:215], v5 offset:50176
  ds_read_b128 v[220:223], v57 offset:54272
  v_mfma_f32_16x16x32_bf16 v[16:19], v[44:47], v[176:179], v[16:19]
  ds_read_b64_tr_b16 v[40:41], v2 offset:49152
  ds_read_b128 v[228:231], v5 offset:58368
  ds_read_b128 v[64:67], v10 offset:256
  v_mfma_f32_16x16x32_bf16 v[16:19], v[48:51], v[184:187], v[16:19]
  ds_read_b64_tr_b16 v[42:43], v2 offset:51200
  ds_read_b128 v[236:239], v57 offset:62464
  ds_read_b128 v[224:227], v5 offset:57344
  buffer_load_dwordx4 v8, s[8:11], s39 offen lds
  s_add_u32 m0, s33, 122880
  s_add_u32 s39, s45, 2949120
  buffer_load_dwordx4 v8, s[8:11], s39 offen lds
  s_waitcnt lgkmcnt(8)
  v_mfma_f32_16x16x32_bf16 v[20:23], v[44:47], v[180:183], v[20:23]
  ds_read_b64_tr_b16 v[44:45], v2 offset:53248
  s_add_u32 m0, s33, 131072
  ds_read_b128 v[232:235], v57 offset:61440
  v_mfma_f32_16x16x32_bf16 v[20:23], v[48:51], v[188:191], v[20:23]
  ds_read_b64_tr_b16 v[46:47], v2 offset:55296
  s_add_u32 s39, s45, 3538944
  ds_read_b128 v[240:243], v56 offset:0
  ds_read_b128 v[248:251], v58 offset:4096
  v_mfma_f32_16x16x32_bf16 v[20:23], v[32:35], v[196:199], v[20:23]
  ds_read_b64_tr_b16 v[48:49], v2 offset:57344
  ds_read_b128 v[244:247], v56 offset:1024
  v_mfma_f32_16x16x32_bf16 v[20:23], v[36:39], v[204:207], v[20:23]
  ds_read_b64_tr_b16 v[50:51], v2 offset:59392
  ds_read_b128 v[252:255], v58 offset:5120
  s_waitcnt vmcnt(8) lgkmcnt(7)
  s_barrier
  buffer_load_dwordx4 v8, s[8:11], s39 offen lds
  s_add_u32 m0, s33, 139264
  s_add_u32 s39, s45, 4128768
  buffer_load_dwordx4 v8, s[8:11], s39 offen lds
  s_waitcnt lgkmcnt(6)
  v_mfma_f32_16x16x32_bf16 v[16:19], v[32:35], v[192:195], v[16:19]
  ds_read_b64_tr_b16 v[32:33], v2 offset:61440
  s_add_u32 m0, s33, 147456
  v_mfma_f32_16x16x32_bf16 v[16:19], v[36:39], v[200:203], v[16:19]
  ds_read_b64_tr_b16 v[34:35], v2 offset:63488
  s_add_u32 s39, s45, 4718592
  v_mfma_f32_16x16x32_bf16 v[16:19], v[40:43], v[208:211], v[16:19]
  ds_read_b64_tr_b16 v[36:37], v3 offset:0
  v_mfma_f32_16x16x32_bf16 v[16:19], v[44:47], v[216:219], v[16:19]
  ds_read_b64_tr_b16 v[38:39], v3 offset:2048
  s_waitcnt vmcnt(7) lgkmcnt(4)
  s_barrier
  buffer_load_dwordx4 v8, s[8:11], s39 offen lds
  s_waitcnt lgkmcnt(2)
  v_mfma_f32_16x16x32_bf16 v[20:23], v[40:43], v[212:215], v[20:23]
  ds_read_b64_tr_b16 v[40:41], v3 offset:4096
  s_add_u32 m0, s33, 0
  v_mfma_f32_16x16x32_bf16 v[20:23], v[44:47], v[220:223], v[20:23]
  ds_read_b64_tr_b16 v[42:43], v3 offset:6144
  s_add_u32 s39, s46, 0
  v_mfma_f32_16x16x32_bf16 v[20:23], v[48:51], v[228:231], v[20:23]
  ds_read_b64_tr_b16 v[44:45], v3 offset:8192
  v_mfma_f32_16x16x32_bf16 v[20:23], v[32:35], v[236:239], v[20:23]
  ds_read_b64_tr_b16 v[46:47], v3 offset:10240
  buffer_load_dwordx4 v8, s[8:11], s39 offen lds
  s_waitcnt lgkmcnt(2)
  v_mfma_f32_16x16x32_bf16 v[16:19], v[48:51], v[224:227], v[16:19]
  ds_read_b64_tr_b16 v[48:49], v3 offset:12288
  s_add_u32 m0, s33, 8192
  v_mfma_f32_16x16x32_bf16 v[16:19], v[32:35], v[232:235], v[16:19]
  ds_read_b64_tr_b16 v[50:51], v3 offset:14336
  s_add_u32 s39, s46, 589824
  v_mfma_f32_16x16x32_bf16 v[16:19], v[36:39], v[240:243], v[16:19]
  ds_read_b64_tr_b16 v[32:33], v3 offset:24576
  v_mfma_f32_16x16x32_bf16 v[16:19], v[40:43], v[248:251], v[16:19]
  ds_read_b64_tr_b16 v[34:35], v3 offset:26624
  s_waitcnt vmcnt(7)
  s_barrier
  buffer_load_dwordx4 v8, s[8:11], s39 offen lds
  s_waitcnt lgkmcnt(2)
  v_mfma_f32_16x16x32_bf16 v[20:23], v[36:39], v[244:247], v[20:23]
  ds_read_b64_tr_b16 v[36:37], v3 offset:28672
  s_add_u32 m0, s33, 16384
  v_mfma_f32_16x16x32_bf16 v[20:23], v[40:43], v[252:255], v[20:23]
  ds_read_b64_tr_b16 v[38:39], v3 offset:30720
  s_add_u32 s39, s46, 1179648
  v_mfma_f32_16x16x32_bf16 v[24:27], v[44:47], v[112:115], v[64:67]
  ds_read_b64_tr_b16 v[40:41], v3 offset:32768
  v_mfma_f32_16x16x32_bf16 v[24:27], v[48:51], v[120:123], v[24:27]
  ds_read_b64_tr_b16 v[42:43], v3 offset:34816
  buffer_load_dwordx4 v8, s[8:11], s39 offen lds
  s_add_u32 m0, s33, 24576
  s_add_u32 s39, s46, 1769472
  v_mul_f32 v56, v16, v16
  v_mul_f32 v57, v17, v17
  buffer_load_dwordx4 v8, s[8:11], s39 offen lds
  v_mul_f32 v58, v18, v18
  v_mul_f32 v59, v19, v19
  v_mul_f32 v60, v20, v20
  v_mul_f32 v61, v21, v21
  v_mul_f32 v62, v22, v22
  v_mul_f32 v63, v23, v23
  s_waitcnt lgkmcnt(2)
  v_mfma_f32_16x16x32_bf16 v[28:31], v[44:47], v[116:119], v[64:67]
  ds_read_b64_tr_b16 v[44:45], v3 offset:36864
  s_add_u32 m0, s33, 32768
  v_mfma_f32_16x16x32_bf16 v[28:31], v[48:51], v[124:127], v[28:31]
  ds_read_b64_tr_b16 v[46:47], v3 offset:38912
  s_add_u32 s39, s46, 2359296
  v_mfma_f32_16x16x32_bf16 v[28:31], v[32:35], v[132:135], v[28:31]
  ds_read_b64_tr_b16 v[48:49], v3 offset:40960
  v_mfma_f32_16x16x32_bf16 v[28:31], v[36:39], v[140:143], v[28:31]
  ds_read_b64_tr_b16 v[50:51], v3 offset:43008
  s_waitcnt vmcnt(4)
  s_barrier
  buffer_load_dwordx4 v8, s[8:11], s39 offen lds
  v_fma_f32 v56, v56, s34, v7
  v_fma_f32 v57, v57, s34, v7
  s_cmp_eq_u32 s31, s28
  s_cbranch_scc1 parallel_sum__ssm_conv_h3__dense_activation_gelu__prompt_kernel_Z_xt0
parallel_sum__ssm_conv_h3__dense_activation_gelu__prompt_kernel_Z_xt0b:
  v_fma_f32 v58, v58, s34, v7
  v_fma_f32 v59, v59, s34, v7
  v_fma_f32 v60, v60, s34, v7
  v_fma_f32 v61, v61, s34, v7
  v_fma_f32 v62, v62, s34, v7
  v_fma_f32 v63, v63, s34, v7
  v_mul_f32 v56, v56, v16
  s_waitcnt lgkmcnt(2)
  v_mfma_f32_16x16x32_bf16 v[24:27], v[32:35], v[128:131], v[24:27]
  ds_read_b64_tr_b16 v[32:33], v3 offset:45056
  s_add_u32 m0, s33, 40960
  v_mfma_f32_16x16x32_bf16 v[24:27], v[36:39], v[136:139], v[24:27]
  ds_read_b64_tr_b16 v[34:35], v3 offset:47104
  s_add_u32 s39, s46, 2949120
  v_mfma_f32_16x16x32_bf16 v[24:27], v[40:43], v[144:147], v[24:27]
  ds_read_b64_tr_b16 v[36:37], v3 offset:49152
  v_mfma_f32_16x16x32_bf16 v[24:27], v[44:47], v[152:155], v[24:27]
  ds_read_b64_tr_b16 v[38:39], v3 offset:51200
  buffer_load_dwordx4 v8, s[8:11], s39 offen lds
  v_mul_f32 v57, v57, v17
  v_mul_f32 v58, v58, v18
  v_mul_f32 v59, v59, v19
  v_mul_f32 v60, v60, v20
  v_mul_f32 v61, v61, v21
  v_mul_f32 v62, v62, v22
  v_mul_f32 v63, v63, v23
  v_exp_f32 v56, v56
  s_waitcnt lgkmcnt(2)
  v_mfma_f32_16x16x32_bf16 v[28:31], v[40:43], v[148:151], v[28:31]
  ds_read_b64_tr_b16 v[40:41], v3 offset:53248
  s_add_u32 m0, s33, 49152
  v_mfma_f32_16x16x32_bf16 v[28:31], v[44:47], v[156:159], v[28:31]
  ds_read_b64_tr_b16 v[42:43], v3 offset:55296
  s_add_u32 s39, s46, 3538944
  v_mfma_f32_16x16x32_bf16 v[28:31], v[48:51], v[164:167], v[28:31]
  ds_read_b64_tr_b16 v[44:45], v3 offset:57344
  v_mfma_f32_16x16x32_bf16 v[28:31], v[32:35], v[172:175], v[28:31]
  ds_read_b64_tr_b16 v[46:47], v3 offset:59392
  buffer_load_dwordx4 v8, s[8:11], s39 offen lds
  v_exp_f32 v57, v57
  v_exp_f32 v58, v58
  v_exp_f32 v59, v59
  v_exp_f32 v60, v60
  s_waitcnt lgkmcnt(2)
  v_mfma_f32_16x16x32_bf16 v[24:27], v[48:51], v[160:163], v[24:27]
  ds_read_b64_tr_b16 v[48:49], v3 offset:61440
  s_add_u32 m0, s33, 57344
  v_mfma_f32_16x16x32_bf16 v[24:27], v[32:35], v[168:171], v[24:27]
  ds_read_b64_tr_b16 v[50:51], v3 offset:63488
  s_add_u32 s39, s46, 4128768
  v_mfma_f32_16x16x32_bf16 v[24:27], v[36:39], v[176:179], v[24:27]
  ds_read_b64_tr_b16 v[32:33], v4 offset:0
  ds_read_b128 v[64:67], v10 offset:512
  v_mfma_f32_16x16x32_bf16 v[24:27], v[40:43], v[184:187], v[24:27]
  ds_read_b64_tr_b16 v[34:35], v4 offset:2048
  buffer_load_dwordx4 v8, s[8:11], s39 offen lds
  s_add_u32 m0, s33, 65536
  s_add_u32 s39, s46, 4718592
  v_exp_f32 v61, v61
  v_exp_f32 v62, v62
  buffer_load_dwordx4 v8, s[8:11], s39 offen lds
  v_exp_f32 v63, v63
  v_add_f32 v56, 1.0, v56
  v_add_f32 v57, 1.0, v57
  s_waitcnt lgkmcnt(3)
  v_mfma_f32_16x16x32_bf16 v[28:31], v[36:39], v[180:183], v[28:31]
  ds_read_b64_tr_b16 v[36:37], v4 offset:4096
  s_add_u32 m0, s33, 155648
  v_mfma_f32_16x16x32_bf16 v[28:31], v[40:43], v[188:191], v[28:31]
  ds_read_b64_tr_b16 v[38:39], v4 offset:6144
  s_add_u32 s39, s47, 0
  v_mfma_f32_16x16x32_bf16 v[28:31], v[44:47], v[196:199], v[28:31]
  ds_read_b64_tr_b16 v[40:41], v4 offset:8192
  v_mfma_f32_16x16x32_bf16 v[28:31], v[48:51], v[204:207], v[28:31]
  ds_read_b64_tr_b16 v[42:43], v4 offset:10240
  buffer_load_dwordx4 v8, s[8:11], s39 offen lds
  v_add_f32 v58, 1.0, v58
  v_add_f32 v59, 1.0, v59
  v_add_f32 v60, 1.0, v60
  v_add_f32 v61, 1.0, v61
  v_add_f32 v62, 1.0, v62
  v_add_f32 v63, 1.0, v63
  v_rcp_f32 v56, v56
  s_waitcnt lgkmcnt(2)
  v_mfma_f32_16x16x32_bf16 v[24:27], v[44:47], v[192:195], v[24:27]
  ds_read_b64_tr_b16 v[44:45], v4 offset:12288
  s_add_u32 m0, s33, 90112
  v_mfma_f32_16x16x32_bf16 v[24:27], v[48:51], v[200:203], v[24:27]
  ds_read_b64_tr_b16 v[46:47], v4 offset:14336
  s_add_u32 s39, s47, 589824
  v_mfma_f32_16x16x32_bf16 v[24:27], v[32:35], v[208:211], v[24:27]
  ds_read_b64_tr_b16 v[48:49], v4 offset:16384
  v_mfma_f32_16x16x32_bf16 v[24:27], v[36:39], v[216:219], v[24:27]
  ds_read_b64_tr_b16 v[50:51], v4 offset:18432
  s_waitcnt vmcnt(6)
  s_barrier
  buffer_load_dwordx4 v8, s[8:11], s39 offen lds
  v_rcp_f32 v57, v57
  v_rcp_f32 v58, v58
  s_mov_b32 exec_lo, 926365495
  s_mov_b32 exec_hi, exec_lo
  buffer_load_dword v55, v53, s[64:67], 0 offen
  s_mov_b64 exec, -1
  v_rcp_f32 v59, v59
  v_rcp_f32 v60, v60
  v_rcp_f32 v61, v61
  s_lshl_b32 s38, s55, 13
  v_lshl_add_u32 v5, v1, 4, s38
  s_waitcnt lgkmcnt(2)
  v_mfma_f32_16x16x32_bf16 v[28:31], v[32:35], v[212:215], v[28:31]
  ds_read_b64_tr_b16 v[32:33], v4 offset:20480
  s_add_u32 m0, s33, 98304
  v_mfma_f32_16x16x32_bf16 v[28:31], v[36:39], v[220:223], v[28:31]
  ds_read_b64_tr_b16 v[34:35], v4 offset:22528
  s_add_u32 s39, s47, 1179648
  v_mfma_f32_16x16x32_bf16 v[28:31], v[40:43], v[228:231], v[28:31]
  ds_read_b64_tr_b16 v[36:37], v2 offset:0
  v_mfma_f32_16x16x32_bf16 v[28:31], v[44:47], v[236:239], v[28:31]
  ds_read_b64_tr_b16 v[38:39], v2 offset:2048
  buffer_load_dwordx4 v8, s[8:11], s39 offen lds
  v_rcp_f32 v62, v62
  v_rcp_f32 v63, v63
  v_mul_f32 v56, v56, v16
  v_mul_f32 v57, v57, v17
  v_mul_f32 v58, v58, v18
  v_mul_f32 v59, v59, v19
  s_waitcnt lgkmcnt(2)
  v_mfma_f32_16x16x32_bf16 v[24:27], v[40:43], v[224:227], v[24:27]
  ds_read_b64_tr_b16 v[40:41], v2 offset:4096
  s_add_u32 m0, s33, 106496
  v_mfma_f32_16x16x32_bf16 v[24:27], v[44:47], v[232:235], v[24:27]
  ds_read_b64_tr_b16 v[42:43], v2 offset:6144
  s_add_u32 s39, s47, 1769472
  v_mfma_f32_16x16x32_bf16 v[24:27], v[48:51], v[240:243], v[24:27]
  ds_read_b64_tr_b16 v[44:45], v2 offset:8192
  v_mfma_f32_16x16x32_bf16 v[24:27], v[32:35], v[248:251], v[24:27]
  ds_read_b64_tr_b16 v[46:47], v2 offset:10240
  buffer_load_dwordx4 v8, s[8:11], s39 offen lds
  v_mul_f32 v60, v60, v20
  v_mul_f32 v61, v61, v21
  v_mul_f32 v62, v62, v22
  v_mul_f32 v63, v63, v23
  v_cvt_pk_bf16_f32 v76, v56, v57
  v_cvt_pk_bf16_f32 v77, v58, v59
  v_cvt_pk_bf16_f32 v80, v60, v61
  v_cvt_pk_bf16_f32 v81, v62, v63
  s_waitcnt lgkmcnt(2)
  v_mfma_f32_16x16x32_bf16 v[28:31], v[48:51], v[244:247], v[28:31]
  ds_read_b64_tr_b16 v[48:49], v2 offset:12288
  s_add_u32 m0, s33, 114688
  v_mfma_f32_16x16x32_bf16 v[28:31], v[32:35], v[252:255], v[28:31]
  ds_read_b64_tr_b16 v[50:51], v2 offset:14336
  s_add_u32 s39, s47, 2359296
  v_mfma_f32_16x16x32_bf16 v[16:19], v[36:39], v[112:115], v[64:67]
  ds_read_b64_tr_b16 v[32:33], v2 offset:16384
  v_mfma_f32_16x16x32_bf16 v[16:19], v[40:43], v[120:123], v[16:19]
  ds_read_b64_tr_b16 v[34:35], v2 offset:18432
  buffer_load_dwordx4 v8, s[8:11], s39 offen lds
  v_mul_f32 v56, v24, v24
  v_mul_f32 v57, v25, v25
  v_mul_f32 v58, v26, v26
  v_mul_f32 v59, v27, v27
  v_mul_f32 v60, v28, v28
  v_mul_f32 v61, v29, v29
  v_mul_f32 v62, v30, v30
  v_mul_f32 v63, v31, v31
  s_waitcnt lgkmcnt(2)
  v_mfma_f32_16x16x32_bf16 v[20:23], v[36:39], v[116:119], v[64:67]
  ds_read_b64_tr_b16 v[36:37], v2 offset:20480
  s_add_u32 m0, s33, 122880
  v_mfma_f32_16x16x32_bf16 v[20:23], v[40:43], v[124:127], v[20:23]
  ds_read_b64_tr_b16 v[38:39], v2 offset:22528
  s_add_u32 s39, s47, 2949120
  v_mfma_f32_16x16x32_bf16 v[20:23], v[44:47], v[132:135], v[20:23]
  ds_read_b64_tr_b16 v[40:41], v2 offset:24576
  v_mfma_f32_16x16x32_bf16 v[20:23], v[48:51], v[140:143], v[20:23]
  ds_read_b64_tr_b16 v[42:43], v2 offset:26624
  s_waitcnt vmcnt(6)
  s_barrier
  buffer_load_dwordx4 v8, s[8:11], s39 offen lds
  v_fma_f32 v56, v56, s34, v7
  v_fma_f32 v57, v57, s34, v7
  v_fma_f32 v58, v58, s34, v7
  v_fma_f32 v59, v59, s34, v7
  v_fma_f32 v60, v60, s34, v7
  v_fma_f32 v61, v61, s34, v7
  v_fma_f32 v62, v62, s34, v7
  v_fma_f32 v63, v63, s34, v7
  v_mul_f32 v56, v56, v24
  s_waitcnt lgkmcnt(2)
  v_mfma_f32_16x16x32_bf16 v[16:19], v[44:47], v[128:131], v[16:19]
  ds_read_b64_tr_b16 v[44:45], v2 offset:28672
  s_add_u32 m0, s33, 131072
  v_mfma_f32_16x16x32_bf16 v[16:19], v[48:51], v[136:139], v[16:19]
  ds_read_b64_tr_b16 v[46:47], v2 offset:30720
  s_add_u32 s39, s47, 3538944
  v_mfma_f32_16x16x32_bf16 v[16:19], v[32:35], v[144:147], v[16:19]
  ds_read_b64_tr_b16 v[48:49], v2 offset:32768
  v_mfma_f32_16x16x32_bf16 v[16:19], v[36:39], v[152:155], v[16:19]
  ds_read_b64_tr_b16 v[50:51], v2 offset:34816
  buffer_load_dwordx4 v8, s[8:11], s39 offen lds
  v_mul_f32 v57, v57, v25
  v_mul_f32 v58, v58, v26
  v_mul_f32 v59, v59, v27
  v_mul_f32 v60, v60, v28
  v_mul_f32 v61, v61, v29
  v_mul_f32 v62, v62, v30
  v_mul_f32 v63, v63, v31
  v_exp_f32 v56, v56
  s_waitcnt lgkmcnt(2)
  v_mfma_f32_16x16x32_bf16 v[20:23], v[32:35], v[148:151], v[20:23]
  ds_read_b64_tr_b16 v[32:33], v2 offset:36864
  s_add_u32 m0, s33, 139264
  v_mfma_f32_16x16x32_bf16 v[20:23], v[36:39], v[156:159], v[20:23]
  ds_read_b64_tr_b16 v[34:35], v2 offset:38912
  s_add_u32 s39, s47, 4128768
  v_mfma_f32_16x16x32_bf16 v[20:23], v[40:43], v[164:167], v[20:23]
  ds_read_b64_tr_b16 v[36:37], v2 offset:40960
  v_mfma_f32_16x16x32_bf16 v[20:23], v[44:47], v[172:175], v[20:23]
  ds_read_b64_tr_b16 v[38:39], v2 offset:43008
  buffer_load_dwordx4 v8, s[8:11], s39 offen lds
  v_exp_f32 v57, v57
  v_exp_f32 v58, v58
  v_exp_f32 v59, v59
  v_exp_f32 v60, v60
  s_waitcnt lgkmcnt(2)
  v_mfma_f32_16x16x32_bf16 v[16:19], v[40:43], v[160:163], v[16:19]
  ds_read_b64_tr_b16 v[40:41], v2 offset:45056
  s_add_u32 m0, s33, 147456
  v_mfma_f32_16x16x32_bf16 v[16:19], v[44:47], v[168:171], v[16:19]
  ds_read_b64_tr_b16 v[42:43], v2 offset:47104
  s_add_u32 s39, s47, 4718592
  v_mfma_f32_16x16x32_bf16 v[16:19], v[48:51], v[176:179], v[16:19]
  ds_read_b64_tr_b16 v[44:45], v2 offset:49152
  ds_read_b128 v[64:67], v10 offset:768
  v_mfma_f32_16x16x32_bf16 v[16:19], v[32:35], v[184:187], v[16:19]
  ds_read_b64_tr_b16 v[46:47], v2 offset:51200
  buffer_load_dwordx4 v8, s[8:11], s39 offen lds
  v_exp_f32 v61, v61
  v_exp_f32 v62, v62
  v_exp_f32 v63, v63
  v_add_f32 v56, 1.0, v56
  v_add_f32 v57, 1.0, v57
  s_waitcnt lgkmcnt(3)
  v_mfma_f32_16x16x32_bf16 v[20:23], v[48:51], v[180:183], v[20:23]
  ds_read_b64_tr_b16 v[48:49], v2 offset:53248
  s_add_u32 m0, s33, 0
  v_mfma_f32_16x16x32_bf16 v[20:23], v[32:35], v[188:191], v[20:23]
  ds_read_b64_tr_b16 v[50:51], v2 offset:55296
  s_add_u32 s39, s48, 0
  v_mfma_f32_16x16x32_bf16 v[20:23], v[36:39], v[196:199], v[20:23]
  ds_read_b64_tr_b16 v[32:33], v2 offset:57344
  v_mfma_f32_16x16x32_bf16 v[20:23], v[40:43], v[204:207], v[20:23]
  ds_read_b64_tr_b16 v[34:35], v2 offset:59392
  buffer_load_dwordx4 v8, s[8:11], s39 offen lds
  v_add_f32 v58, 1.0, v58
  v_add_f32 v59, 1.0, v59
  v_add_f32 v60, 1.0, v60
  v_add_f32 v61, 1.0, v61
  v_add_f32 v62, 1.0, v62
  v_add_f32 v63, 1.0, v63
  v_rcp_f32 v56, v56
  s_waitcnt lgkmcnt(2)
  v_mfma_f32_16x16x32_bf16 v[16:19], v[36:39], v[192:195], v[16:19]
  ds_read_b64_tr_b16 v[36:37], v2 offset:61440
  s_add_u32 m0, s33, 8192
  v_mfma_f32_16x16x32_bf16 v[16:19], v[40:43], v[200:203], v[16:19]
  ds_read_b64_tr_b16 v[38:39], v2 offset:63488
  s_add_u32 s39, s48, 589824
  v_mfma_f32_16x16x32_bf16 v[16:19], v[44:47], v[208:211], v[16:19]
  ds_read_b64_tr_b16 v[40:41], v3 offset:0
  v_mfma_f32_16x16x32_bf16 v[16:19], v[48:51], v[216:219], v[16:19]
  ds_read_b64_tr_b16 v[42:43], v3 offset:2048
  s_waitcnt vmcnt(6)
  s_barrier
  buffer_load_dwordx4 v8, s[8:11], s39 offen lds
  v_rcp_f32 v57, v57
  v_rcp_f32 v58, v58
  s_cmp_eq_u32 s31, s28
  s_cbranch_scc1 parallel_sum__ssm_conv_h3__dense_activation_gelu__prompt_kernel_Z_xt1
parallel_sum__ssm_conv_h3__dense_activation_gelu__prompt_kernel_Z_xt1b:
  v_rcp_f32 v59, v59
  v_rcp_f32 v60, v60
  v_rcp_f32 v61, v61
  s_waitcnt lgkmcnt(2)
  v_mfma_f32_16x16x32_bf16 v[20:23], v[44:47], v[212:215], v[20:23]
  ds_read_b64_tr_b16 v[44:45], v3 offset:4096
  s_add_u32 m0, s33, 16384
  v_mfma_f32_16x16x32_bf16 v[20:23], v[48:51], v[220:223], v[20:23]
  ds_read_b64_tr_b16 v[46:47], v3 offset:6144
  s_add_u32 s39, s48, 1179648
  v_mfma_f32_16x16x32_bf16 v[20:23], v[32:35], v[228:231], v[20:23]
  ds_read_b64_tr_b16 v[48:49], v4 offset:24576
  v_mfma_f32_16x16x32_bf16 v[20:23], v[36:39], v[236:239], v[20:23]
  ds_read_b64_tr_b16 v[50:51], v4 offset:26624
  buffer_load_dwordx4 v8, s[8:11], s39 offen lds
  v_rcp_f32 v62, v62
  v_rcp_f32 v63, v63
  v_mul_f32 v56, v56, v24
  v_mul_f32 v57, v57, v25
  v_mul_f32 v58, v58, v26
  v_mul_f32 v59, v59, v27
  s_waitcnt lgkmcnt(2)
  v_mfma_f32_16x16x32_bf16 v[16:19], v[32:35], v[224:227], v[16:19]
  ds_read_b64_tr_b16 v[32:33], v4 offset:28672
  s_add_u32 m0, s33, 24576
  v_mfma_f32_16x16x32_bf16 v[16:19], v[36:39], v[232:235], v[16:19]
  ds_read_b64_tr_b16 v[34:35], v4 offset:30720
  s_add_u32 s39, s48, 1769472
  v_mfma_f32_16x16x32_bf16 v[16:19], v[40:43], v[240:243], v[16:19]
  ds_read_b64_tr_b16 v[36:37], v3 offset:24576
  v_mfma_f32_16x16x32_bf16 v[16:19], v[44:47], v[248:251], v[16:19]
  ds_read_b64_tr_b16 v[38:39], v3 offset:26624
  buffer_load_dwordx4 v8, s[8:11], s39 offen lds
  v_mul_f32 v60, v60, v28
  v_mul_f32 v61, v61, v29
  v_mul_f32 v62, v62, v30
  v_mul_f32 v63, v63, v31
  v_cvt_pk_bf16_f32 v78, v56, v57
  v_cvt_pk_bf16_f32 v79, v58, v59
  v_cvt_pk_bf16_f32 v82, v60, v61
  v_cvt_pk_bf16_f32 v83, v62, v63
  s_waitcnt lgkmcnt(2)
  v_mfma_f32_16x16x32_bf16 v[20:23], v[40:43], v[244:247], v[20:23]
  ds_read_b64_tr_b16 v[40:41], v3 offset:28672
  s_add_u32 m0, s33, 32768
  v_mfma_f32_16x16x32_bf16 v[20:23], v[44:47], v[252:255], v[20:23]
  ds_read_b64_tr_b16 v[42:43], v3 offset:30720
  s_add_u32 s39, s48, 2359296
  v_mfma_f32_16x16x32_bf16 v[24:27], v[48:51], v[112:115], v[64:67]
  ds_read_b64_tr_b16 v[44:45], v3 offset:32768
  v_mfma_f32_16x16x32_bf16 v[24:27], v[32:35], v[120:123], v[24:27]
  ds_read_b64_tr_b16 v[46:47], v3 offset:34816
  buffer_load_dwordx4 v8, s[8:11], s39 offen lds
  v_mul_f32 v56, v16, v16
  v_mul_f32 v57, v17, v17
  v_mul_f32 v58, v18, v18
  v_mul_f32 v59, v19, v19
  v_mul_f32 v60, v20, v20
  v_mul_f32 v61, v21, v21
  v_mul_f32 v62, v22, v22
  v_mul_f32 v63, v23, v23
  s_waitcnt lgkmcnt(2)
  v_mfma_f32_16x16x32_bf16 v[28:31], v[48:51], v[116:119], v[64:67]
  ds_read_b64_tr_b16 v[48:49], v3 offset:36864
  s_add_u32 m0, s33, 40960
  v_mfma_f32_16x16x32_bf16 v[28:31], v[32:35], v[124:127], v[28:31]
  ds_read_b64_tr_b16 v[50:51], v3 offset:38912
  s_add_u32 s39, s48, 2949120
  v_mfma_f32_16x16x32_bf16 v[28:31], v[36:39], v[132:135], v[28:31]
  ds_read_b64_tr_b16 v[32:33], v3 offset:40960
  v_mfma_f32_16x16x32_bf16 v[28:31], v[40:43], v[140:143], v[28:31]
  ds_read_b64_tr_b16 v[34:35], v3 offset:43008
  s_waitcnt vmcnt(5)
  s_barrier
  buffer_load_dwordx4 v8, s[8:11], s39 offen lds
  v_fma_f32 v56, v56, s34, v7
  v_fma_f32 v57, v57, s34, v7
  v_fma_f32 v58, v58, s34, v7
  v_fma_f32 v59, v59, s34, v7
  v_fma_f32 v60, v60, s34, v7
  v_fma_f32 v61, v61, s34, v7
  v_fma_f32 v62, v62, s34, v7
  v_fma_f32 v63, v63, s34, v7
  v_mul_f32 v56, v56, v16
  s_waitcnt lgkmcnt(2)
  v_mfma_f32_16x16x32_bf16 v[24:27], v[36:39], v[128:131], v[24:27]
  ds_read_b64_tr_b16 v[36:37], v3 offset:45056
  s_add_u32 m0, s33, 49152
  v_mfma_f32_16x16x32_bf16 v[24:27], v[40:43], v[136:139], v[24:27]
  ds_read_b64_tr_b16 v[38:39], v3 offset:47104
  s_add_u32 s39, s48, 3538944
  v_mfma_f32_16x16x32_bf16 v[24:27], v[44:47], v[144:147], v[24:27]
  ds_read_b64_tr_b16 v[40:41], v3 offset:49152
  v_mfma_f32_16x16x32_bf16 v[24:27], v[48:51], v[152:155], v[24:27]
  ds_read_b64_tr_b16 v[42:43], v3 offset:51200
  buffer_load_dwordx4 v8, s[8:11], s39 offen lds
  v_mul_f32 v57, v57, v17
  v_mul_f32 v58, v58, v18
  v_mul_f32 v59, v59, v19
  v_mul_f32 v60, v60, v20
  v_mul_f32 v61, v61, v21
  v_mul_f32 v62, v62, v22
  v_mul_f32 v63, v63, v23
  v_exp_f32 v56, v56
  s_waitcnt lgkmcnt(2)
  v_mfma_f32_16x16x32_bf16 v[28:31], v[44:47], v[148:151], v[28:31]
  ds_read_b64_tr_b16 v[44:45], v3 offset:53248
  s_add_u32 m0, s33, 57344
  v_mfma_f32_16x16x32_bf16 v[28:31], v[48:51], v[156:159], v[28:31]
  ds_read_b64_tr_b16 v[46:47], v3 offset:55296
  s_add_u32 s39, s48, 4128768
  v_mfma_f32_16x16x32_bf16 v[28:31], v[32:35], v[164:167], v[28:31]
  ds_read_b64_tr_b16 v[48:49], v3 offset:57344
  v_mfma_f32_16x16x32_bf16 v[28:31], v[36:39], v[172:175], v[28:31]
  ds_read_b64_tr_b16 v[50:51], v3 offset:59392
  buffer_load_dwordx4 v8, s[8:11], s39 offen lds
  v_exp_f32 v57, v57
  v_exp_f32 v58, v58
  v_exp_f32 v59, v59
  v_exp_f32 v60, v60
  s_waitcnt lgkmcnt(2)
  v_mfma_f32_16x16x32_bf16 v[24:27], v[32:35], v[160:163], v[24:27]
  ds_read_b64_tr_b16 v[32:33], v3 offset:61440
  s_add_u32 m0, s33, 65536
  v_mfma_f32_16x16x32_bf16 v[24:27], v[36:39], v[168:171], v[24:27]
  ds_read_b64_tr_b16 v[34:35], v3 offset:63488
  s_add_u32 s39, s48, 4718592
  v_mfma_f32_16x16x32_bf16 v[24:27], v[40:43], v[176:179], v[24:27]
  ds_read_b64_tr_b16 v[36:37], v4 offset:0
  ds_read_b128 v[64:67], v10 offset:1024
  v_mfma_f32_16x16x32_bf16 v[24:27], v[44:47], v[184:187], v[24:27]
  ds_read_b64_tr_b16 v[38:39], v4 offset:2048
  buffer_load_dwordx4 v8, s[8:11], s39 offen lds
  v_exp_f32 v61, v61
  v_exp_f32 v62, v62
  v_exp_f32 v63, v63
  v_add_f32 v56, 1.0, v56
  v_add_f32 v57, 1.0, v57
  s_waitcnt lgkmcnt(3)
  v_mfma_f32_16x16x32_bf16 v[28:31], v[40:43], v[180:183], v[28:31]
  ds_read_b64_tr_b16 v[40:41], v4 offset:4096
  s_add_u32 m0, s33, 155648
  v_mfma_f32_16x16x32_bf16 v[28:31], v[44:47], v[188:191], v[28:31]
  ds_read_b64_tr_b16 v[42:43], v4 offset:6144
  s_add_u32 s39, s49, 0
  v_mfma_f32_16x16x32_bf16 v[28:31], v[48:51], v[196:199], v[28:31]
  ds_read_b64_tr_b16 v[44:45], v4 offset:8192
  v_mfma_f32_16x16x32_bf16 v[28:31], v[32:35], v[204:207], v[28:31]
  ds_read_b64_tr_b16 v[46:47], v4 offset:10240
  buffer_load_dwordx4 v8, s[8:11], s39 offen lds
  v_add_f32 v58, 1.0, v58
  v_add_f32 v59, 1.0, v59
  v_add_f32 v60, 1.0, v60
  v_add_f32 v61, 1.0, v61
  v_add_f32 v62, 1.0, v62
  v_add_f32 v63, 1.0, v63
  v_rcp_f32 v56, v56
  s_waitcnt lgkmcnt(2)
  v_mfma_f32_16x16x32_bf16 v[24:27], v[48:51], v[192:195], v[24:27]
  ds_read_b64_tr_b16 v[48:49], v4 offset:12288
  s_add_u32 m0, s33, 90112
  v_mfma_f32_16x16x32_bf16 v[24:27], v[32:35], v[200:203], v[24:27]
  ds_read_b64_tr_b16 v[50:51], v4 offset:14336
  s_add_u32 s39, s49, 589824
  v_mfma_f32_16x16x32_bf16 v[24:27], v[36:39], v[208:211], v[24:27]
  ds_read_b64_tr_b16 v[32:33], v4 offset:16384
  v_mfma_f32_16x16x32_bf16 v[24:27], v[40:43], v[216:219], v[24:27]
  ds_read_b64_tr_b16 v[34:35], v4 offset:18432
  s_waitcnt vmcnt(6)
  s_barrier
  buffer_load_dwordx4 v8, s[8:11], s39 offen lds
  v_rcp_f32 v57, v57
  v_rcp_f32 v58, v58
  s_mov_b32 exec_lo, 808464432
  s_mov_b32 exec_hi, exec_lo
  buffer_load_dword v70, v53, s[68:71], 0 offen
  s_mov_b64 exec, -1
  v_rcp_f32 v59, v59
  v_rcp_f32 v60, v60
  v_rcp_f32 v61, v61
  s_waitcnt lgkmcnt(2)
  v_mfma_f32_16x16x32_bf16 v[28:31], v[36:39], v[212:215], v[28:31]
  ds_read_b64_tr_b16 v[36:37], v4 offset:20480
  s_add_u32 m0, s33, 98304
  v_mfma_f32_16x16x32_bf16 v[28:31], v[40:43], v[220:223], v[28:31]
  ds_read_b64_tr_b16 v[38:39], v4 offset:22528
  s_add_u32 s39, s49, 1179648
  v_mfma_f32_16x16x32_bf16 v[28:31], v[44:47], v[228:231], v[28:31]
  ds_read_b64_tr_b16 v[40:41], v2 offset:0
  v_mfma_f32_16x16x32_bf16 v[28:31], v[48:51], v[236:239], v[28:31]
  ds_read_b64_tr_b16 v[42:43], v2 offset:2048
  buffer_load_dwordx4 v8, s[8:11], s39 offen lds
  v_rcp_f32 v62, v62
  v_rcp_f32 v63, v63
  v_mul_f32 v56, v56, v16
  v_mul_f32 v57, v57, v17
  v_mul_f32 v58, v58, v18
  v_mul_f32 v59, v59, v19
  s_waitcnt lgkmcnt(2)
  v_mfma_f32_16x16x32_bf16 v[24:27], v[44:47], v[224:227], v[24:27]
  ds_read_b64_tr_b16 v[44:45], v2 offset:4096
  s_add_u32 m0, s33, 106496
  v_mfma_f32_16x16x32_bf16 v[24:27], v[48:51], v[232:235], v[24:27]
  ds_read_b64_tr_b16 v[46:47], v2 offset:6144
  s_add_u32 s39, s49, 1769472
  v_mfma_f32_16x16x32_bf16 v[24:27], v[32:35], v[240:243], v[24:27]
  ds_read_b64_tr_b16 v[48:49], v2 offset:8192
  v_mfma_f32_16x16x32_bf16 v[24:27], v[36:39], v[248:251], v[24:27]
  ds_read_b64_tr_b16 v[50:51], v2 offset:10240
  buffer_load_dwordx4 v8, s[8:11], s39 offen lds
  v_mul_f32 v60, v60, v20
  v_mul_f32 v61, v61, v21
  v_mul_f32 v62, v62, v22
  v_mul_f32 v63, v63, v23
  v_cvt_pk_bf16_f32 v84, v56, v57
  v_cvt_pk_bf16_f32 v85, v58, v59
  v_cvt_pk_bf16_f32 v88, v60, v61
  v_cvt_pk_bf16_f32 v89, v62, v63
  s_waitcnt lgkmcnt(2)
  v_mfma_f32_16x16x32_bf16 v[28:31], v[32:35], v[244:247], v[28:31]
  ds_read_b64_tr_b16 v[32:33], v2 offset:12288
  s_add_u32 m0, s33, 114688
  v_mfma_f32_16x16x32_bf16 v[28:31], v[36:39], v[252:255], v[28:31]
  ds_read_b64_tr_b16 v[34:35], v2 offset:14336
  s_add_u32 s39, s49, 2359296
  v_mfma_f32_16x16x32_bf16 v[16:19], v[40:43], v[112:115], v[64:67]
  ds_read_b64_tr_b16 v[36:37], v2 offset:16384
  v_mfma_f32_16x16x32_bf16 v[16:19], v[44:47], v[120:123], v[16:19]
  ds_read_b64_tr_b16 v[38:39], v2 offset:18432
  buffer_load_dwordx4 v8, s[8:11], s39 offen lds
  v_mul_f32 v56, v24, v24
  v_mul_f32 v57, v25, v25
  v_mul_f32 v58, v26, v26
  v_mul_f32 v59, v27, v27
  v_mul_f32 v60, v28, v28
  v_mul_f32 v61, v29, v29
  v_mul_f32 v62, v30, v30
  v_mul_f32 v63, v31, v31
  s_waitcnt lgkmcnt(2)
  v_mfma_f32_16x16x32_bf16 v[20:23], v[40:43], v[116:119], v[64:67]
  ds_read_b64_tr_b16 v[40:41], v2 offset:20480
  s_add_u32 m0, s33, 122880
  v_mfma_f32_16x16x32_bf16 v[20:23], v[44:47], v[124:127], v[20:23]
  ds_read_b64_tr_b16 v[42:43], v2 offset:22528
  s_add_u32 s39, s49, 2949120
  v_mfma_f32_16x16x32_bf16 v[20:23], v[48:51], v[132:135], v[20:23]
  ds_read_b64_tr_b16 v[44:45], v2 offset:24576
  v_mfma_f32_16x16x32_bf16 v[20:23], v[32:35], v[140:143], v[20:23]
  ds_read_b64_tr_b16 v[46:47], v2 offset:26624
  s_waitcnt vmcnt(6)
  s_barrier
  buffer_load_dwordx4 v8, s[8:11], s39 offen lds
  v_fma_f32 v56, v56, s34, v7
  v_fma_f32 v57, v57, s34, v7
  v_fma_f32 v58, v58, s34, v7
  v_fma_f32 v59, v59, s34, v7
  v_fma_f32 v60, v60, s34, v7
  v_fma_f32 v61, v61, s34, v7
  v_fma_f32 v62, v62, s34, v7
  v_fma_f32 v63, v63, s34, v7
  v_mul_f32 v56, v56, v24
  s_waitcnt lgkmcnt(2)
  v_mfma_f32_16x16x32_bf16 v[16:19], v[48:51], v[128:131], v[16:19]
  ds_read_b64_tr_b16 v[48:49], v2 offset:28672
  s_add_u32 m0, s33, 131072
  v_mfma_f32_16x16x32_bf16 v[16:19], v[32:35], v[136:139], v[16:19]
  ds_read_b64_tr_b16 v[50:51], v2 offset:30720
  s_add_u32 s39, s49, 3538944
  v_mfma_f32_16x16x32_bf16 v[16:19], v[36:39], v[144:147], v[16:19]
  ds_read_b64_tr_b16 v[32:33], v2 offset:32768
  v_mfma_f32_16x16x32_bf16 v[16:19], v[40:43], v[152:155], v[16:19]
  ds_read_b64_tr_b16 v[34:35], v2 offset:34816
  buffer_load_dwordx4 v8, s[8:11], s39 offen lds
  v_mul_f32 v57, v57, v25
  v_mul_f32 v58, v58, v26
  v_mul_f32 v59, v59, v27
  v_mul_f32 v60, v60, v28
  v_mul_f32 v61, v61, v29
  v_mul_f32 v62, v62, v30
  v_mul_f32 v63, v63, v31
  v_exp_f32 v56, v56
  s_waitcnt lgkmcnt(2)
  v_mfma_f32_16x16x32_bf16 v[20:23], v[36:39], v[148:151], v[20:23]
  ds_read_b64_tr_b16 v[36:37], v2 offset:36864
  s_add_u32 m0, s33, 139264
  v_mfma_f32_16x16x32_bf16 v[20:23], v[40:43], v[156:159], v[20:23]
  ds_read_b64_tr_b16 v[38:39], v2 offset:38912
  s_add_u32 s39, s49, 4128768
  v_mfma_f32_16x16x32_bf16 v[20:23], v[44:47], v[164:167], v[20:23]
  ds_read_b64_tr_b16 v[40:41], v2 offset:40960
  v_mfma_f32_16x16x32_bf16 v[20:23], v[48:51], v[172:175], v[20:23]
  ds_read_b64_tr_b16 v[42:43], v2 offset:43008
  buffer_load_dwordx4 v8, s[8:11], s39 offen lds
  v_exp_f32 v57, v57
  v_exp_f32 v58, v58
  v_exp_f32 v59, v59
  v_exp_f32 v60, v60
  s_waitcnt lgkmcnt(2)
  v_mfma_f32_16x16x32_bf16 v[16:19], v[44:47], v[160:163], v[16:19]
  ds_read_b64_tr_b16 v[44:45], v2 offset:45056
  s_add_u32 m0, s33, 147456
  v_mfma_f32_16x16x32_bf16 v[16:19], v[48:51], v[168:171], v[16:19]
  ds_read_b64_tr_b16 v[46:47], v2 offset:47104
  s_add_u32 s39, s49, 4718592
  v_mfma_f32_16x16x32_bf16 v[16:19], v[32:35], v[176:179], v[16:19]
  ds_read_b64_tr_b16 v[48:49], v2 offset:49152
  ds_read_b128 v[64:67], v10 offset:1280
  v_mfma_f32_16x16x32_bf16 v[16:19], v[36:39], v[184:187], v[16:19]
  ds_read_b64_tr_b16 v[50:51], v2 offset:51200
  buffer_load_dwordx4 v8, s[8:11], s39 offen lds
  v_exp_f32 v61, v61
  v_exp_f32 v62, v62
  v_exp_f32 v63, v63
  v_add_f32 v56, 1.0, v56
  v_add_f32 v57, 1.0, v57
  s_waitcnt lgkmcnt(3)
  v_mfma_f32_16x16x32_bf16 v[20:23], v[32:35], v[180:183], v[20:23]
  ds_read_b64_tr_b16 v[32:33], v2 offset:53248
  s_add_u32 m0, s33, 0
  v_mfma_f32_16x16x32_bf16 v[20:23], v[36:39], v[188:191], v[20:23]
  ds_read_b64_tr_b16 v[34:35], v2 offset:55296
  s_add_u32 s39, s50, 0
  v_mfma_f32_16x16x32_bf16 v[20:23], v[40:43], v[196:199], v[20:23]
  ds_read_b64_tr_b16 v[36:37], v2 offset:57344
  v_mfma_f32_16x16x32_bf16 v[20:23], v[44:47], v[204:207], v[20:23]
  ds_read_b64_tr_b16 v[38:39], v2 offset:59392
  buffer_load_dwordx4 v8, s[8:11], s39 offen lds
  v_add_f32 v58, 1.0, v58
  v_add_f32 v59, 1.0, v59
  v_add_f32 v60, 1.0, v60
  v_add_f32 v61, 1.0, v61
  v_add_f32 v62, 1.0, v62
  v_add_f32 v63, 1.0, v63
  v_rcp_f32 v56, v56
  s_waitcnt lgkmcnt(2)
  v_mfma_f32_16x16x32_bf16 v[16:19], v[40:43], v[192:195], v[16:19]
  ds_read_b64_tr_b16 v[40:41], v2 offset:61440
  s_add_u32 m0, s33, 8192
  v_mfma_f32_16x16x32_bf16 v[16:19], v[44:47], v[200:203], v[16:19]
  ds_read_b64_tr_b16 v[42:43], v2 offset:63488
  s_add_u32 s39, s50, 589824
  v_mfma_f32_16x16x32_bf16 v[16:19], v[48:51], v[208:211], v[16:19]
  ds_read_b64_tr_b16 v[44:45], v3 offset:0
  v_mfma_f32_16x16x32_bf16 v[16:19], v[32:35], v[216:219], v[16:19]
  ds_read_b64_tr_b16 v[46:47], v3 offset:2048
  s_waitcnt vmcnt(6)
  s_barrier
  buffer_load_dwordx4 v8, s[8:11], s39 offen lds
  v_rcp_f32 v57, v57
  v_rcp_f32 v58, v58
  s_cmp_eq_u32 s31, s28
  s_cbranch_scc1 parallel_sum__ssm_conv_h3__dense_activation_gelu__prompt_kernel_Z_xt2
parallel_sum__ssm_conv_h3__dense_activation_gelu__prompt_kernel_Z_xt2b:
  v_rcp_f32 v59, v59
  v_rcp_f32 v60, v60
  v_rcp_f32 v61, v61
  s_waitcnt lgkmcnt(2)
  v_mfma_f32_16x16x32_bf16 v[20:23], v[48:51], v[212:215], v[20:23]
  ds_read_b64_tr_b16 v[48:49], v3 offset:4096
  s_add_u32 m0, s33, 16384
  v_mfma_f32_16x16x32_bf16 v[20:23], v[32:35], v[220:223], v[20:23]
  ds_read_b64_tr_b16 v[50:51], v3 offset:6144
  s_add_u32 s39, s50, 1179648
  v_mfma_f32_16x16x32_bf16 v[20:23], v[36:39], v[228:231], v[20:23]
  ds_read_b64_tr_b16 v[32:33], v4 offset:24576
  v_mfma_f32_16x16x32_bf16 v[20:23], v[40:43], v[236:239], v[20:23]
  ds_read_b64_tr_b16 v[34:35], v4 offset:26624
  buffer_load_dwordx4 v8, s[8:11], s39 offen lds
  v_rcp_f32 v62, v62
  v_rcp_f32 v63, v63
  v_mul_f32 v56, v56, v24
  v_mul_f32 v57, v57, v25
  v_mul_f32 v58, v58, v26
  v_mul_f32 v59, v59, v27
  s_waitcnt lgkmcnt(2)
  v_mfma_f32_16x16x32_bf16 v[16:19], v[36:39], v[224:227], v[16:19]
  ds_read_b64_tr_b16 v[36:37], v4 offset:28672
  s_add_u32 m0, s33, 24576
  v_mfma_f32_16x16x32_bf16 v[16:19], v[40:43], v[232:235], v[16:19]
  ds_read_b64_tr_b16 v[38:39], v4 offset:30720
  s_add_u32 s39, s50, 1769472
  v_mfma_f32_16x16x32_bf16 v[16:19], v[44:47], v[240:243], v[16:19]
  ds_read_b64_tr_b16 v[40:41], v3 offset:24576
  v_mfma_f32_16x16x32_bf16 v[16:19], v[48:51], v[248:251], v[16:19]
  ds_read_b64_tr_b16 v[42:43], v3 offset:26624
  buffer_load_dwordx4 v8, s[8:11], s39 offen lds
  v_mul_f32 v60, v60, v28
  v_mul_f32 v61, v61, v29
  v_mul_f32 v62, v62, v30
  v_mul_f32 v63, v63, v31
  v_cvt_pk_bf16_f32 v86, v56, v57
  v_cvt_pk_bf16_f32 v87, v58, v59
  v_cvt_pk_bf16_f32 v90, v60, v61
  v_cvt_pk_bf16_f32 v91, v62, v63
  s_waitcnt lgkmcnt(2)
  v_mfma_f32_16x16x32_bf16 v[20:23], v[44:47], v[244:247], v[20:23]
  ds_read_b64_tr_b16 v[44:45], v3 offset:28672
  s_add_u32 m0, s33, 32768
  v_mfma_f32_16x16x32_bf16 v[20:23], v[48:51], v[252:255], v[20:23]
  ds_read_b64_tr_b16 v[46:47], v3 offset:30720
  s_add_u32 s39, s50, 2359296
  v_mfma_f32_16x16x32_bf16 v[24:27], v[32:35], v[112:115], v[64:67]
  ds_read_b64_tr_b16 v[48:49], v3 offset:32768
  v_mfma_f32_16x16x32_bf16 v[24:27], v[36:39], v[120:123], v[24:27]
  ds_read_b64_tr_b16 v[50:51], v3 offset:34816
  buffer_load_dwordx4 v8, s[8:11], s39 offen lds
  v_mul_f32 v56, v16, v16
  v_mul_f32 v57, v17, v17
  v_mul_f32 v58, v18, v18
  v_mul_f32 v59, v19, v19
  v_mul_f32 v60, v20, v20
  v_mul_f32 v61, v21, v21
  v_mul_f32 v62, v22, v22
  v_mul_f32 v63, v23, v23
  s_waitcnt lgkmcnt(2)
  v_mfma_f32_16x16x32_bf16 v[28:31], v[32:35], v[116:119], v[64:67]
  ds_read_b64_tr_b16 v[32:33], v3 offset:36864
  s_add_u32 m0, s33, 40960
  v_mfma_f32_16x16x32_bf16 v[28:31], v[36:39], v[124:127], v[28:31]
  ds_read_b64_tr_b16 v[34:35], v3 offset:38912
  s_add_u32 s39, s50, 2949120
  v_mfma_f32_16x16x32_bf16 v[28:31], v[40:43], v[132:135], v[28:31]
  ds_read_b64_tr_b16 v[36:37], v3 offset:40960
  v_mfma_f32_16x16x32_bf16 v[28:31], v[44:47], v[140:143], v[28:31]
  ds_read_b64_tr_b16 v[38:39], v3 offset:43008
  s_waitcnt vmcnt(5)
  s_barrier
  buffer_load_dwordx4 v8, s[8:11], s39 offen lds
  v_fma_f32 v56, v56, s34, v7
  v_fma_f32 v57, v57, s34, v7
  v_fma_f32 v58, v58, s34, v7
  v_fma_f32 v59, v59, s34, v7
  v_fma_f32 v60, v60, s34, v7
  v_fma_f32 v61, v61, s34, v7
  v_fma_f32 v62, v62, s34, v7
  v_fma_f32 v63, v63, s34, v7
  v_mul_f32 v56, v56, v16
  s_waitcnt lgkmcnt(2)
  v_mfma_f32_16x16x32_bf16 v[24:27], v[40:43], v[128:131], v[24:27]
  ds_read_b64_tr_b16 v[40:41], v3 offset:45056
  s_add_u32 m0, s33, 49152
  v_mfma_f32_16x16x32_bf16 v[24:27], v[44:47], v[136:139], v[24:27]
  ds_read_b64_tr_b16 v[42:43], v3 offset:47104
  s_add_u32 s39, s50, 3538944
  v_mfma_f32_16x16x32_bf16 v[24:27], v[48:51], v[144:147], v[24:27]
  ds_read_b64_tr_b16 v[44:45], v3 offset:49152
  v_mfma_f32_16x16x32_bf16 v[24:27], v[32:35], v[152:155], v[24:27]
  ds_read_b64_tr_b16 v[46:47], v3 offset:51200
  buffer_load_dwordx4 v8, s[8:11], s39 offen lds
  v_mul_f32 v57, v57, v17
  v_mul_f32 v58, v58, v18
  v_mul_f32 v59, v59, v19
  v_mul_f32 v60, v60, v20
  v_mul_f32 v61, v61, v21
  v_mul_f32 v62, v62, v22
  v_mul_f32 v63, v63, v23
  v_exp_f32 v56, v56
  s_waitcnt lgkmcnt(2)
  v_mfma_f32_16x16x32_bf16 v[28:31], v[48:51], v[148:151], v[28:31]
  ds_read_b64_tr_b16 v[48:49], v3 offset:53248
  s_add_u32 m0, s33, 57344
  v_mfma_f32_16x16x32_bf16 v[28:31], v[32:35], v[156:159], v[28:31]
  ds_read_b64_tr_b16 v[50:51], v3 offset:55296
  s_add_u32 s39, s50, 4128768
  v_mfma_f32_16x16x32_bf16 v[28:31], v[36:39], v[164:167], v[28:31]
  ds_read_b64_tr_b16 v[32:33], v3 offset:57344
  v_mfma_f32_16x16x32_bf16 v[28:31], v[40:43], v[172:175], v[28:31]
  ds_read_b64_tr_b16 v[34:35], v3 offset:59392
  buffer_load_dwordx4 v8, s[8:11], s39 offen lds
  v_exp_f32 v57, v57
  v_exp_f32 v58, v58
  v_exp_f32 v59, v59
  v_exp_f32 v60, v60
  s_waitcnt lgkmcnt(2)
  v_mfma_f32_16x16x32_bf16 v[24:27], v[36:39], v[160:163], v[24:27]
  ds_read_b64_tr_b16 v[36:37], v3 offset:61440
  s_add_u32 m0, s33, 65536
  v_mfma_f32_16x16x32_bf16 v[24:27], v[40:43], v[168:171], v[24:27]
  ds_read_b64_tr_b16 v[38:39], v3 offset:63488
  s_add_u32 s39, s50, 4718592
  v_mfma_f32_16x16x32_bf16 v[24:27], v[44:47], v[176:179], v[24:27]
  ds_read_b64_tr_b16 v[40:41], v4 offset:0
  ds_read_b128 v[64:67], v10 offset:1536
  v_mfma_f32_16x16x32_bf16 v[24:27], v[48:51], v[184:187], v[24:27]
  ds_read_b64_tr_b16 v[42:43], v4 offset:2048
  buffer_load_dwordx4 v8, s[8:11], s39 offen lds
  v_exp_f32 v61, v61
  v_exp_f32 v62, v62
  v_exp_f32 v63, v63
  v_add_f32 v56, 1.0, v56
  v_add_f32 v57, 1.0, v57
  s_waitcnt lgkmcnt(3)
  v_mfma_f32_16x16x32_bf16 v[28:31], v[44:47], v[180:183], v[28:31]
  ds_read_b64_tr_b16 v[44:45], v4 offset:4096
  s_add_u32 m0, s33, 90112
  v_mfma_f32_16x16x32_bf16 v[28:31], v[48:51], v[188:191], v[28:31]
  ds_read_b64_tr_b16 v[46:47], v4 offset:6144
  s_add_u32 s39, s51, 0
  v_mfma_f32_16x16x32_bf16 v[28:31], v[32:35], v[196:199], v[28:31]
  ds_read_b64_tr_b16 v[48:49], v4 offset:8192
  v_mfma_f32_16x16x32_bf16 v[28:31], v[36:39], v[204:207], v[28:31]
  ds_read_b64_tr_b16 v[50:51], v4 offset:10240
  buffer_load_dwordx4 v8, s[8:11], s39 offen lds
  v_add_f32 v58, 1.0, v58
  v_add_f32 v59, 1.0, v59
  v_add_f32 v60, 1.0, v60
  v_add_f32 v61, 1.0, v61
  v_add_f32 v62, 1.0, v62
  v_add_f32 v63, 1.0, v63
  v_rcp_f32 v56, v56
  s_waitcnt lgkmcnt(2)
  v_mfma_f32_16x16x32_bf16 v[24:27], v[32:35], v[192:195], v[24:27]
  ds_read_b64_tr_b16 v[32:33], v4 offset:12288
  s_add_u32 m0, s33, 98304
  v_mfma_f32_16x16x32_bf16 v[24:27], v[36:39], v[200:203], v[24:27]
  ds_read_b64_tr_b16 v[34:35], v4 offset:14336
  s_add_u32 s39, s51, 589824
  v_mfma_f32_16x16x32_bf16 v[24:27], v[40:43], v[208:211], v[24:27]
  ds_read_b64_tr_b16 v[36:37], v4 offset:16384
  v_mfma_f32_16x16x32_bf16 v[24:27], v[44:47], v[216:219], v[24:27]
  ds_read_b64_tr_b16 v[38:39], v4 offset:18432
  s_waitcnt vmcnt(6)
  s_barrier
  buffer_load_dwordx4 v8, s[8:11], s39 offen lds
  v_rcp_f32 v57, v57
  v_rcp_f32 v58, v58
  v_rcp_f32 v59, v59
  v_rcp_f32 v60, v60
  v_rcp_f32 v61, v61
  s_waitcnt lgkmcnt(2)
  v_mfma_f32_16x16x32_bf16 v[28:31], v[40:43], v[212:215], v[28:31]
  ds_read_b64_tr_b16 v[40:41], v4 offset:20480
  s_add_u32 m0, s33, 106496
  v_mfma_f32_16x16x32_bf16 v[28:31], v[44:47], v[220:223], v[28:31]
  ds_read_b64_tr_b16 v[42:43], v4 offset:22528
  s_add_u32 s39, s51, 1179648
  v_mfma_f32_16x16x32_bf16 v[28:31], v[48:51], v[228:231], v[28:31]
  ds_read_b64_tr_b16 v[44:45], v2 offset:0
  v_mfma_f32_16x16x32_bf16 v[28:31], v[32:35], v[236:239], v[28:31]
  ds_read_b64_tr_b16 v[46:47], v2 offset:2048
  buffer_load_dwordx4 v8, s[8:11], s39 offen lds
  v_rcp_f32 v62, v62
  v_rcp_f32 v63, v63
  v_mul_f32 v56, v56, v16
  v_mul_f32 v57, v57, v17
  v_mul_f32 v58, v58, v18
  v_mul_f32 v59, v59, v19
  s_waitcnt lgkmcnt(2)
  v_mfma_f32_16x16x32_bf16 v[24:27], v[48:51], v[224:227], v[24:27]
  ds_read_b64_tr_b16 v[48:49], v2 offset:4096
  s_add_u32 m0, s33, 114688
  v_mfma_f32_16x16x32_bf16 v[24:27], v[32:35], v[232:235], v[24:27]
  ds_read_b64_tr_b16 v[50:51], v2 offset:6144
  s_add_u32 s39, s51, 1769472
  v_mfma_f32_16x16x32_bf16 v[24:27], v[36:39], v[240:243], v[24:27]
  ds_read_b64_tr_b16 v[32:33], v2 offset:8192
  v_mfma_f32_16x16x32_bf16 v[24:27], v[40:43], v[248:251], v[24:27]
  ds_read_b64_tr_b16 v[34:35], v2 offset:10240
  buffer_load_dwordx4 v8, s[8:11], s39 offen lds
  v_mul_f32 v60, v60, v20
  v_mul_f32 v61, v61, v21
  v_mul_f32 v62, v62, v22
  v_mul_f32 v63, v63, v23
  v_cvt_pk_bf16_f32 v92, v56, v57
  v_cvt_pk_bf16_f32 v93, v58, v59
  v_cvt_pk_bf16_f32 v96, v60, v61
  v_cvt_pk_bf16_f32 v97, v62, v63
  s_waitcnt lgkmcnt(2)
  v_mfma_f32_16x16x32_bf16 v[28:31], v[36:39], v[244:247], v[28:31]
  ds_read_b64_tr_b16 v[36:37], v2 offset:12288
  s_add_u32 m0, s33, 122880
  v_mfma_f32_16x16x32_bf16 v[28:31], v[40:43], v[252:255], v[28:31]
  ds_read_b64_tr_b16 v[38:39], v2 offset:14336
  s_add_u32 s39, s51, 2359296
  v_mfma_f32_16x16x32_bf16 v[16:19], v[44:47], v[112:115], v[64:67]
  ds_read_b64_tr_b16 v[40:41], v2 offset:16384
  v_mfma_f32_16x16x32_bf16 v[16:19], v[48:51], v[120:123], v[16:19]
  ds_read_b64_tr_b16 v[42:43], v2 offset:18432
  buffer_load_dwordx4 v8, s[8:11], s39 offen lds
  v_mul_f32 v56, v24, v24
  v_mul_f32 v57, v25, v25
  v_mul_f32 v58, v26, v26
  v_mul_f32 v59, v27, v27
  v_mul_f32 v60, v28, v28
  v_mul_f32 v61, v29, v29
  v_mul_f32 v62, v30, v30
  v_mul_f32 v63, v31, v31
  s_waitcnt lgkmcnt(2)
  v_mfma_f32_16x16x32_bf16 v[20:23], v[44:47], v[116:119], v[64:67]
  ds_read_b64_tr_b16 v[44:45], v2 offset:20480
  s_add_u32 m0, s33, 131072
  v_mfma_f32_16x16x32_bf16 v[20:23], v[48:51], v[124:127], v[20:23]
  ds_read_b64_tr_b16 v[46:47], v2 offset:22528
  s_add_u32 s39, s51, 2949120
  v_mfma_f32_16x16x32_bf16 v[20:23], v[32:35], v[132:135], v[20:23]
  ds_read_b64_tr_b16 v[48:49], v2 offset:24576
  v_mfma_f32_16x16x32_bf16 v[20:23], v[36:39], v[140:143], v[20:23]
  ds_read_b64_tr_b16 v[50:51], v2 offset:26624
  s_waitcnt vmcnt(5)
  s_barrier
  buffer_load_dwordx4 v8, s[8:11], s39 offen lds
  v_fma_f32 v56, v56, s34, v7
  v_fma_f32 v57, v57, s34, v7
  v_fma_f32 v58, v58, s34, v7
  v_fma_f32 v59, v59, s34, v7
  v_fma_f32 v60, v60, s34, v7
  v_fma_f32 v61, v61, s34, v7
  v_fma_f32 v62, v62, s34, v7
  v_fma_f32 v63, v63, s34, v7
  v_mul_f32 v56, v56, v24
  s_waitcnt lgkmcnt(2)
  v_mfma_f32_16x16x32_bf16 v[16:19], v[32:35], v[128:131], v[16:19]
  ds_read_b64_tr_b16 v[32:33], v2 offset:28672
  s_add_u32 m0, s33, 139264
  v_mfma_f32_16x16x32_bf16 v[16:19], v[36:39], v[136:139], v[16:19]
  ds_read_b64_tr_b16 v[34:35], v2 offset:30720
  s_add_u32 s39, s51, 3538944
  v_mfma_f32_16x16x32_bf16 v[16:19], v[40:43], v[144:147], v[16:19]
  ds_read_b64_tr_b16 v[36:37], v2 offset:32768
  v_mfma_f32_16x16x32_bf16 v[16:19], v[44:47], v[152:155], v[16:19]
  ds_read_b64_tr_b16 v[38:39], v2 offset:34816
  buffer_load_dwordx4 v8, s[8:11], s39 offen lds
  v_mul_f32 v57, v57, v25
  v_mul_f32 v58, v58, v26
  v_mul_f32 v59, v59, v27
  v_mul_f32 v60, v60, v28
  v_mul_f32 v61, v61, v29
  v_mul_f32 v62, v62, v30
  v_mul_f32 v63, v63, v31
  v_exp_f32 v56, v56
  s_waitcnt lgkmcnt(2)
  v_mfma_f32_16x16x32_bf16 v[20:23], v[40:43], v[148:151], v[20:23]
  ds_read_b64_tr_b16 v[40:41], v2 offset:36864
  s_add_u32 m0, s33, 147456
  v_mfma_f32_16x16x32_bf16 v[20:23], v[44:47], v[156:159], v[20:23]
  ds_read_b64_tr_b16 v[42:43], v2 offset:38912
  s_add_u32 s39, s51, 4128768
  v_mfma_f32_16x16x32_bf16 v[20:23], v[48:51], v[164:167], v[20:23]
  ds_read_b64_tr_b16 v[44:45], v2 offset:40960
  v_mfma_f32_16x16x32_bf16 v[20:23], v[32:35], v[172:175], v[20:23]
  ds_read_b64_tr_b16 v[46:47], v2 offset:43008
  buffer_load_dwordx4 v8, s[8:11], s39 offen lds
  v_exp_f32 v57, v57
  v_exp_f32 v58, v58
  v_exp_f32 v59, v59
  v_exp_f32 v60, v60
  s_waitcnt lgkmcnt(2)
  v_mfma_f32_16x16x32_bf16 v[16:19], v[48:51], v[160:163], v[16:19]
  ds_read_b64_tr_b16 v[48:49], v2 offset:45056
  s_add_u32 m0, s33, 155648
  v_mfma_f32_16x16x32_bf16 v[16:19], v[32:35], v[168:171], v[16:19]
  ds_read_b64_tr_b16 v[50:51], v2 offset:47104
  s_add_u32 s39, s51, 4718592
  v_mfma_f32_16x16x32_bf16 v[16:19], v[36:39], v[176:179], v[16:19]
  ds_read_b64_tr_b16 v[32:33], v2 offset:49152
  ds_read_b128 v[64:67], v10 offset:1792
  v_mfma_f32_16x16x32_bf16 v[16:19], v[40:43], v[184:187], v[16:19]
  ds_read_b64_tr_b16 v[34:35], v2 offset:51200
  buffer_load_dwordx4 v8, s[8:11], s39 offen lds
  v_exp_f32 v61, v61
  v_exp_f32 v62, v62
  v_exp_f32 v63, v63
  v_add_f32 v56, 1.0, v56
  v_add_f32 v57, 1.0, v57
  s_waitcnt lgkmcnt(3)
  v_mfma_f32_16x16x32_bf16 v[20:23], v[36:39], v[180:183], v[20:23]
  ds_read_b64_tr_b16 v[36:37], v2 offset:53248
  s_add_u32 m0, s33, 0
  v_mfma_f32_16x16x32_bf16 v[20:23], v[40:43], v[188:191], v[20:23]
  ds_read_b64_tr_b16 v[38:39], v2 offset:55296
  s_add_u32 s39, s52, 0
  v_mfma_f32_16x16x32_bf16 v[20:23], v[44:47], v[196:199], v[20:23]
  ds_read_b64_tr_b16 v[40:41], v2 offset:57344
  v_mfma_f32_16x16x32_bf16 v[20:23], v[48:51], v[204:207], v[20:23]
  ds_read_b64_tr_b16 v[42:43], v2 offset:59392
  buffer_load_dwordx4 v8, s[8:11], s39 offen lds
  v_add_f32 v58, 1.0, v58
  v_add_f32 v59, 1.0, v59
  v_add_f32 v60, 1.0, v60
  v_add_f32 v61, 1.0, v61
  v_add_f32 v62, 1.0, v62
  v_add_f32 v63, 1.0, v63
  v_rcp_f32 v56, v56
  s_waitcnt lgkmcnt(2)
  v_mfma_f32_16x16x32_bf16 v[16:19], v[44:47], v[192:195], v[16:19]
  ds_read_b64_tr_b16 v[44:45], v2 offset:61440
  s_add_u32 m0, s33, 8192
  v_mfma_f32_16x16x32_bf16 v[16:19], v[48:51], v[200:203], v[16:19]
  ds_read_b64_tr_b16 v[46:47], v2 offset:63488
  s_add_u32 s39, s52, 589824
  v_mfma_f32_16x16x32_bf16 v[16:19], v[32:35], v[208:211], v[16:19]
  ds_read_b64_tr_b16 v[48:49], v3 offset:0
  v_mfma_f32_16x16x32_bf16 v[16:19], v[36:39], v[216:219], v[16:19]
  ds_read_b64_tr_b16 v[50:51], v3 offset:2048
  s_waitcnt vmcnt(6)
  s_barrier
  buffer_load_dwordx4 v8, s[8:11], s39 offen lds
  v_rcp_f32 v57, v57
  v_rcp_f32 v58, v58
  v_rcp_f32 v59, v59
  v_rcp_f32 v60, v60
  v_rcp_f32 v61, v61
  s_waitcnt lgkmcnt(2)
  v_mfma_f32_16x16x32_bf16 v[20:23], v[32:35], v[212:215], v[20:23]
  ds_read_b64_tr_b16 v[32:33], v3 offset:4096
  s_add_u32 m0, s33, 16384
  v_mfma_f32_16x16x32_bf16 v[20:23], v[36:39], v[220:223], v[20:23]
  ds_read_b64_tr_b16 v[34:35], v3 offset:6144
  s_add_u32 s39, s52, 1179648
  v_mfma_f32_16x16x32_bf16 v[20:23], v[40:43], v[228:231], v[20:23]
  ds_read_b64_tr_b16 v[36:37], v3 offset:24576
  v_mfma_f32_16x16x32_bf16 v[20:23], v[44:47], v[236:239], v[20:23]
  ds_read_b64_tr_b16 v[38:39], v3 offset:26624
  buffer_load_dwordx4 v8, s[8:11], s39 offen lds
  v_rcp_f32 v62, v62
  v_rcp_f32 v63, v63
  v_mul_f32 v56, v56, v24
  v_mul_f32 v57, v57, v25
  v_mul_f32 v58, v58, v26
  v_mul_f32 v59, v59, v27
  s_waitcnt lgkmcnt(2)
  v_mfma_f32_16x16x32_bf16 v[16:19], v[40:43], v[224:227], v[16:19]
  ds_read_b64_tr_b16 v[40:41], v3 offset:28672
  s_add_u32 m0, s33, 24576
  v_mfma_f32_16x16x32_bf16 v[16:19], v[44:47], v[232:235], v[16:19]
  ds_read_b64_tr_b16 v[42:43], v3 offset:30720
  s_add_u32 s39, s52, 1769472
  v_mfma_f32_16x16x32_bf16 v[16:19], v[48:51], v[240:243], v[16:19]
  ds_read_b64_tr_b16 v[44:45], v3 offset:32768
  v_mfma_f32_16x16x32_bf16 v[16:19], v[32:35], v[248:251], v[16:19]
  ds_read_b64_tr_b16 v[46:47], v3 offset:34816
  buffer_load_dwordx4 v8, s[8:11], s39 offen lds
  v_mul_f32 v60, v60, v28
  v_mul_f32 v61, v61, v29
  v_mul_f32 v62, v62, v30
  v_mul_f32 v63, v63, v31
  v_cvt_pk_bf16_f32 v94, v56, v57
  v_cvt_pk_bf16_f32 v95, v58, v59
  v_cvt_pk_bf16_f32 v98, v60, v61
  v_cvt_pk_bf16_f32 v99, v62, v63
  s_waitcnt lgkmcnt(2)
  v_mfma_f32_16x16x32_bf16 v[20:23], v[48:51], v[244:247], v[20:23]
  ds_read_b64_tr_b16 v[48:49], v3 offset:36864
  s_add_u32 m0, s33, 32768
  v_mfma_f32_16x16x32_bf16 v[20:23], v[32:35], v[252:255], v[20:23]
  ds_read_b64_tr_b16 v[50:51], v3 offset:38912
  s_add_u32 s39, s52, 2359296
  v_mfma_f32_16x16x32_bf16 v[24:27], v[36:39], v[112:115], v[64:67]
  ds_read_b64_tr_b16 v[32:33], v3 offset:40960
  v_mfma_f32_16x16x32_bf16 v[24:27], v[40:43], v[120:123], v[24:27]
  ds_read_b64_tr_b16 v[34:35], v3 offset:43008
  buffer_load_dwordx4 v8, s[8:11], s39 offen lds
  v_mul_f32 v56, v16, v16
  v_mul_f32 v57, v17, v17
  v_mul_f32 v58, v18, v18
  v_mul_f32 v59, v19, v19
  v_mul_f32 v60, v20, v20
  v_mul_f32 v61, v21, v21
  v_mul_f32 v62, v22, v22
  v_mul_f32 v63, v23, v23
  s_waitcnt lgkmcnt(2)
  v_mfma_f32_16x16x32_bf16 v[28:31], v[36:39], v[116:119], v[64:67]
  ds_read_b64_tr_b16 v[36:37], v3 offset:45056
  s_add_u32 m0, s33, 40960
  ds_read_b128 v[64:67], v10 offset:2048
  v_mfma_f32_16x16x32_bf16 v[28:31], v[40:43], v[124:127], v[28:31]
  ds_read_b64_tr_b16 v[38:39], v3 offset:47104
  s_add_u32 s39, s52, 2949120
  v_mfma_f32_16x16x32_bf16 v[28:31], v[44:47], v[132:135], v[28:31]
  ds_read_b64_tr_b16 v[40:41], v3 offset:49152
  v_mfma_f32_16x16x32_bf16 v[28:31], v[48:51], v[140:143], v[28:31]
  ds_read_b64_tr_b16 v[42:43], v3 offset:51200
  s_waitcnt vmcnt(5) lgkmcnt(3)
  s_barrier
  buffer_load_dwordx4 v8, s[8:11], s39 offen lds
  v_fma_f32 v56, v56, s34, v7
  v_fma_f32 v57, v57, s34, v7
  s_lshr_b32 s38, s2, 5
  s_cmp_eq_u32 s38, 7
  s_cbranch_scc1 parallel_sum__ssm_conv_h3__dense_activation_gelu__prompt_kernel_Z_u2
parallel_sum__ssm_conv_h3__dense_activation_gelu__prompt_kernel_Z_u2b:
  s_mov_b32 m0, s30
  s_nop 0
  buffer_load_dwordx4 v68, s[64:67], 0 offen lds
  v_fma_f32 v58, v58, s34, v7
  v_fma_f32 v59, v59, s34, v7
  v_fma_f32 v60, v60, s34, v7
  v_fma_f32 v61, v61, s34, v7
  v_fma_f32 v62, v62, s34, v7
  v_fma_f32 v63, v63, s34, v7
  v_mul_f32 v56, v56, v16
  s_waitcnt lgkmcnt(2)
  v_mfma_f32_16x16x32_bf16 v[24:27], v[44:47], v[128:131], v[24:27]
  ds_read_b64_tr_b16 v[44:45], v3 offset:53248
  s_add_u32 m0, s33, 49152
  v_mfma_f32_16x16x32_bf16 v[24:27], v[48:51], v[136:139], v[24:27]
  ds_read_b64_tr_b16 v[46:47], v3 offset:55296
  s_add_u32 s39, s52, 3538944
  v_mfma_f32_16x16x32_bf16 v[24:27], v[32:35], v[144:147], v[24:27]
  ds_read_b64_tr_b16 v[48:49], v3 offset:57344
  v_mfma_f32_16x16x32_bf16 v[24:27], v[36:39], v[152:155], v[24:27]
  ds_read_b64_tr_b16 v[50:51], v3 offset:59392
  buffer_load_dwordx4 v8, s[8:11], s39 offen lds
  v_mul_f32 v57, v57, v17
  v_mul_f32 v58, v58, v18
  s_add_u32 m0, s30, 16384
  s_nop 0
  buffer_load_dwordx4 v68, s[68:71], 0 offen lds
  v_mul_f32 v59, v59, v19
  v_mul_f32 v60, v60, v20
  v_mul_f32 v61, v61, v21
  v_mul_f32 v62, v62, v22
  v_mul_f32 v63, v63, v23
  v_exp_f32 v56, v56
  s_waitcnt lgkmcnt(2)
  v_mfma_f32_16x16x32_bf16 v[28:31], v[32:35], v[148:151], v[28:31]
  ds_read_b64_tr_b16 v[32:33], v3 offset:61440
  s_add_u32 m0, s33, 57344
  v_mfma_f32_16x16x32_bf16 v[28:31], v[36:39], v[156:159], v[28:31]
  ds_read_b64_tr_b16 v[34:35], v3 offset:63488
  s_add_u32 s39, s52, 4128768
  v_mfma_f32_16x16x32_bf16 v[28:31], v[40:43], v[164:167], v[28:31]
  ds_read_b64_tr_b16 v[36:37], v4 offset:0
  v_mfma_f32_16x16x32_bf16 v[28:31], v[44:47], v[172:175], v[28:31]
  ds_read_b64_tr_b16 v[38:39], v4 offset:2048
  buffer_load_dwordx4 v8, s[8:11], s39 offen lds
  v_exp_f32 v57, v57
  v_exp_f32 v58, v58
  s_add_u32 s38, s44, s43
  buffer_load_dword v70, v9, s[12:15], s38 offen
  v_exp_f32 v59, v59
  v_exp_f32 v60, v60
  s_waitcnt lgkmcnt(2)
  v_mfma_f32_16x16x32_bf16 v[24:27], v[40:43], v[160:163], v[24:27]
  ds_read_b64_tr_b16 v[40:41], v4 offset:4096
  s_add_u32 m0, s33, 65536
  v_mfma_f32_16x16x32_bf16 v[24:27], v[44:47], v[168:171], v[24:27]
  ds_read_b64_tr_b16 v[42:43], v4 offset:6144
  s_add_u32 s39, s52, 4718592
  v_mfma_f32_16x16x32_bf16 v[24:27], v[48:51], v[176:179], v[24:27]
  ds_read_b64_tr_b16 v[44:45], v4 offset:8192
  v_mfma_f32_16x16x32_bf16 v[24:27], v[32:35], v[184:187], v[24:27]
  ds_read_b64_tr_b16 v[46:47], v4 offset:10240
  buffer_load_dwordx4 v8, s[8:11], s39 offen lds
  v_exp_f32 v61, v61
  v_exp_f32 v62, v62
  v_exp_f32 v63, v63
  v_add_f32 v56, 1.0, v56
  v_add_f32 v57, 1.0, v57
  s_waitcnt lgkmcnt(2)
  v_mfma_f32_16x16x32_bf16 v[28:31], v[48:51], v[180:183], v[28:31]
  ds_read_b64_tr_b16 v[48:49], v4 offset:12288
  v_mfma_f32_16x16x32_bf16 v[28:31], v[32:35], v[188:191], v[28:31]
  ds_read_b64_tr_b16 v[50:51], v4 offset:14336
  v_mfma_f32_16x16x32_bf16 v[28:31], v[36:39], v[196:199], v[28:31]
  ds_read_b64_tr_b16 v[32:33], v4 offset:16384
  v_mfma_f32_16x16x32_bf16 v[28:31], v[40:43], v[204:207], v[28:31]
  ds_read_b64_tr_b16 v[34:35], v4 offset:18432
  v_add_f32 v58, 1.0, v58
  v_add_f32 v59, 1.0, v59
  v_add_f32 v60, 1.0, v60
  v_add_f32 v61, 1.0, v61
  v_add_f32 v62, 1.0, v62
  v_add_f32 v63, 1.0, v63
  v_rcp_f32 v56, v56
  s_waitcnt lgkmcnt(2)
  v_mfma_f32_16x16x32_bf16 v[24:27], v[36:39], v[192:195], v[24:27]
  ds_read_b64_tr_b16 v[36:37], v4 offset:20480
  s_add_u32 m0, s33, 106496
  v_mfma_f32_16x16x32_bf16 v[24:27], v[40:43], v[200:203], v[24:27]
  ds_read_b64_tr_b16 v[38:39], v4 offset:22528
  s_add_u32 s39, s44, s16
  v_mfma_f32_16x16x32_bf16 v[24:27], v[44:47], v[208:211], v[24:27]
  ds_read_b64_tr_b16 v[40:41], v4 offset:24576
  v_mfma_f32_16x16x32_bf16 v[24:27], v[48:51], v[216:219], v[24:27]
  ds_read_b64_tr_b16 v[42:43], v4 offset:26624
  s_waitcnt vmcnt(8)
  s_barrier
  buffer_load_dwordx4 v9, s[12:15], s39 offen lds
  v_rcp_f32 v57, v57
  v_rcp_f32 v58, v58
  v_rcp_f32 v59, v59
  v_rcp_f32 v60, v60
  v_rcp_f32 v61, v61
  s_waitcnt lgkmcnt(2)
  v_mfma_f32_16x16x32_bf16 v[28:31], v[44:47], v[212:215], v[28:31]
  ds_read_b64_tr_b16 v[44:45], v4 offset:28672
  s_add_u32 m0, s33, 114688
  v_mfma_f32_16x16x32_bf16 v[28:31], v[48:51], v[220:223], v[28:31]
  ds_read_b64_tr_b16 v[46:47], v4 offset:30720
  s_add_u32 s39, s44, s17
  v_mfma_f32_16x16x32_bf16 v[28:31], v[32:35], v[228:231], v[28:31]
  ds_read_b64_tr_b16 v[48:49], v2 offset:0
  v_mfma_f32_16x16x32_bf16 v[28:31], v[36:39], v[236:239], v[28:31]
  ds_read_b64_tr_b16 v[50:51], v2 offset:2048
  buffer_load_dwordx4 v9, s[12:15], s39 offen lds
  v_rcp_f32 v62, v62
  v_rcp_f32 v63, v63
  v_mul_f32 v56, v56, v16
  v_mul_f32 v57, v57, v17
  v_mul_f32 v58, v58, v18
  v_mul_f32 v59, v59, v19
  s_waitcnt lgkmcnt(2)
  v_mfma_f32_16x16x32_bf16 v[24:27], v[32:35], v[224:227], v[24:27]
  ds_read_b64_tr_b16 v[32:33], v2 offset:4096
  s_add_u32 m0, s33, 122880
  v_mfma_f32_16x16x32_bf16 v[24:27], v[36:39], v[232:235], v[24:27]
  ds_read_b64_tr_b16 v[34:35], v2 offset:6144
  s_add_u32 s39, s44, s18
  v_mfma_f32_16x16x32_bf16 v[24:27], v[40:43], v[240:243], v[24:27]
  ds_read_b64_tr_b16 v[36:37], v2 offset:8192
  v_mfma_f32_16x16x32_bf16 v[24:27], v[44:47], v[248:251], v[24:27]
  ds_read_b64_tr_b16 v[38:39], v2 offset:10240
  buffer_load_dwordx4 v9, s[12:15], s39 offen lds
  v_mul_f32 v60, v60, v20
  v_mul_f32 v61, v61, v21
  v_mul_f32 v62, v62, v22
  v_mul_f32 v63, v63, v23
  v_cvt_pk_bf16_f32 v100, v56, v57
  v_cvt_pk_bf16_f32 v101, v58, v59
  v_cvt_pk_bf16_f32 v104, v60, v61
  v_cvt_pk_bf16_f32 v105, v62, v63
  s_waitcnt lgkmcnt(2)
  v_mfma_f32_16x16x32_bf16 v[28:31], v[40:43], v[244:247], v[28:31]
  ds_read_b64_tr_b16 v[40:41], v2 offset:12288
  s_add_u32 m0, s33, 131072
  v_mfma_f32_16x16x32_bf16 v[28:31], v[44:47], v[252:255], v[28:31]
  ds_read_b64_tr_b16 v[42:43], v2 offset:14336
  s_add_u32 s39, s44, s19
  v_mfma_f32_16x16x32_bf16 v[16:19], v[48:51], v[112:115], v[64:67]
  ds_read_b64_tr_b16 v[44:45], v2 offset:16384
  v_mfma_f32_16x16x32_bf16 v[16:19], v[32:35], v[120:123], v[16:19]
  ds_read_b64_tr_b16 v[46:47], v2 offset:18432
  buffer_load_dwordx4 v9, s[12:15], s39 offen lds
  v_mul_f32 v56, v24, v24
  v_mul_f32 v57, v25, v25
  v_mul_f32 v58, v26, v26
  v_mul_f32 v59, v27, v27
  v_mul_f32 v60, v28, v28
  v_mul_f32 v61, v29, v29
  v_mul_f32 v62, v30, v30
  v_mul_f32 v63, v31, v31
  v_fma_f32 v56, v56, s34, v7
  v_fma_f32 v57, v57, s34, v7
  v_fma_f32 v58, v58, s34, v7
  s_waitcnt lgkmcnt(2)
  v_mfma_f32_16x16x32_bf16 v[20:23], v[48:51], v[116:119], v[64:67]
  ds_read_b64_tr_b16 v[48:49], v2 offset:20480
  s_add_u32 m0, s33, 139264
  v_mfma_f32_16x16x32_bf16 v[20:23], v[32:35], v[124:127], v[20:23]
  ds_read_b64_tr_b16 v[50:51], v2 offset:22528
  s_add_u32 s39, s44, s36
  v_mfma_f32_16x16x32_bf16 v[20:23], v[36:39], v[132:135], v[20:23]
  ds_read_b64_tr_b16 v[32:33], v2 offset:24576
  v_mfma_f32_16x16x32_bf16 v[20:23], v[40:43], v[140:143], v[20:23]
  ds_read_b64_tr_b16 v[34:35], v2 offset:26624
  s_waitcnt vmcnt(7)
  s_barrier
  buffer_load_dwordx4 v9, s[12:15], s39 offen lds
  ds_write_b128 v6, v[76:79] offset:0
  ds_write_b128 v6, v[80:83] offset:1024
  v_fma_f32 v59, v59, s34, v7
  v_fma_f32 v60, v60, s34, v7
  v_fma_f32 v61, v61, s34, v7
  v_fma_f32 v62, v62, s34, v7
  v_fma_f32 v63, v63, s34, v7
  v_mul_f32 v56, v56, v24
  v_mul_f32 v57, v57, v25
  v_mul_f32 v58, v58, v26
  v_mul_f32 v59, v59, v27
  v_mul_f32 v60, v60, v28
  v_mul_f32 v61, v61, v29
  s_waitcnt lgkmcnt(4)
  v_mfma_f32_16x16x32_bf16 v[16:19], v[36:39], v[128:131], v[16:19]
  ds_read_b64_tr_b16 v[36:37], v2 offset:28672
  s_add_u32 m0, s33, 147456
  ds_read_b32 v76, v74 offset:17408
  ds_read_b32 v77, v74 offset:17536
  v_mfma_f32_16x16x32_bf16 v[16:19], v[40:43], v[136:139], v[16:19]
  ds_read_b64_tr_b16 v[38:39], v2 offset:30720
  s_add_u32 s39, s44, s37
  ds_read_b32 v78, v74 offset:17664
  ds_read_b32 v79, v74 offset:17792
  v_mfma_f32_16x16x32_bf16 v[16:19], v[44:47], v[144:147], v[16:19]
  ds_read_b64_tr_b16 v[40:41], v2 offset:32768
  ds_read_b32 v80, v74 offset:17920
  ds_read_b32 v81, v74 offset:18048
  v_mfma_f32_16x16x32_bf16 v[16:19], v[48:51], v[152:155], v[16:19]
  ds_read_b64_tr_b16 v[42:43], v2 offset:34816
  ds_read_b32 v82, v74 offset:18176
  ds_read_b32 v83, v74 offset:18304
  buffer_load_dwordx4 v9, s[12:15], s39 offen lds
  v_mul_f32 v62, v62, v30
  v_mul_f32 v63, v63, v31
  v_exp_f32 v56, v56
  v_exp_f32 v57, v57
  v_exp_f32 v58, v58
  v_exp_f32 v59, v59
  s_waitcnt lgkmcnt(8)
  v_mfma_f32_16x16x32_bf16 v[20:23], v[44:47], v[148:151], v[20:23]
  ds_read_b64_tr_b16 v[44:45], v2 offset:36864
  s_add_u32 m0, s33, 155648
  v_mfma_f32_16x16x32_bf16 v[20:23], v[48:51], v[156:159], v[20:23]
  ds_read_b64_tr_b16 v[46:47], v2 offset:38912
  s_add_u32 s39, s44, s41
  v_mfma_f32_16x16x32_bf16 v[20:23], v[32:35], v[164:167], v[20:23]
  ds_read_b64_tr_b16 v[48:49], v2 offset:40960
  v_mfma_f32_16x16x32_bf16 v[20:23], v[36:39], v[172:175], v[20:23]
  ds_read_b64_tr_b16 v[50:51], v2 offset:43008
  s_waitcnt vmcnt(8) lgkmcnt(4)
  s_barrier
  buffer_load_dwordx4 v9, s[12:15], s39 offen lds
  ds_write_b128 v6, v[84:87] offset:16384
  ds_write_b128 v6, v[88:91] offset:17408
  v_exp_f32 v60, v60
  v_exp_f32 v61, v61
  s_mov_b64 exec, 0x7ff
  buffer_load_dword v70, v71, s[84:87], 0 offen
  s_mov_b64 exec, -1
  v_exp_f32 v62, v62
  v_exp_f32 v63, v63
  v_add_f32 v56, 1.0, v56
  v_add_f32 v57, 1.0, v57
  v_add_f32 v58, 1.0, v58
  s_waitcnt lgkmcnt(4)
  v_mfma_f32_16x16x32_bf16 v[16:19], v[32:35], v[160:163], v[16:19]
  ds_read_b64_tr_b16 v[32:33], v2 offset:45056
  s_add_u32 m0, s33, 98304
  ds_read_b128 v[112:115], v5 offset:0
  v_mfma_f32_16x16x32_bf16 v[16:19], v[36:39], v[168:171], v[16:19]
  ds_read_b64_tr_b16 v[34:35], v2 offset:47104
  s_add_u32 s39, s44, s42
  ds_read_b128 v[120:123], v5 offset:2048
  v_mfma_f32_16x16x32_bf16 v[16:19], v[40:43], v[176:179], v[16:19]
  ds_read_b64_tr_b16 v[36:37], v2 offset:49152
  ds_read_b128 v[116:119], v5 offset:1024
  v_mfma_f32_16x16x32_bf16 v[16:19], v[44:47], v[184:187], v[16:19]
  ds_read_b64_tr_b16 v[38:39], v2 offset:51200
  ds_read_b128 v[124:127], v5 offset:3072
  buffer_load_dwordx4 v9, s[12:15], s39 offen lds
  v_add_f32 v59, 1.0, v59
  v_add_f32 v60, 1.0, v60
  buffer_load_dword v8, off, s[88:91], 0 sc1
  v_add_f32 v61, 1.0, v61
  v_add_f32 v62, 1.0, v62
  v_add_f32 v63, 1.0, v63
  v_rcp_f32 v56, v56
  v_rcp_f32 v57, v57
  v_rcp_f32 v58, v58
  s_waitcnt lgkmcnt(5)
  v_mfma_f32_16x16x32_bf16 v[20:23], v[40:43], v[180:183], v[20:23]
  ds_read_b64_tr_b16 v[40:41], v2 offset:53248
  s_add_u32 m0, s33, 90112
  ds_read_b128 v[132:135], v5 offset:5120
  v_mfma_f32_16x16x32_bf16 v[20:23], v[44:47], v[188:191], v[20:23]
  ds_read_b64_tr_b16 v[42:43], v2 offset:55296
  s_add_u32 s39, s44, s43
  ds_read_b128 v[140:143], v5 offset:7168
  v_mfma_f32_16x16x32_bf16 v[20:23], v[48:51], v[196:199], v[20:23]
  ds_read_b64_tr_b16 v[44:45], v2 offset:57344
  ds_read_b128 v[128:131], v5 offset:4096
  v_mfma_f32_16x16x32_bf16 v[20:23], v[32:35], v[204:207], v[20:23]
  ds_read_b64_tr_b16 v[46:47], v2 offset:59392
  ds_read_b128 v[136:139], v5 offset:6144
  s_waitcnt vmcnt(8)
  s_barrier
  buffer_load_dwordx4 v9, s[12:15], s39 offen lds
  ds_write_b128 v6, v[92:95] offset:32768
  ds_write_b128 v6, v[96:99] offset:33792
  v_rcp_f32 v59, v59
  v_rcp_f32 v60, v60
  v_rcp_f32 v61, v61
  v_rcp_f32 v62, v62
  v_rcp_f32 v63, v63
  v_mul_f32 v56, v56, v24
  s_waitcnt lgkmcnt(7)
  v_mfma_f32_16x16x32_bf16 v[16:19], v[48:51], v[192:195], v[16:19]
  ds_read_b64_tr_b16 v[48:49], v2 offset:61440
  ds_read_b128 v[144:147], v5 offset:16384
  ds_read_b32 v84, v69 offset:640
  ds_read_b32 v85, v69 offset:768
  v_mfma_f32_16x16x32_bf16 v[16:19], v[32:35], v[200:203], v[16:19]
  ds_read_b64_tr_b16 v[50:51], v2 offset:63488
  ds_read_b128 v[152:155], v5 offset:18432
  ds_read_b32 v86, v69 offset:896
  v_mfma_f32_16x16x32_bf16 v[16:19], v[36:39], v[208:211], v[16:19]
  ds_read_b64_tr_b16 v[32:33], v3 offset:0
  ds_read_b128 v[148:151], v5 offset:17408
  ds_read_b32 v87, v74 offset:1024
  ds_read_b32 v88, v74 offset:1152
  v_mfma_f32_16x16x32_bf16 v[16:19], v[40:43], v[216:219], v[16:19]
  ds_read_b64_tr_b16 v[34:35], v3 offset:2048
  ds_read_b128 v[156:159], v5 offset:19456
  ds_read_b32 v89, v74 offset:1280
  v_mul_f32 v57, v57, v25
  v_mul_f32 v58, v58, v26
  v_mul_f32 v59, v59, v27
  v_mul_f32 v60, v60, v28
  v_mul_f32 v61, v61, v29
  v_mul_f32 v62, v62, v30
  v_mul_f32 v63, v63, v31
  v_cvt_pk_bf16_f32 v102, v56, v57
  v_cvt_pk_bf16_f32 v103, v58, v59
  v_cvt_pk_bf16_f32 v106, v60, v61
  v_cvt_pk_bf16_f32 v107, v62, v63
  s_waitcnt lgkmcnt(9)
  v_mfma_f32_16x16x32_bf16 v[20:23], v[36:39], v[212:215], v[20:23]
  ds_read_b64_tr_b16 v[36:37], v3 offset:4096
  s_add_u32 m0, s33, 0
  ds_read_b128 v[164:167], v5 offset:21504
  ds_read_b32 v90, v74 offset:1408
  v_mfma_f32_16x16x32_bf16 v[20:23], v[40:43], v[220:223], v[20:23]
  ds_read_b64_tr_b16 v[38:39], v3 offset:6144
  s_add_u32 s39, s45, s16
  ds_read_b128 v[172:175], v5 offset:23552
  ds_read_b32 v91, v74 offset:1536
  ds_read_b32 v92, v74 offset:1664
  v_mfma_f32_16x16x32_bf16 v[20:23], v[44:47], v[228:231], v[20:23]
  ds_read_b64_tr_b16 v[40:41], v3 offset:40960
  ds_read_b128 v[160:163], v5 offset:20480
  ds_read_b32 v93, v74 offset:1792
  v_mfma_f32_16x16x32_bf16 v[20:23], v[48:51], v[236:239], v[20:23]
  ds_read_b64_tr_b16 v[42:43], v3 offset:49152
  ds_read_b128 v[168:171], v5 offset:22528
  ds_read_b32 v94, v74 offset:1920
  s_waitcnt vmcnt(7)
  s_barrier
  buffer_load_dwordx4 v9, s[12:15], s39 offen lds
  ds_write_b128 v6, v[100:103] offset:49152
  ds_write_b128 v6, v[104:107] offset:50176
  v_lshrrev_b32 v15, 9, v75
  v_and_b32 v15, -16, v15
  buffer_load_dwordx4 v[96:99], v15, s[72:75], 0 offen
  s_waitcnt lgkmcnt(11)
  v_mfma_f32_16x16x32_bf16 v[16:19], v[44:47], v[224:227], v[16:19]
  ds_read_b64_tr_b16 v[44:45], v3 offset:43008
  s_add_u32 m0, s33, 8192
  ds_read_b128 v[176:179], v5 offset:32768
  v_mfma_f32_16x16x32_bf16 v[16:19], v[48:51], v[232:235], v[16:19]
  ds_read_b64_tr_b16 v[46:47], v3 offset:51200
  s_add_u32 s39, s45, s17
  ds_read_b128 v[184:187], v5 offset:34816
  v_mfma_f32_16x16x32_bf16 v[16:19], v[32:35], v[240:243], v[16:19]
  ds_read_b64_tr_b16 v[48:49], v3 offset:45056
  ds_read_b128 v[180:183], v5 offset:33792
  v_mfma_f32_16x16x32_bf16 v[16:19], v[36:39], v[248:251], v[16:19]
  ds_read_b64_tr_b16 v[50:51], v3 offset:53248
  ds_read_b128 v[188:191], v5 offset:35840
  buffer_load_dwordx4 v9, s[12:15], s39 offen lds
  s_waitcnt lgkmcnt(5)
  v_mfma_f32_16x16x32_bf16 v[20:23], v[32:35], v[244:247], v[20:23]
  ds_read_b64_tr_b16 v[32:33], v3 offset:47104
  s_add_u32 m0, s33, 16384
  ds_read_b128 v[196:199], v5 offset:37888
  v_mfma_f32_16x16x32_bf16 v[20:23], v[36:39], v[252:255], v[20:23]
  ds_read_b64_tr_b16 v[34:35], v3 offset:55296
  s_add_u32 s39, s45, s18
  ds_read_b128 v[204:207], v5 offset:39936
  v_mfma_f32_16x16x32_bf16 v[24:27], v[40:43], v[112:115], 0
  ds_read_b64_tr_b16 v[36:37], v3 offset:57344
  ds_read_b128 v[192:195], v5 offset:36864
  v_mfma_f32_16x16x32_bf16 v[24:27], v[44:47], v[120:123], v[24:27]
  ds_read_b64_tr_b16 v[38:39], v4 offset:0
  ds_read_b128 v[200:203], v5 offset:38912
  s_waitcnt vmcnt(8)
  s_barrier
  buffer_load_dwordx4 v9, s[12:15], s39 offen lds
  s_lshl_b32 s38, s55, 12
  s_add_u32 s38, s38, 65536
  v_lshl_add_u32 v6, v1, 4, s38
  s_lshr_b32 s38, s32, 1
  s_lshl_b32 s38, s38, 8
  s_and_b32 s40, s32, 1
  s_add_u32 s38, s38, s40
  v_lshl_add_u32 v14, s38, 3, v6
  v_mul_f32 v56, v16, v16
  v_mul_f32 v57, v17, v17
  v_mul_f32 v58, v18, v18
  v_mul_f32 v59, v19, v19
  v_mul_f32 v60, v20, v20
  v_mul_f32 v61, v21, v21
  v_mul_f32 v62, v22, v22
  v_mul_f32 v63, v23, v23
  v_fma_f32 v56, v56, s34, v7
  v_fma_f32 v57, v57, s34, v7
  v_fma_f32 v58, v58, s34, v7
  v_fma_f32 v59, v59, s34, v7
  v_fma_f32 v60, v60, s34, v7
  v_fma_f32 v61, v61, s34, v7
  v_fma_f32 v62, v62, s34, v7
  v_fma_f32 v63, v63, s34, v7
  v_mul_f32 v56, v56, v16
  v_mul_f32 v57, v57, v17
  v_mul_f32 v58, v58, v18
  s_waitcnt lgkmcnt(5)
  v_mfma_f32_16x16x32_bf16 v[28:31], v[40:43], v[116:119], 0
  ds_read_b64_tr_b16 v[40:41], v3 offset:59392
  s_add_u32 m0, s33, 24576
  ds_read_b128 v[208:211], v5 offset:49152
  v_mfma_f32_16x16x32_bf16 v[28:31], v[44:47], v[124:127], v[28:31]
  ds_read_b64_tr_b16 v[42:43], v4 offset:2048
  s_add_u32 s39, s45, s19
  ds_read_b128 v[216:219], v5 offset:51200
  v_mfma_f32_16x16x32_bf16 v[28:31], v[48:51], v[132:135], v[28:31]
  ds_read_b64_tr_b16 v[44:45], v3 offset:61440
  ds_read_b128 v[212:215], v5 offset:50176
  v_mfma_f32_16x16x32_bf16 v[28:31], v[32:35], v[140:143], v[28:31]
  ds_read_b64_tr_b16 v[46:47], v4 offset:4096
  ds_read_b128 v[220:223], v5 offset:52224
  buffer_load_dwordx4 v9, s[12:15], s39 offen lds
  v_mul_f32 v59, v59, v19
  v_mul_f32 v60, v60, v20
  v_mul_f32 v61, v61, v21
  v_mul_f32 v62, v62, v22
  v_mul_f32 v63, v63, v23
  v_exp_f32 v56, v56
  v_exp_f32 v57, v57
  v_exp_f32 v58, v58
  v_exp_f32 v59, v59
  v_exp_f32 v60, v60
  v_exp_f32 v61, v61
  v_exp_f32 v62, v62
  s_waitcnt lgkmcnt(5)
  v_mfma_f32_16x16x32_bf16 v[24:27], v[48:51], v[128:131], v[24:27]
  ds_read_b64_tr_b16 v[48:49], v3 offset:63488
  s_add_u32 m0, s33, 32768
  ds_read_b128 v[228:231], v5 offset:54272
  v_mfma_f32_16x16x32_bf16 v[24:27], v[32:35], v[136:139], v[24:27]
  ds_read_b64_tr_b16 v[50:51], v4 offset:6144
  s_add_u32 s39, s45, s36
  ds_read_b128 v[236:239], v5 offset:56320
  v_mfma_f32_16x16x32_bf16 v[24:27], v[36:39], v[144:147], v[24:27]
  ds_read_b64_tr_b16 v[32:33], v4 offset:8192
  ds_read_b128 v[224:227], v5 offset:53248
  v_mfma_f32_16x16x32_bf16 v[24:27], v[40:43], v[152:155], v[24:27]
  ds_read_b64_tr_b16 v[34:35], v4 offset:16384
  ds_read_b128 v[232:235], v5 offset:55296
  s_waitcnt vmcnt(7)
  s_barrier
  buffer_load_dwordx4 v9, s[12:15], s39 offen lds
  v_exp_f32 v63, v63
  v_add_f32 v56, 1.0, v56
  v_add_f32 v57, 1.0, v57
  v_add_f32 v58, 1.0, v58
  v_add_f32 v59, 1.0, v59
  v_add_f32 v60, 1.0, v60
  v_add_f32 v61, 1.0, v61
  v_add_f32 v62, 1.0, v62
  v_add_f32 v63, 1.0, v63
  v_rcp_f32 v56, v56
  v_rcp_f32 v57, v57
  v_rcp_f32 v58, v58
  v_rcp_f32 v59, v59
  s_waitcnt lgkmcnt(5)
  v_mfma_f32_16x16x32_bf16 v[28:31], v[36:39], v[148:151], v[28:31]
  ds_read_b64_tr_b16 v[36:37], v4 offset:10240
  s_add_u32 m0, s33, 40960
  v_mfma_f32_16x16x32_bf16 v[28:31], v[40:43], v[156:159], v[28:31]
  ds_read_b64_tr_b16 v[38:39], v4 offset:18432
  s_add_u32 s39, s45, s37
  v_mfma_f32_16x16x32_bf16 v[28:31], v[44:47], v[164:167], v[28:31]
  ds_read_b64_tr_b16 v[40:41], v4 offset:12288
  v_mfma_f32_16x16x32_bf16 v[28:31], v[48:51], v[172:175], v[28:31]
  ds_read_b64_tr_b16 v[42:43], v4 offset:20480
  buffer_load_dwordx4 v9, s[12:15], s39 offen lds
  v_rcp_f32 v60, v60
  v_rcp_f32 v61, v61
  v_rcp_f32 v62, v62
  v_rcp_f32 v63, v63
  v_mul_f32 v56, v56, v16
  v_mul_f32 v57, v57, v17
  v_mul_f32 v58, v58, v18
  v_mul_f32 v59, v59, v19
  v_mul_f32 v60, v60, v20
  v_mul_f32 v61, v61, v21
  v_mul_f32 v62, v62, v22
  v_mul_f32 v63, v63, v23
  v_cvt_pk_bf16_f32 v108, v56, v57
  v_cvt_pk_bf16_f32 v109, v58, v59
  v_cvt_pk_bf16_f32 v110, v60, v61
  v_cvt_pk_bf16_f32 v111, v62, v63
  ds_write2st64_b64 v14, v[108:109], v[110:111] offset0:0 offset1:2
  s_waitcnt lgkmcnt(3)
  v_mfma_f32_16x16x32_bf16 v[24:27], v[44:47], v[160:163], v[24:27]
  ds_read_b64_tr_b16 v[44:45], v4 offset:14336
  s_add_u32 m0, s33, 49152
  v_mfma_f32_16x16x32_bf16 v[24:27], v[48:51], v[168:171], v[24:27]
  ds_read_b64_tr_b16 v[46:47], v4 offset:22528
  s_add_u32 s39, s45, s41
  v_mfma_f32_16x16x32_bf16 v[24:27], v[32:35], v[176:179], v[24:27]
  ds_read_b64_tr_b16 v[48:49], v4 offset:24576
  v_mfma_f32_16x16x32_bf16 v[24:27], v[36:39], v[184:187], v[24:27]
  ds_read_b64_tr_b16 v[50:51], v3 offset:32768
  s_waitcnt vmcnt(7) lgkmcnt(4)
  s_barrier
  buffer_load_dwordx4 v9, s[12:15], s39 offen lds
  s_add_u32 m0, s33, 57344
  s_add_u32 s39, s45, s42
  buffer_load_dwordx4 v9, s[12:15], s39 offen lds
  s_waitcnt lgkmcnt(2)
  v_mfma_f32_16x16x32_bf16 v[28:31], v[32:35], v[180:183], v[28:31]
  ds_read_b64_tr_b16 v[32:33], v4 offset:26624
  s_add_u32 m0, s33, 73728
  ds_read_b128 v[240:243], v6 offset:0
  v_mfma_f32_16x16x32_bf16 v[28:31], v[36:39], v[188:191], v[28:31]
  ds_read_b64_tr_b16 v[34:35], v3 offset:34816
  s_add_u32 s39, s45, s43
  ds_read_b128 v[248:251], v6 offset:2048
  v_mfma_f32_16x16x32_bf16 v[28:31], v[40:43], v[196:199], v[28:31]
  ds_read_b64_tr_b16 v[36:37], v4 offset:28672
  ds_read_b128 v[244:247], v6 offset:1024
  v_mfma_f32_16x16x32_bf16 v[28:31], v[44:47], v[204:207], v[28:31]
  ds_read_b64_tr_b16 v[38:39], v3 offset:36864
  ds_read_b128 v[252:255], v6 offset:3072
  buffer_load_dwordx4 v9, s[12:15], s39 offen lds
  s_waitcnt vmcnt(8)
  s_mov_b32 vcc_lo, 0xfefefefe
  s_mov_b32 vcc_hi, vcc_lo
  v_cndmask_b32 v84, v55, v84, vcc
  v_cndmask_b32_dpp v85, v55, v85, vcc row_shl:1 row_mask:0xf bank_mask:0xf
  v_cndmask_b32_dpp v86, v55, v86, vcc row_shl:2 row_mask:0xf bank_mask:0xf
  v_lshlrev_b32 v100, 16, v96
  v_and_b32 v101, 0xffff0000, v96
  v_lshlrev_b32 v102, 16, v97
  v_and_b32 v103, 0xffff0000, v97
  v_lshlrev_b32 v52, 16, v84
  v_lshlrev_b32 v53, 16, v85
  v_mul_f32 v104, v103, v52
  v_lshlrev_b32 v52, 16, v86
  s_waitcnt lgkmcnt(5)
  v_mfma_f32_16x16x32_bf16 v[24:27], v[40:43], v[192:195], v[24:27]
  ds_read_b64_tr_b16 v[40:41], v4 offset:30720
  s_add_u32 m0, s33, 106496
  v_mfma_f32_16x16x32_bf16 v[24:27], v[44:47], v[200:203], v[24:27]
  ds_read_b64_tr_b16 v[42:43], v3 offset:38912
  s_add_u32 s39, s46, s16
  v_mfma_f32_16x16x32_bf16 v[24:27], v[48:51], v[208:211], v[24:27]
  ds_read_b64_tr_b16 v[44:45], v3 offset:24576
  v_mfma_f32_16x16x32_bf16 v[24:27], v[32:35], v[216:219], v[24:27]
  ds_read_b64_tr_b16 v[46:47], v3 offset:26624
  s_waitcnt vmcnt(7)
  v_readfirstlane_b32 s3, v8
  s_cmp_eq_u32 s3, 0
  s_cbranch_scc1 parallel_sum__ssm_conv_h3__dense_activation_gelu__prompt_kernel_Z_tok_slow
parallel_sum__ssm_conv_h3__dense_activation_gelu__prompt_kernel_Z_tok_back:
  s_andn2_b32 s56, s62, 0xe0
  s_xor_b32 s56, s56, 4
  s_barrier
  buffer_load_dwordx4 v9, s[12:15], s39 offen lds
  v_fmac_f32 v104, v102, v53
  v_mul_f32 v105, v103, v53
  v_lshlrev_b32 v53, 16, v87
  v_fmac_f32 v104, v101, v52
  v_fmac_f32 v105, v102, v52
  v_mul_f32 v106, v103, v52
  v_lshlrev_b32 v52, 16, v88
  v_fmac_f32 v104, v100, v53
  v_fmac_f32 v105, v101, v53
  v_fmac_f32 v106, v102, v53
  s_waitcnt lgkmcnt(2)
  v_mfma_f32_16x16x32_bf16 v[28:31], v[48:51], v[212:215], v[28:31]
  ds_read_b64_tr_b16 v[48:49], v3 offset:28672
  s_add_u32 m0, s33, 114688
  v_mfma_f32_16x16x32_bf16 v[28:31], v[32:35], v[220:223], v[28:31]
  ds_read_b64_tr_b16 v[50:51], v3 offset:30720
  s_add_u32 s39, s46, s17
  v_mfma_f32_16x16x32_bf16 v[28:31], v[36:39], v[228:231], v[28:31]
  ds_read_b64_tr_b16 v[32:33], v2 offset:0
  v_mfma_f32_16x16x32_bf16 v[28:31], v[40:43], v[236:239], v[28:31]
  ds_read_b64_tr_b16 v[34:35], v2 offset:8192
  buffer_load_dwordx4 v9, s[12:15], s39 offen lds
  v_mul_f32 v107, v103, v53
  v_lshlrev_b32 v53, 16, v89
  v_fmac_f32 v105, v100, v52
  v_fmac_f32 v106, v101, v52
  v_fmac_f32 v107, v102, v52
  v_mul_f32 v108, v103, v52
  v_lshlrev_b32 v52, 16, v90
  v_fmac_f32 v106, v100, v53
  v_fmac_f32 v107, v101, v53
  v_fmac_f32 v108, v102, v53
  s_waitcnt lgkmcnt(2)
  v_mfma_f32_16x16x32_bf16 v[24:27], v[36:39], v[224:227], v[24:27]
  ds_read_b64_tr_b16 v[36:37], v2 offset:2048
  s_add_u32 m0, s33, 122880
  v_mfma_f32_16x16x32_bf16 v[24:27], v[40:43], v[232:235], v[24:27]
  ds_read_b64_tr_b16 v[38:39], v2 offset:10240
  s_add_u32 s39, s46, s18
  v_mfma_f32_16x16x32_bf16 v[24:27], v[44:47], v[240:243], v[24:27]
  ds_read_b64_tr_b16 v[40:41], v2 offset:4096
  v_mfma_f32_16x16x32_bf16 v[24:27], v[48:51], v[248:251], v[24:27]
  ds_read_b64_tr_b16 v[42:43], v2 offset:12288
  s_waitcnt vmcnt(7)
  s_barrier
  buffer_load_dwordx4 v9, s[12:15], s39 offen lds
  v_mul_f32 v109, v103, v53
  v_lshlrev_b32 v53, 16, v91
  v_fmac_f32 v107, v100, v52
  v_fmac_f32 v108, v101, v52
  v_fmac_f32 v109, v102, v52
  v_mul_f32 v110, v103, v52
  v_lshlrev_b32 v52, 16, v92
  v_fmac_f32 v108, v100, v53
  v_fmac_f32 v109, v101, v53
  s_waitcnt lgkmcnt(2)
  v_mfma_f32_16x16x32_bf16 v[28:31], v[44:47], v[244:247], v[28:31]
  ds_read_b64_tr_b16 v[44:45], v2 offset:6144
  s_add_u32 m0, s33, 131072
  v_mfma_f32_16x16x32_bf16 v[28:31], v[48:51], v[252:255], v[28:31]
  ds_read_b64_tr_b16 v[46:47], v2 offset:14336
  s_add_u32 s39, s46, s19
  v_mfma_f32_16x16x32_bf16 v[16:19], v[32:35], v[112:115], 0
  ds_read_b64_tr_b16 v[48:49], v2 offset:16384
  v_mfma_f32_16x16x32_bf16 v[16:19], v[36:39], v[120:123], v[16:19]
  ds_read_b64_tr_b16 v[50:51], v2 offset:24576
  buffer_load_dwordx4 v9, s[12:15], s39 offen lds
  v_fmac_f32 v110, v102, v53
  v_mul_f32 v111, v103, v53
  v_lshlrev_b32 v53, 16, v93
  v_fmac_f32 v109, v100, v52
  v_fmac_f32 v110, v101, v52
  v_fmac_f32 v111, v102, v52
  v_lshlrev_b32 v52, 16, v94
  v_fmac_f32 v110, v100, v53
  v_fmac_f32 v111, v101, v53
  v_fmac_f32 v111, v100, v52
  s_waitcnt lgkmcnt(2)
  v_mfma_f32_16x16x32_bf16 v[20:23], v[32:35], v[116:119], 0
  ds_read_b64_tr_b16 v[32:33], v2 offset:18432
  s_add_u32 m0, s33, 139264
  v_mfma_f32_16x16x32_bf16 v[20:23], v[36:39], v[124:127], v[20:23]
  ds_read_b64_tr_b16 v[34:35], v2 offset:26624
  s_add_u32 s39, s46, s36
  v_mfma_f32_16x16x32_bf16 v[20:23], v[40:43], v[132:135], v[20:23]
  ds_read_b64_tr_b16 v[36:37], v2 offset:20480
  v_mfma_f32_16x16x32_bf16 v[20:23], v[44:47], v[140:143], v[20:23]
  ds_read_b64_tr_b16 v[38:39], v2 offset:28672
  s_waitcnt vmcnt(4)
  s_barrier
  buffer_load_dwordx4 v9, s[12:15], s39 offen lds
  v_lshlrev_b32 v52, 16, v76
  v_lshlrev_b32 v53, 16, v77
  v_lshlrev_b32 v54, 16, v78
  v_lshlrev_b32 v55, 16, v79
  v_mul_f32 v104, v104, v52
  v_bfe_i32 v58, v1, 4, 1
  v_and_b32 v59, 0x10000, v58
  v_or_b32 v58, 0xfffe0000, v58
  v_mul_f32 v105, v105, v53
  v_mul_f32 v106, v106, v54
  v_xor_b32 v59, 0x10000, v59
  v_add_u32 v24, v24, v59
  v_add_u32 v28, v28, v59
  v_mul_f32 v107, v107, v55
  v_lshlrev_b32 v52, 16, v80
  v_lshlrev_b32 v53, 16, v81
  v_and_b32 v24, v24, v58
  v_and_b32 v28, v28, v58
  v_cvt_pk_bf16_f32 v56, v24, v25
  s_waitcnt lgkmcnt(2)
  v_mfma_f32_16x16x32_bf16 v[16:19], v[40:43], v[128:131], v[16:19]
  ds_read_b64_tr_b16 v[40:41], v2 offset:22528
  s_add_u32 m0, s33, 147456
  v_mfma_f32_16x16x32_bf16 v[16:19], v[44:47], v[136:139], v[16:19]
  ds_read_b64_tr_b16 v[42:43], v2 offset:30720
  s_add_u32 s39, s46, s37
  v_mfma_f32_16x16x32_bf16 v[16:19], v[48:51], v[144:147], v[16:19]
  ds_read_b64_tr_b16 v[44:45], v2 offset:32768
  v_mfma_f32_16x16x32_bf16 v[16:19], v[32:35], v[152:155], v[16:19]
  ds_read_b64_tr_b16 v[46:47], v2 offset:40960
  buffer_load_dwordx4 v9, s[12:15], s39 offen lds
  v_lshlrev_b32 v54, 16, v82
  v_lshlrev_b32 v55, 16, v83
  v_cvt_pk_bf16_f32 v57, v26, v27
  v_cvt_pk_bf16_f32 v58, v28, v29
  v_cvt_pk_bf16_f32 v59, v30, v31
  v_mul_f32 v108, v108, v52
  v_mul_f32 v109, v109, v53
  v_mul_f32 v110, v110, v54
  s_nop 0
  v_permlane16_swap_b32 v56, v58
  v_permlane16_swap_b32 v57, v59
  v_mul_f32 v111, v111, v55
  v_cvt_pk_bf16_f32 v60, v104, v105
  s_lshl_b32 s40, s44, 11
  s_add_u32 s40, s40, s53
  v_and_b32 v56, -2, v56
  buffer_store_dwordx4 v[56:59], v11, s[24:27], s40 offen sc1
  v_cvt_pk_bf16_f32 v61, v106, v107
  v_cvt_pk_bf16_f32 v62, v108, v109
  s_waitcnt lgkmcnt(2)
  v_mfma_f32_16x16x32_bf16 v[20:23], v[48:51], v[148:151], v[20:23]
  ds_read_b64_tr_b16 v[48:49], v2 offset:34816
  s_add_u32 m0, s33, 155648
  v_mfma_f32_16x16x32_bf16 v[20:23], v[32:35], v[156:159], v[20:23]
  ds_read_b64_tr_b16 v[50:51], v2 offset:43008
  s_add_u32 s39, s46, s41
  v_mfma_f32_16x16x32_bf16 v[20:23], v[36:39], v[164:167], v[20:23]
  ds_read_b64_tr_b16 v[32:33], v2 offset:36864
  v_mfma_f32_16x16x32_bf16 v[20:23], v[40:43], v[172:175], v[20:23]
  ds_read_b64_tr_b16 v[34:35], v2 offset:45056
  buffer_load_dwordx4 v9, s[12:15], s39 offen lds
  v_cvt_pk_bf16_f32 v63, v110, v111
  v_lshlrev_b32 v100, 16, v98
  v_and_b32 v101, 0xffff0000, v98
  v_lshlrev_b32 v102, 16, v99
  v_and_b32 v103, 0xffff0000, v99
  v_and_b32 v52, 0xffff0000, v84
  v_and_b32 v53, 0xffff0000, v85
  v_mul_f32 v104, v103, v52
  v_and_b32 v52, 0xffff0000, v86
  v_fmac_f32 v104, v102, v53
  s_waitcnt lgkmcnt(2)
  v_mfma_f32_16x16x32_bf16 v[16:19], v[36:39], v[160:163], v[16:19]
  ds_read_b64_tr_b16 v[36:37], v2 offset:38912
  s_add_u32 m0, s33, 98304
  v_mfma_f32_16x16x32_bf16 v[16:19], v[40:43], v[168:171], v[16:19]
  ds_read_b64_tr_b16 v[38:39], v2 offset:47104
  s_add_u32 s39, s46, s42
  v_mfma_f32_16x16x32_bf16 v[16:19], v[44:47], v[176:179], v[16:19]
  ds_read_b64_tr_b16 v[40:41], v2 offset:49152
  v_mfma_f32_16x16x32_bf16 v[16:19], v[48:51], v[184:187], v[16:19]
  ds_read_b64_tr_b16 v[42:43], v2 offset:57344
  buffer_load_dwordx4 v9, s[12:15], s39 offen lds
  s_add_u32 m0, s33, 90112
  s_add_u32 s39, s46, s43
  v_mul_f32 v105, v103, v53
  v_and_b32 v53, 0xffff0000, v87
  buffer_load_dwordx4 v9, s[12:15], s39 offen lds
  v_fmac_f32 v104, v101, v52
  v_fmac_f32 v105, v102, v52
  v_mul_f32 v106, v103, v52
  v_and_b32 v52, 0xffff0000, v88
  v_fmac_f32 v104, v100, v53
  v_fmac_f32 v105, v101, v53
  v_fmac_f32 v106, v102, v53
  v_mul_f32 v107, v103, v53
  s_waitcnt lgkmcnt(2)
  v_mfma_f32_16x16x32_bf16 v[20:23], v[44:47], v[180:183], v[20:23]
  ds_read_b64_tr_b16 v[44:45], v2 offset:51200
  s_add_u32 m0, s33, 0
  v_mfma_f32_16x16x32_bf16 v[20:23], v[48:51], v[188:191], v[20:23]
  ds_read_b64_tr_b16 v[46:47], v2 offset:59392
  s_add_u32 s39, s47, s16
  v_mfma_f32_16x16x32_bf16 v[20:23], v[32:35], v[196:199], v[20:23]
  ds_read_b64_tr_b16 v[48:49], v2 offset:53248
  v_mfma_f32_16x16x32_bf16 v[20:23], v[36:39], v[204:207], v[20:23]
  ds_read_b64_tr_b16 v[50:51], v2 offset:61440
  buffer_load_dwordx4 v9, s[12:15], s39 offen lds
  v_and_b32 v53, 0xffff0000, v89
  v_fmac_f32 v105, v100, v52
  v_fmac_f32 v106, v101, v52
  v_fmac_f32 v107, v102, v52
  v_mul_f32 v108, v103, v52
  v_and_b32 v52, 0xffff0000, v90
  v_fmac_f32 v106, v100, v53
  v_fmac_f32 v107, v101, v53
  v_fmac_f32 v108, v102, v53
  v_mul_f32 v109, v103, v53
  s_waitcnt lgkmcnt(2)
  v_mfma_f32_16x16x32_bf16 v[16:19], v[32:35], v[192:195], v[16:19]
  ds_read_b64_tr_b16 v[32:33], v2 offset:55296
  s_add_u32 m0, s33, 8192
  v_mfma_f32_16x16x32_bf16 v[16:19], v[36:39], v[200:203], v[16:19]
  ds_read_b64_tr_b16 v[34:35], v2 offset:63488
  s_add_u32 s39, s47, s17
  v_mfma_f32_16x16x32_bf16 v[16:19], v[40:43], v[208:211], v[16:19]
  ds_read_b64_tr_b16 v[36:37], v3 offset:8192
  v_mfma_f32_16x16x32_bf16 v[16:19], v[44:47], v[216:219], v[16:19]
  ds_read_b64_tr_b16 v[38:39], v3 offset:10240
  s_waitcnt vmcnt(7)
  s_barrier
  buffer_load_dwordx4 v9, s[12:15], s39 offen lds
  v_and_b32 v53, 0xffff0000, v91
  v_fmac_f32 v107, v100, v52
  v_fmac_f32 v108, v101, v52
  v_fmac_f32 v109, v102, v52
  v_mul_f32 v110, v103, v52
  v_and_b32 v52, 0xffff0000, v92
  v_fmac_f32 v108, v100, v53
  v_fmac_f32 v109, v101, v53
  v_fmac_f32 v110, v102, v53
  s_waitcnt lgkmcnt(2)
  v_mfma_f32_16x16x32_bf16 v[20:23], v[40:43], v[212:215], v[20:23]
  ds_read_b64_tr_b16 v[40:41], v3 offset:12288
  s_add_u32 m0, s33, 16384
  v_mfma_f32_16x16x32_bf16 v[20:23], v[44:47], v[220:223], v[20:23]
  ds_read_b64_tr_b16 v[42:43], v3 offset:14336
  s_add_u32 s39, s47, s18
  v_mfma_f32_16x16x32_bf16 v[20:23], v[48:51], v[228:231], v[20:23]
  ds_read_b64_tr_b16 v[44:45], v3 offset:40960
  v_mfma_f32_16x16x32_bf16 v[20:23], v[32:35], v[236:239], v[20:23]
  ds_read_b64_tr_b16 v[46:47], v3 offset:49152
  buffer_load_dwordx4 v9, s[12:15], s39 offen lds
  v_mul_f32 v111, v103, v53
  v_and_b32 v53, 0xffff0000, v93
  v_fmac_f32 v109, v100, v52
  v_fmac_f32 v110, v101, v52
  v_fmac_f32 v111, v102, v52
  v_and_b32 v52, 0xffff0000, v94
  v_fmac_f32 v110, v100, v53
  v_fmac_f32 v111, v101, v53
  v_fmac_f32 v111, v100, v52
  v_and_b32 v52, 0xffff0000, v76
  s_waitcnt lgkmcnt(2)
  v_mfma_f32_16x16x32_bf16 v[16:19], v[48:51], v[224:227], v[16:19]
  ds_read_b64_tr_b16 v[48:49], v3 offset:43008
  s_add_u32 m0, s33, 24576
  v_mfma_f32_16x16x32_bf16 v[16:19], v[32:35], v[232:235], v[16:19]
  ds_read_b64_tr_b16 v[50:51], v3 offset:51200
  s_add_u32 s39, s47, s19
  v_mfma_f32_16x16x32_bf16 v[16:19], v[36:39], v[240:243], v[16:19]
  ds_read_b64_tr_b16 v[32:33], v3 offset:45056
  v_mfma_f32_16x16x32_bf16 v[16:19], v[40:43], v[248:251], v[16:19]
  ds_read_b64_tr_b16 v[34:35], v3 offset:53248
  buffer_load_dwordx4 v9, s[12:15], s39 offen lds
  v_and_b32 v53, 0xffff0000, v77
  v_and_b32 v54, 0xffff0000, v78
  v_and_b32 v55, 0xffff0000, v79
  v_mul_f32 v104, v104, v52
  v_mul_f32 v105, v105, v53
  v_mul_f32 v106, v106, v54
  v_mul_f32 v107, v107, v55
  v_and_b32 v52, 0xffff0000, v80
  v_and_b32 v53, 0xffff0000, v81
  v_and_b32 v54, 0xffff0000, v82
  s_waitcnt lgkmcnt(2)
  v_mfma_f32_16x16x32_bf16 v[20:23], v[36:39], v[244:247], v[20:23]
  ds_read_b64_tr_b16 v[36:37], v3 offset:47104
  s_add_u32 m0, s33, 32768
  v_mfma_f32_16x16x32_bf16 v[20:23], v[40:43], v[252:255], v[20:23]
  ds_read_b64_tr_b16 v[38:39], v3 offset:55296
  s_add_u32 s39, s47, s36
  v_mfma_f32_16x16x32_bf16 v[24:27], v[44:47], v[112:115], 0
  ds_read_b64_tr_b16 v[40:41], v3 offset:57344
  v_mfma_f32_16x16x32_bf16 v[24:27], v[48:51], v[120:123], v[24:27]
  ds_read_b64_tr_b16 v[42:43], v4 offset:0
  buffer_load_dwordx4 v9, s[12:15], s39 offen lds
  v_and_b32 v55, 0xffff0000, v83
  v_mul_f32 v108, v108, v52
  v_mul_f32 v109, v109, v53
  v_mul_f32 v110, v110, v54
  v_mul_f32 v111, v111, v55
  v_cvt_pk_bf16_f32 v104, v104, v105
  v_cvt_pk_bf16_f32 v105, v106, v107
  v_cvt_pk_bf16_f32 v106, v108, v109
  v_cvt_pk_bf16_f32 v107, v110, v111
  s_waitcnt lgkmcnt(2)
  v_mfma_f32_16x16x32_bf16 v[28:31], v[44:47], v[116:119], 0
  ds_read_b64_tr_b16 v[44:45], v3 offset:59392
  s_add_u32 m0, s33, 40960
  v_mfma_f32_16x16x32_bf16 v[28:31], v[48:51], v[124:127], v[28:31]
  ds_read_b64_tr_b16 v[46:47], v4 offset:2048
  s_add_u32 s39, s47, s37
  v_mfma_f32_16x16x32_bf16 v[28:31], v[32:35], v[132:135], v[28:31]
  ds_read_b64_tr_b16 v[48:49], v3 offset:61440
  v_mfma_f32_16x16x32_bf16 v[28:31], v[36:39], v[140:143], v[28:31]
  ds_read_b64_tr_b16 v[50:51], v4 offset:4096
  s_waitcnt vmcnt(5)
  s_barrier
  buffer_load_dwordx4 v9, s[12:15], s39 offen lds
  v_bfe_i32 v58, v1, 4, 1
  v_and_b32 v59, 0x10000, v58
  v_or_b32 v58, 0xfffe0000, v58
  v_xor_b32 v59, 0x10000, v59
  v_add_u32 v16, v16, v59
  v_add_u32 v20, v20, v59
  v_and_b32 v16, v16, v58
  v_and_b32 v20, v20, v58
  v_cvt_pk_bf16_f32 v56, v16, v17
  s_waitcnt lgkmcnt(2)
  v_mfma_f32_16x16x32_bf16 v[24:27], v[32:35], v[128:131], v[24:27]
  ds_read_b64_tr_b16 v[32:33], v3 offset:63488
  s_add_u32 m0, s33, 49152
  v_mfma_f32_16x16x32_bf16 v[24:27], v[36:39], v[136:139], v[24:27]
  ds_read_b64_tr_b16 v[34:35], v4 offset:6144
  s_add_u32 s39, s47, s41
  v_mfma_f32_16x16x32_bf16 v[24:27], v[40:43], v[144:147], v[24:27]
  ds_read_b64_tr_b16 v[36:37], v4 offset:8192
  v_mfma_f32_16x16x32_bf16 v[24:27], v[44:47], v[152:155], v[24:27]
  ds_read_b64_tr_b16 v[38:39], v4 offset:16384
  buffer_load_dwordx4 v9, s[12:15], s39 offen lds
  v_cvt_pk_bf16_f32 v57, v18, v19
  v_cvt_pk_bf16_f32 v58, v20, v21
  v_cvt_pk_bf16_f32 v59, v22, v23
  s_nop 0
  v_permlane16_swap_b32 v56, v58
  v_permlane16_swap_b32 v57, v59
  s_lshl_b32 s40, s45, 11
  s_add_u32 s40, s40, s53
  v_and_b32 v56, -2, v56
  buffer_store_dwordx4 v[56:59], v11, s[24:27], s40 offen sc1
  buffer_store_dwordx4 v[60:63], v75, s[24:27], s76 offen sc1
  s_add_u32 s76, s76, 4096
  buffer_store_dwordx4 v[104:107], v75, s[24:27], s76 offen sc1
  s_lshl1_add_u32 s38, s44, s62
  buffer_store_dword v8, v12, s[24:27], s38 offen sc1
  s_waitcnt lgkmcnt(2)
  v_mfma_f32_16x16x32_bf16 v[28:31], v[40:43], v[148:151], v[28:31]
  ds_read_b64_tr_b16 v[40:41], v4 offset:10240
  s_add_u32 m0, s33, 57344
  v_mfma_f32_16x16x32_bf16 v[28:31], v[44:47], v[156:159], v[28:31]
  ds_read_b64_tr_b16 v[42:43], v4 offset:18432
  s_add_u32 s39, s47, s42
  v_mfma_f32_16x16x32_bf16 v[28:31], v[48:51], v[164:167], v[28:31]
  ds_read_b64_tr_b16 v[44:45], v4 offset:12288
  v_mfma_f32_16x16x32_bf16 v[28:31], v[32:35], v[172:175], v[28:31]
  ds_read_b64_tr_b16 v[46:47], v4 offset:20480
  buffer_load_dwordx4 v9, s[12:15], s39 offen lds
  s_waitcnt lgkmcnt(2)
  v_mfma_f32_16x16x32_bf16 v[24:27], v[48:51], v[160:163], v[24:27]
  ds_read_b64_tr_b16 v[48:49], v4 offset:14336
  s_add_u32 m0, s33, 65536
  v_mfma_f32_16x16x32_bf16 v[24:27], v[32:35], v[168:171], v[24:27]
  ds_read_b64_tr_b16 v[50:51], v4 offset:22528
  s_add_u32 s39, s47, s43
  v_mfma_f32_16x16x32_bf16 v[24:27], v[36:39], v[176:179], v[24:27]
  ds_read_b64_tr_b16 v[32:33], v4 offset:24576
  v_mfma_f32_16x16x32_bf16 v[24:27], v[40:43], v[184:187], v[24:27]
  ds_read_b64_tr_b16 v[34:35], v3 offset:32768
  buffer_load_dwordx4 v9, s[12:15], s39 offen lds
  s_waitcnt lgkmcnt(2)
  v_mfma_f32_16x16x32_bf16 v[28:31], v[36:39], v[180:183], v[28:31]
  ds_read_b64_tr_b16 v[36:37], v4 offset:26624
  s_add_u32 m0, s33, 106496
  v_mfma_f32_16x16x32_bf16 v[28:31], v[40:43], v[188:191], v[28:31]
  ds_read_b64_tr_b16 v[38:39], v3 offset:34816
  s_add_u32 s39, s48, s16
  v_mfma_f32_16x16x32_bf16 v[28:31], v[44:47], v[196:199], v[28:31]
  ds_read_b64_tr_b16 v[40:41], v4 offset:28672
  v_mfma_f32_16x16x32_bf16 v[28:31], v[48:51], v[204:207], v[28:31]
  ds_read_b64_tr_b16 v[42:43], v3 offset:36864
  buffer_load_dwordx4 v9, s[12:15], s39 offen lds
  s_waitcnt lgkmcnt(2)
  v_mfma_f32_16x16x32_bf16 v[24:27], v[44:47], v[192:195], v[24:27]
  ds_read_b64_tr_b16 v[44:45], v4 offset:30720
  s_add_u32 m0, s33, 114688
  v_mfma_f32_16x16x32_bf16 v[24:27], v[48:51], v[200:203], v[24:27]
  ds_read_b64_tr_b16 v[46:47], v3 offset:38912
  s_add_u32 s39, s48, s17
  v_mfma_f32_16x16x32_bf16 v[24:27], v[32:35], v[208:211], v[24:27]
  ds_read_b64_tr_b16 v[48:49], v3 offset:24576
  v_mfma_f32_16x16x32_bf16 v[24:27], v[36:39], v[216:219], v[24:27]
  ds_read_b64_tr_b16 v[50:51], v3 offset:26624
  s_waitcnt vmcnt(10)
  s_barrier
  buffer_load_dwordx4 v9, s[12:15], s39 offen lds
  s_waitcnt lgkmcnt(2)
  v_mfma_f32_16x16x32_bf16 v[28:31], v[32:35], v[212:215], v[28:31]
  ds_read_b64_tr_b16 v[32:33], v3 offset:28672
  s_add_u32 m0, s33, 122880
  v_mfma_f32_16x16x32_bf16 v[28:31], v[36:39], v[220:223], v[28:31]
  ds_read_b64_tr_b16 v[34:35], v3 offset:30720
  s_add_u32 s39, s48, s18
  v_mfma_f32_16x16x32_bf16 v[28:31], v[40:43], v[228:231], v[28:31]
  ds_read_b64_tr_b16 v[36:37], v2 offset:0
  v_mfma_f32_16x16x32_bf16 v[28:31], v[44:47], v[236:239], v[28:31]
  ds_read_b64_tr_b16 v[38:39], v2 offset:8192
  buffer_load_dwordx4 v9, s[12:15], s39 offen lds
  s_waitcnt lgkmcnt(2)
  v_mfma_f32_16x16x32_bf16 v[24:27], v[40:43], v[224:227], v[24:27]
  ds_read_b64_tr_b16 v[40:41], v2 offset:2048
  s_add_u32 m0, s33, 131072
  v_mfma_f32_16x16x32_bf16 v[24:27], v[44:47], v[232:235], v[24:27]
  ds_read_b64_tr_b16 v[42:43], v2 offset:10240
  s_add_u32 s39, s48, s19
  v_mfma_f32_16x16x32_bf16 v[24:27], v[48:51], v[240:243], v[24:27]
  ds_read_b64_tr_b16 v[44:45], v2 offset:4096
  v_mfma_f32_16x16x32_bf16 v[24:27], v[32:35], v[248:251], v[24:27]
  ds_read_b64_tr_b16 v[46:47], v2 offset:12288
  buffer_load_dwordx4 v9, s[12:15], s39 offen lds
  s_waitcnt lgkmcnt(2)
  v_mfma_f32_16x16x32_bf16 v[28:31], v[48:51], v[244:247], v[28:31]
  ds_read_b64_tr_b16 v[48:49], v2 offset:6144
  s_add_u32 m0, s33, 139264
  v_mfma_f32_16x16x32_bf16 v[28:31], v[32:35], v[252:255], v[28:31]
  ds_read_b64_tr_b16 v[50:51], v2 offset:14336
  s_add_u32 s39, s48, s36
  v_mfma_f32_16x16x32_bf16 v[16:19], v[36:39], v[112:115], 0
  ds_read_b64_tr_b16 v[32:33], v2 offset:16384
  v_mfma_f32_16x16x32_bf16 v[16:19], v[40:43], v[120:123], v[16:19]
  ds_read_b64_tr_b16 v[34:35], v2 offset:24576
  buffer_load_dwordx4 v9, s[12:15], s39 offen lds
  s_waitcnt lgkmcnt(2)
  v_mfma_f32_16x16x32_bf16 v[20:23], v[36:39], v[116:119], 0
  ds_read_b64_tr_b16 v[36:37], v2 offset:18432
  s_add_u32 m0, s33, 147456
  v_mfma_f32_16x16x32_bf16 v[20:23], v[40:43], v[124:127], v[20:23]
  ds_read_b64_tr_b16 v[38:39], v2 offset:26624
  s_add_u32 s39, s48, s37
  v_mfma_f32_16x16x32_bf16 v[20:23], v[44:47], v[132:135], v[20:23]
  ds_read_b64_tr_b16 v[40:41], v2 offset:20480
  v_mfma_f32_16x16x32_bf16 v[20:23], v[48:51], v[140:143], v[20:23]
  ds_read_b64_tr_b16 v[42:43], v2 offset:28672
  s_waitcnt vmcnt(5)
  s_barrier
  buffer_load_dwordx4 v9, s[12:15], s39 offen lds
  v_bfe_i32 v62, v1, 4, 1
  v_and_b32 v63, 0x10000, v62
  v_or_b32 v62, 0xfffe0000, v62
  v_xor_b32 v63, 0x10000, v63
  v_add_u32 v24, v24, v63
  v_add_u32 v28, v28, v63
  v_and_b32 v24, v24, v62
  v_and_b32 v28, v28, v62
  v_cvt_pk_bf16_f32 v56, v24, v25
  s_waitcnt lgkmcnt(2)
  v_mfma_f32_16x16x32_bf16 v[16:19], v[44:47], v[128:131], v[16:19]
  ds_read_b64_tr_b16 v[44:45], v2 offset:22528
  s_add_u32 m0, s33, 155648
  v_mfma_f32_16x16x32_bf16 v[16:19], v[48:51], v[136:139], v[16:19]
  ds_read_b64_tr_b16 v[46:47], v2 offset:30720
  s_add_u32 s39, s48, s41
  v_mfma_f32_16x16x32_bf16 v[16:19], v[32:35], v[144:147], v[16:19]
  ds_read_b64_tr_b16 v[48:49], v2 offset:32768
  v_mfma_f32_16x16x32_bf16 v[16:19], v[36:39], v[152:155], v[16:19]
  ds_read_b64_tr_b16 v[50:51], v2 offset:40960
  buffer_load_dwordx4 v9, s[12:15], s39 offen lds
  v_cvt_pk_bf16_f32 v57, v26, v27
  v_cvt_pk_bf16_f32 v58, v28, v29
  v_cvt_pk_bf16_f32 v59, v30, v31
  s_nop 0
  v_permlane16_swap_b32 v56, v58
  v_permlane16_swap_b32 v57, v59
  s_lshl_b32 s40, s46, 11
  s_add_u32 s40, s40, s53
  v_and_b32 v56, -2, v56
  buffer_store_dwordx4 v[56:59], v11, s[24:27], s40 offen sc1
  s_lshl1_add_u32 s38, s45, s62
  buffer_store_dword v8, v12, s[24:27], s38 offen sc1
  s_mul_i32 s38, s2, 257
  s_bfe_u32 s38, s38, 524291
  s_lshl2_add_u32 s38, s38, 27262976
  buffer_store_dword v8, v12, s[24:27], s38 offen sc1
  s_waitcnt lgkmcnt(2)
  v_mfma_f32_16x16x32_bf16 v[20:23], v[32:35], v[148:151], v[20:23]
  ds_read_b64_tr_b16 v[32:33], v2 offset:34816
  s_add_u32 m0, s33, 98304
  v_mfma_f32_16x16x32_bf16 v[20:23], v[36:39], v[156:159], v[20:23]
  ds_read_b64_tr_b16 v[34:35], v2 offset:43008
  s_add_u32 s39, s48, s42
  v_mfma_f32_16x16x32_bf16 v[20:23], v[40:43], v[164:167], v[20:23]
  ds_read_b64_tr_b16 v[36:37], v2 offset:36864
  v_mfma_f32_16x16x32_bf16 v[20:23], v[44:47], v[172:175], v[20:23]
  ds_read_b64_tr_b16 v[38:39], v2 offset:45056
  buffer_load_dwordx4 v9, s[12:15], s39 offen lds
  s_waitcnt lgkmcnt(2)
  v_mfma_f32_16x16x32_bf16 v[16:19], v[40:43], v[160:163], v[16:19]
  ds_read_b64_tr_b16 v[40:41], v2 offset:38912
  s_add_u32 m0, s33, 90112
  v_mfma_f32_16x16x32_bf16 v[16:19], v[44:47], v[168:171], v[16:19]
  ds_read_b64_tr_b16 v[42:43], v2 offset:47104
  s_add_u32 s39, s48, s43
  v_mfma_f32_16x16x32_bf16 v[16:19], v[48:51], v[176:179], v[16:19]
  ds_read_b64_tr_b16 v[44:45], v2 offset:49152
  v_mfma_f32_16x16x32_bf16 v[16:19], v[32:35], v[184:187], v[16:19]
  ds_read_b64_tr_b16 v[46:47], v2 offset:57344
  buffer_load_dwordx4 v9, s[12:15], s39 offen lds
  s_waitcnt lgkmcnt(2)
  v_mfma_f32_16x16x32_bf16 v[20:23], v[48:51], v[180:183], v[20:23]
  ds_read_b64_tr_b16 v[48:49], v2 offset:51200
  s_add_u32 m0, s33, 0
  v_mfma_f32_16x16x32_bf16 v[20:23], v[32:35], v[188:191], v[20:23]
  ds_read_b64_tr_b16 v[50:51], v2 offset:59392
  s_add_u32 s39, s49, s16
  v_mfma_f32_16x16x32_bf16 v[20:23], v[36:39], v[196:199], v[20:23]
  ds_read_b64_tr_b16 v[32:33], v2 offset:53248
  v_mfma_f32_16x16x32_bf16 v[20:23], v[40:43], v[204:207], v[20:23]
  ds_read_b64_tr_b16 v[34:35], v2 offset:61440
  buffer_load_dwordx4 v9, s[12:15], s39 offen lds
  s_lshl1_add_u32 s38, s48, s56
  buffer_load_dword v68, off, s[24:27], s38 sc1
  s_waitcnt lgkmcnt(2)
  v_mfma_f32_16x16x32_bf16 v[16:19], v[36:39], v[192:195], v[16:19]
  ds_read_b64_tr_b16 v[36:37], v2 offset:55296
  s_add_u32 m0, s33, 8192
  v_mfma_f32_16x16x32_bf16 v[16:19], v[40:43], v[200:203], v[16:19]
  ds_read_b64_tr_b16 v[38:39], v2 offset:63488
  s_add_u32 s39, s49, s17
  v_mfma_f32_16x16x32_bf16 v[16:19], v[44:47], v[208:211], v[16:19]
  ds_read_b64_tr_b16 v[40:41], v3 offset:0
  v_mfma_f32_16x16x32_bf16 v[16:19], v[48:51], v[216:219], v[16:19]
  ds_read_b64_tr_b16 v[42:43], v3 offset:2048
  s_waitcnt vmcnt(10)
  s_barrier
  buffer_load_dwordx4 v9, s[12:15], s39 offen lds
  s_waitcnt lgkmcnt(2)
  v_mfma_f32_16x16x32_bf16 v[20:23], v[44:47], v[212:215], v[20:23]
  ds_read_b64_tr_b16 v[44:45], v3 offset:4096
  s_add_u32 m0, s33, 16384
  v_mfma_f32_16x16x32_bf16 v[20:23], v[48:51], v[220:223], v[20:23]
  ds_read_b64_tr_b16 v[46:47], v3 offset:6144
  s_add_u32 s39, s49, s18
  v_mfma_f32_16x16x32_bf16 v[20:23], v[32:35], v[228:231], v[20:23]
  ds_read_b64_tr_b16 v[48:49], v3 offset:40960
  v_mfma_f32_16x16x32_bf16 v[20:23], v[36:39], v[236:239], v[20:23]
  ds_read_b64_tr_b16 v[50:51], v3 offset:49152
  buffer_load_dwordx4 v9, s[12:15], s39 offen lds
  s_waitcnt lgkmcnt(2)
  v_mfma_f32_16x16x32_bf16 v[16:19], v[32:35], v[224:227], v[16:19]
  ds_read_b64_tr_b16 v[32:33], v3 offset:43008
  s_add_u32 m0, s33, 24576
  v_mfma_f32_16x16x32_bf16 v[16:19], v[36:39], v[232:235], v[16:19]
  ds_read_b64_tr_b16 v[34:35], v3 offset:51200
  s_add_u32 s39, s49, s19
  v_mfma_f32_16x16x32_bf16 v[16:19], v[40:43], v[240:243], v[16:19]
  ds_read_b64_tr_b16 v[36:37], v3 offset:45056
  v_mfma_f32_16x16x32_bf16 v[16:19], v[44:47], v[248:251], v[16:19]
  ds_read_b64_tr_b16 v[38:39], v3 offset:53248
  buffer_load_dwordx4 v9, s[12:15], s39 offen lds
  s_waitcnt lgkmcnt(2)
  v_mfma_f32_16x16x32_bf16 v[20:23], v[40:43], v[244:247], v[20:23]
  ds_read_b64_tr_b16 v[40:41], v3 offset:47104
  s_add_u32 m0, s33, 32768
  v_mfma_f32_16x16x32_bf16 v[20:23], v[44:47], v[252:255], v[20:23]
  ds_read_b64_tr_b16 v[42:43], v3 offset:55296
  s_add_u32 s39, s49, s36
  v_mfma_f32_16x16x32_bf16 v[24:27], v[48:51], v[112:115], 0
  ds_read_b64_tr_b16 v[44:45], v3 offset:57344
  v_mfma_f32_16x16x32_bf16 v[24:27], v[32:35], v[120:123], v[24:27]
  ds_read_b64_tr_b16 v[46:47], v4 offset:0
  buffer_load_dwordx4 v9, s[12:15], s39 offen lds
  s_waitcnt lgkmcnt(2)
  v_mfma_f32_16x16x32_bf16 v[28:31], v[48:51], v[116:119], 0
  ds_read_b64_tr_b16 v[48:49], v3 offset:59392
  s_add_u32 m0, s33, 40960
  v_mfma_f32_16x16x32_bf16 v[28:31], v[32:35], v[124:127], v[28:31]
  ds_read_b64_tr_b16 v[50:51], v4 offset:2048
  s_add_u32 s39, s49, s37
  v_mfma_f32_16x16x32_bf16 v[28:31], v[36:39], v[132:135], v[28:31]
  ds_read_b64_tr_b16 v[32:33], v3 offset:61440
  v_mfma_f32_16x16x32_bf16 v[28:31], v[40:43], v[140:143], v[28:31]
  ds_read_b64_tr_b16 v[34:35], v4 offset:4096
  s_waitcnt vmcnt(6)
  s_barrier
  buffer_load_dwordx4 v9, s[12:15], s39 offen lds
  v_add_u32 v16, v16, v63
  v_add_u32 v20, v20, v63
  v_and_b32 v16, v16, v62
  v_and_b32 v20, v20, v62
  v_cvt_pk_bf16_f32 v56, v16, v17
  v_cvt_pk_bf16_f32 v57, v18, v19
  v_cvt_pk_bf16_f32 v58, v20, v21
  s_waitcnt lgkmcnt(2)
  v_mfma_f32_16x16x32_bf16 v[24:27], v[36:39], v[128:131], v[24:27]
  ds_read_b64_tr_b16 v[36:37], v3 offset:63488
  s_add_u32 m0, s33, 49152
  v_mfma_f32_16x16x32_bf16 v[24:27], v[40:43], v[136:139], v[24:27]
  ds_read_b64_tr_b16 v[38:39], v4 offset:6144
  s_add_u32 s39, s49, s41
  v_mfma_f32_16x16x32_bf16 v[24:27], v[44:47], v[144:147], v[24:27]
  ds_read_b64_tr_b16 v[40:41], v4 offset:8192
  v_mfma_f32_16x16x32_bf16 v[24:27], v[48:51], v[152:155], v[24:27]
  ds_read_b64_tr_b16 v[42:43], v4 offset:16384
  buffer_load_dwordx4 v9, s[12:15], s39 offen lds
  v_cvt_pk_bf16_f32 v59, v22, v23
  s_nop 0
  v_permlane16_swap_b32 v56, v58
  v_permlane16_swap_b32 v57, v59
  s_lshl_b32 s40, s47, 11
  s_add_u32 s40, s40, s53
  v_and_b32 v56, -2, v56
  buffer_store_dwordx4 v[56:59], v11, s[24:27], s40 offen sc1
  s_lshl1_add_u32 s38, s46, s62
  buffer_store_dword v8, v12, s[24:27], s38 offen sc1
  s_waitcnt lgkmcnt(2)
  v_mfma_f32_16x16x32_bf16 v[28:31], v[44:47], v[148:151], v[28:31]
  ds_read_b64_tr_b16 v[44:45], v4 offset:10240
  s_add_u32 m0, s33, 57344
  v_mfma_f32_16x16x32_bf16 v[28:31], v[48:51], v[156:159], v[28:31]
  ds_read_b64_tr_b16 v[46:47], v4 offset:18432
  s_add_u32 s39, s49, s42
  v_mfma_f32_16x16x32_bf16 v[28:31], v[32:35], v[164:167], v[28:31]
  ds_read_b64_tr_b16 v[48:49], v4 offset:12288
  v_mfma_f32_16x16x32_bf16 v[28:31], v[36:39], v[172:175], v[28:31]
  ds_read_b64_tr_b16 v[50:51], v4 offset:20480
  buffer_load_dwordx4 v9, s[12:15], s39 offen lds
  s_movk_i32 s72, 0x3f80
  s_lshl_b32 s73, s72, 16
  v_bfrev_b32 v111, 1
  s_lshr_b32 s34, s77, 3
  s_cmp_eq_u32 s34, 8
  s_cselect_b32 s34, s31, s34
  s_cselect_b32 s35, 0, s31
  s_lshl_b32 s34, s34, 7
  s_add_u32 s34, s34, 27262976
  v_and_b32 v61, 31, v1
  s_cmp_eq_u32 s35, 0
  s_cselect_b32 s34, s34, 0x80000000
  s_cselect_b32 s63, s3, 0
  v_lshl_add_u32 v61, v61, 2, s34
  s_waitcnt vmcnt(9)
  v_cmp_ne_u32 vcc, s3, v68
  s_cbranch_vccnz parallel_sum__ssm_conv_h3__dense_activation_gelu__prompt_kernel_Z_pf4
parallel_sum__ssm_conv_h3__dense_activation_gelu__prompt_kernel_Z_pf4b:
  s_lshl_b32 s38, s28, 31
  v_or_b32 v14, s38, v11
  s_lshl_b32 s40, s48, 11
  s_add_u32 s40, s40, s53
  buffer_load_dwordx4 v[64:67], v14, s[24:27], s40 offen
  s_mul_i32 s8, s31, 8704
  s_lshl3_add_u32 s9, s77, s31
  s_lshl_b32 s9, s9, 12
  s_waitcnt lgkmcnt(2)
  v_mfma_f32_16x16x32_bf16 v[24:27], v[32:35], v[160:163], v[24:27]
  ds_read_b64_tr_b16 v[32:33], v4 offset:14336
  s_add_u32 m0, s33, 65536
  v_mfma_f32_16x16x32_bf16 v[24:27], v[36:39], v[168:171], v[24:27]
  ds_read_b64_tr_b16 v[34:35], v4 offset:22528
  s_add_u32 s39, s49, s43
  v_mfma_f32_16x16x32_bf16 v[24:27], v[40:43], v[176:179], v[24:27]
  ds_read_b64_tr_b16 v[36:37], v4 offset:24576
  v_mfma_f32_16x16x32_bf16 v[24:27], v[44:47], v[184:187], v[24:27]
  ds_read_b64_tr_b16 v[38:39], v3 offset:32768
  buffer_load_dwordx4 v9, s[12:15], s39 offen lds
  v_and_b32 v110, v111, v72
  v_lshl_or_b32 v110, v1, 4, v110
  v_lshl_add_u32 v10, v1, 2, s8
  s_add_u32 s34, s8, 4608
  v_lshl_add_u32 v7, v1, 1, s34
  v_lshrrev_b32 v15, 4, v1
  v_bfe_u32 v5, v1, 2, 2
  v_lshl_add_u32 v15, v15, 3, v5
  v_and_b32 v6, 3, v1
  v_add_u32 v5, v15, v6
  s_add_u32 s34, s8, 232
  v_lshl_add_u32 v5, v5, 3, s34
  s_waitcnt lgkmcnt(2)
  v_mfma_f32_16x16x32_bf16 v[28:31], v[40:43], v[180:183], v[28:31]
  ds_read_b64_tr_b16 v[40:41], v4 offset:26624
  s_add_u32 m0, s33, 106496
  v_mfma_f32_16x16x32_bf16 v[28:31], v[44:47], v[188:191], v[28:31]
  ds_read_b64_tr_b16 v[42:43], v3 offset:34816
  s_add_u32 s39, s50, s16
  v_mfma_f32_16x16x32_bf16 v[28:31], v[48:51], v[196:199], v[28:31]
  ds_read_b64_tr_b16 v[44:45], v4 offset:28672
  v_mfma_f32_16x16x32_bf16 v[28:31], v[32:35], v[204:207], v[28:31]
  ds_read_b64_tr_b16 v[46:47], v3 offset:36864
  buffer_load_dwordx4 v9, s[12:15], s39 offen lds
  v_lshlrev_b32 v6, 2, v6
  v_sub_u32 v6, v6, v15
  s_add_u32 s34, s8, 4600
  v_lshl_add_u32 v6, v6, 3, s34
  s_lshl_b32 s34, s32, 4
  s_lshr_b64 s[20:21], s[20:21], s34
  s_lshr_b64 s[22:23], s[22:23], s34
  s_and_b32 s74, s20, 0xffff
  s_and_b32 s79, s22, 0xffff
  s_lshl1_add_u32 s38, s49, s56
  buffer_load_dword v68, off, s[24:27], s38 sc1
  s_lshl_b32 s34, s92, 10
  v_add_u32 v52, s34, v110
  v_ashrrev_i32 v53, 1, v52
  s_waitcnt lgkmcnt(2)
  v_mfma_f32_16x16x32_bf16 v[24:27], v[48:51], v[192:195], v[24:27]
  ds_read_b64_tr_b16 v[48:49], v4 offset:30720
  s_add_u32 m0, s33, 114688
  v_mfma_f32_16x16x32_bf16 v[24:27], v[32:35], v[200:203], v[24:27]
  ds_read_b64_tr_b16 v[50:51], v3 offset:38912
  s_add_u32 s39, s50, s17
  v_mfma_f32_16x16x32_bf16 v[24:27], v[36:39], v[208:211], v[24:27]
  ds_read_b64_tr_b16 v[32:33], v3 offset:24576
  v_mfma_f32_16x16x32_bf16 v[24:27], v[40:43], v[216:219], v[24:27]
  ds_read_b64_tr_b16 v[34:35], v3 offset:26624
  s_waitcnt vmcnt(10)
  s_barrier
  buffer_load_dwordx4 v9, s[12:15], s39 offen lds
  s_lshl_b32 s34, s93, 10
  s_andn2_b32 s35, 0x80000000, s57
  s_or_b32 s34, s34, s35
  v_lshl_add_u32 v54, v1, 4, s34
  v_ashrrev_i32 v55, 1, v54
  v_add_u32 v54, 0x8000, v54
  s_sub_u32 s34, s93, s92
  v_bfe_u32 v75, v1, 4, 1
  v_mul_i32_i24 v74, s34, v75
  v_add_u32 v74, s92, v74
  v_mul_u32_u24 v74, 2304, v74
  s_waitcnt lgkmcnt(2)
  v_mfma_f32_16x16x32_bf16 v[28:31], v[36:39], v[212:215], v[28:31]
  ds_read_b64_tr_b16 v[36:37], v3 offset:28672
  s_add_u32 m0, s33, 122880
  v_mfma_f32_16x16x32_bf16 v[28:31], v[40:43], v[220:223], v[28:31]
  ds_read_b64_tr_b16 v[38:39], v3 offset:30720
  s_add_u32 s39, s50, s18
  v_mfma_f32_16x16x32_bf16 v[28:31], v[44:47], v[228:231], v[28:31]
  ds_read_b64_tr_b16 v[40:41], v2 offset:0
  v_mfma_f32_16x16x32_bf16 v[28:31], v[48:51], v[236:239], v[28:31]
  ds_read_b64_tr_b16 v[42:43], v2 offset:8192
  buffer_load_dwordx4 v9, s[12:15], s39 offen lds
  s_lshr_b32 s10, s77, 3
  s_lshr_b32 s34, s0, 1
  s_cmp_lt_u32 s10, s34
  s_cselect_b32 s23, 9, 0
  s_sub_u32 s34, s23, s34
  s_lshr_b32 s35, s1, 1
  s_cmp_lt_u32 s10, s35
  s_cselect_b32 s23, 9, 0
  s_sub_u32 s35, s23, s35
  s_sub_u32 s35, s35, s34
  s_xor_b32 s23, s0, s1
  v_and_b32 v15, s23, v75
  v_mul_i32_i24 v75, s35, v75
  v_add_u32 v75, s34, v75
  s_waitcnt lgkmcnt(2)
  v_mfma_f32_16x16x32_bf16 v[24:27], v[44:47], v[224:227], v[24:27]
  ds_read_b64_tr_b16 v[44:45], v2 offset:2048
  s_add_u32 m0, s33, 131072
  v_mfma_f32_16x16x32_bf16 v[24:27], v[48:51], v[232:235], v[24:27]
  ds_read_b64_tr_b16 v[46:47], v2 offset:10240
  s_add_u32 s39, s50, s19
  v_mfma_f32_16x16x32_bf16 v[24:27], v[32:35], v[240:243], v[24:27]
  ds_read_b64_tr_b16 v[48:49], v2 offset:4096
  v_mfma_f32_16x16x32_bf16 v[24:27], v[36:39], v[248:251], v[24:27]
  ds_read_b64_tr_b16 v[50:51], v2 offset:12288
  buffer_load_dwordx4 v9, s[12:15], s39 offen lds
  v_xor_b32 v15, s0, v15
  v_xnor_b32 v15, v1, v15
  v_bfe_i32 v15, v15, 0, 1
  v_and_b32 v75, v15, v75
  v_add_u32 v75, s10, v75
  v_lshl_add_u32 v74, v75, 8, v74
  v_and_b32 v15, 7, v1
  v_lshl_add_u32 v74, v15, 2, v74
  s_mov_b32 s10, 26214400
  s_lshl_b32 s11, s77, 15
  s_mov_b32 s23, 25165824
  s_add_u32 s30, s11, 29360128
  s_waitcnt lgkmcnt(2)
  v_mfma_f32_16x16x32_bf16 v[28:31], v[32:35], v[244:247], v[28:31]
  ds_read_b64_tr_b16 v[32:33], v2 offset:6144
  s_add_u32 m0, s33, 139264
  v_mfma_f32_16x16x32_bf16 v[28:31], v[36:39], v[252:255], v[28:31]
  ds_read_b64_tr_b16 v[34:35], v2 offset:14336
  s_add_u32 s39, s50, s36
  v_mfma_f32_16x16x32_bf16 v[16:19], v[40:43], v[112:115], 0
  ds_read_b64_tr_b16 v[36:37], v2 offset:16384
  v_mfma_f32_16x16x32_bf16 v[16:19], v[44:47], v[120:123], v[16:19]
  ds_read_b64_tr_b16 v[38:39], v2 offset:24576
  buffer_load_dwordx4 v9, s[12:15], s39 offen lds
  s_add_u32 s22, s11, 7077888
  s_add_u32 s21, s11, 4718592
  s_add_u32 s20, s11, 2359296
  s_lshl_b32 s64, s96, 16
  s_and_b32 s65, s96, 0xffff0000
  s_lshl_b32 s66, s97, 16
  s_and_b32 s67, s97, 0xffff0000
  s_lshl_b32 s68, s98, 16
  s_and_b32 s69, s98, 0xffff0000
  s_lshl_b32 s70, s99, 16
  s_and_b32 s71, s99, 0xffff0000
  s_waitcnt lgkmcnt(2)
  v_mfma_f32_16x16x32_bf16 v[20:23], v[40:43], v[116:119], 0
  ds_read_b64_tr_b16 v[40:41], v2 offset:18432
  s_add_u32 m0, s33, 147456
  v_mfma_f32_16x16x32_bf16 v[20:23], v[44:47], v[124:127], v[20:23]
  ds_read_b64_tr_b16 v[42:43], v2 offset:26624
  s_add_u32 s39, s50, s37
  v_mfma_f32_16x16x32_bf16 v[20:23], v[48:51], v[132:135], v[20:23]
  ds_read_b64_tr_b16 v[44:45], v2 offset:20480
  v_mfma_f32_16x16x32_bf16 v[20:23], v[32:35], v[140:143], v[20:23]
  ds_read_b64_tr_b16 v[46:47], v2 offset:28672
  s_waitcnt vmcnt(6)
  s_barrier
  buffer_load_dwordx4 v9, s[12:15], s39 offen lds
  v_permlane16_swap_b32 v64, v66
  v_permlane16_swap_b32 v65, v67
  v_dot2c_f32_bf16 v24, s72, v64
  v_dot2c_f32_bf16 v25, s73, v64
  v_dot2c_f32_bf16 v28, s72, v66
  v_dot2c_f32_bf16 v29, s73, v66
  v_dot2c_f32_bf16 v26, s72, v65
  v_dot2c_f32_bf16 v27, s73, v65
  v_dot2c_f32_bf16 v30, s72, v67
  v_dot2c_f32_bf16 v31, s73, v67
  s_lshl_b32 s38, s28, 16
  v_and_b32 v56, s38, v63
  v_add_u32 v24, v24, v56
  v_add_u32 v28, v28, v56
  v_xor_b32 v56, v56, v63
  v_and_or_b32 v24, v24, v62, v56
  s_waitcnt lgkmcnt(2)
  v_mfma_f32_16x16x32_bf16 v[16:19], v[48:51], v[128:131], v[16:19]
  ds_read_b64_tr_b16 v[48:49], v2 offset:22528
  s_add_u32 m0, s33, 155648
  v_mfma_f32_16x16x32_bf16 v[16:19], v[32:35], v[136:139], v[16:19]
  ds_read_b64_tr_b16 v[50:51], v2 offset:30720
  s_add_u32 s39, s50, s41
  v_mfma_f32_16x16x32_bf16 v[16:19], v[36:39], v[144:147], v[16:19]
  ds_read_b64_tr_b16 v[32:33], v2 offset:32768
  v_mfma_f32_16x16x32_bf16 v[16:19], v[40:43], v[152:155], v[16:19]
  ds_read_b64_tr_b16 v[34:35], v2 offset:40960
  buffer_load_dwordx4 v9, s[12:15], s39 offen lds
  v_and_or_b32 v28, v28, v62, v56
  v_cvt_pk_bf16_f32 v56, v24, v25
  v_cvt_pk_bf16_f32 v57, v26, v27
  v_cvt_pk_bf16_f32 v58, v28, v29
  v_cvt_pk_bf16_f32 v59, v30, v31
  s_nop 0
  v_permlane16_swap_b32 v56, v58
  v_permlane16_swap_b32 v57, v59
  s_lshl_b32 s40, s48, 11
  s_add_u32 s40, s40, s53
  s_andn2_b32 s38, 1, s28
  v_and_or_b32 v56, v56, -2, s38
  buffer_store_dwordx4 v[56:59], v11, s[24:27], s40 offen sc1
  s_lshl1_add_u32 s38, s47, s62
  buffer_store_dword v8, v12, s[24:27], s38 offen sc1
  s_waitcnt lgkmcnt(2)
  v_mfma_f32_16x16x32_bf16 v[20:23], v[36:39], v[148:151], v[20:23]
  ds_read_b64_tr_b16 v[36:37], v2 offset:34816
  s_add_u32 m0, s33, 98304
  v_mfma_f32_16x16x32_bf16 v[20:23], v[40:43], v[156:159], v[20:23]
  ds_read_b64_tr_b16 v[38:39], v2 offset:43008
  s_add_u32 s39, s50, s42
  v_mfma_f32_16x16x32_bf16 v[20:23], v[44:47], v[164:167], v[20:23]
  ds_read_b64_tr_b16 v[40:41], v2 offset:36864
  v_mfma_f32_16x16x32_bf16 v[20:23], v[48:51], v[172:175], v[20:23]
  ds_read_b64_tr_b16 v[42:43], v2 offset:45056
  buffer_load_dwordx4 v9, s[12:15], s39 offen lds
  s_waitcnt vmcnt(9)
  v_cmp_ne_u32 vcc, s3, v68
  s_cbranch_vccnz parallel_sum__ssm_conv_h3__dense_activation_gelu__prompt_kernel_Z_pf5
parallel_sum__ssm_conv_h3__dense_activation_gelu__prompt_kernel_Z_pf5b:
  s_lshl_b32 s40, s49, 11
  s_add_u32 s40, s40, s53
  buffer_load_dwordx4 v[64:67], v11, s[24:27], s40 offen
  s_waitcnt lgkmcnt(2)
  v_mfma_f32_16x16x32_bf16 v[16:19], v[44:47], v[160:163], v[16:19]
  ds_read_b64_tr_b16 v[44:45], v2 offset:38912
  s_add_u32 m0, s33, 90112
  v_mfma_f32_16x16x32_bf16 v[16:19], v[48:51], v[168:171], v[16:19]
  ds_read_b64_tr_b16 v[46:47], v2 offset:47104
  s_add_u32 s39, s50, s43
  v_mfma_f32_16x16x32_bf16 v[16:19], v[32:35], v[176:179], v[16:19]
  ds_read_b64_tr_b16 v[48:49], v2 offset:49152
  v_mfma_f32_16x16x32_bf16 v[16:19], v[36:39], v[184:187], v[16:19]
  ds_read_b64_tr_b16 v[50:51], v2 offset:57344
  buffer_load_dwordx4 v9, s[12:15], s39 offen lds
  s_waitcnt lgkmcnt(2)
  v_mfma_f32_16x16x32_bf16 v[20:23], v[32:35], v[180:183], v[20:23]
  ds_read_b64_tr_b16 v[32:33], v2 offset:51200
  s_add_u32 m0, s33, 0
  v_mfma_f32_16x16x32_bf16 v[20:23], v[36:39], v[188:191], v[20:23]
  ds_read_b64_tr_b16 v[34:35], v2 offset:59392
  s_add_u32 s39, s51, s16
  v_mfma_f32_16x16x32_bf16 v[20:23], v[40:43], v[196:199], v[20:23]
  ds_read_b64_tr_b16 v[36:37], v2 offset:53248
  v_mfma_f32_16x16x32_bf16 v[20:23], v[44:47], v[204:207], v[20:23]
  ds_read_b64_tr_b16 v[38:39], v2 offset:61440
  buffer_load_dwordx4 v9, s[12:15], s39 offen lds
  s_lshl1_add_u32 s38, s50, s56
  buffer_load_dword v68, off, s[24:27], s38 sc1
  s_waitcnt lgkmcnt(2)
  v_mfma_f32_16x16x32_bf16 v[16:19], v[40:43], v[192:195], v[16:19]
  ds_read_b64_tr_b16 v[40:41], v2 offset:55296
  s_add_u32 m0, s33, 8192
  v_mfma_f32_16x16x32_bf16 v[16:19], v[44:47], v[200:203], v[16:19]
  ds_read_b64_tr_b16 v[42:43], v2 offset:63488
  s_add_u32 s39, s51, s17
  v_mfma_f32_16x16x32_bf16 v[16:19], v[48:51], v[208:211], v[16:19]
  ds_read_b64_tr_b16 v[44:45], v3 offset:0
  v_mfma_f32_16x16x32_bf16 v[16:19], v[32:35], v[216:219], v[16:19]
  ds_read_b64_tr_b16 v[46:47], v3 offset:2048
  s_waitcnt vmcnt(10)
  s_barrier
  buffer_load_dwordx4 v9, s[12:15], s39 offen lds
  s_waitcnt lgkmcnt(2)
  v_mfma_f32_16x16x32_bf16 v[20:23], v[48:51], v[212:215], v[20:23]
  ds_read_b64_tr_b16 v[48:49], v3 offset:4096
  s_add_u32 m0, s33, 16384
  v_mfma_f32_16x16x32_bf16 v[20:23], v[32:35], v[220:223], v[20:23]
  ds_read_b64_tr_b16 v[50:51], v3 offset:6144
  s_add_u32 s39, s51, s18
  v_mfma_f32_16x16x32_bf16 v[20:23], v[36:39], v[228:231], v[20:23]
  ds_read_b64_tr_b16 v[32:33], v3 offset:40960
  v_mfma_f32_16x16x32_bf16 v[20:23], v[40:43], v[236:239], v[20:23]
  ds_read_b64_tr_b16 v[34:35], v3 offset:49152
  buffer_load_dwordx4 v9, s[12:15], s39 offen lds
  s_waitcnt lgkmcnt(2)
  v_mfma_f32_16x16x32_bf16 v[16:19], v[36:39], v[224:227], v[16:19]
  ds_read_b64_tr_b16 v[36:37], v3 offset:43008
  s_add_u32 m0, s33, 24576
  v_mfma_f32_16x16x32_bf16 v[16:19], v[40:43], v[232:235], v[16:19]
  ds_read_b64_tr_b16 v[38:39], v3 offset:51200
  s_add_u32 s39, s51, s19
  v_mfma_f32_16x16x32_bf16 v[16:19], v[44:47], v[240:243], v[16:19]
  ds_read_b64_tr_b16 v[40:41], v3 offset:45056
  v_mfma_f32_16x16x32_bf16 v[16:19], v[48:51], v[248:251], v[16:19]
  ds_read_b64_tr_b16 v[42:43], v3 offset:53248
  buffer_load_dwordx4 v9, s[12:15], s39 offen lds
  s_waitcnt lgkmcnt(2)
  v_mfma_f32_16x16x32_bf16 v[20:23], v[44:47], v[244:247], v[20:23]
  ds_read_b64_tr_b16 v[44:45], v3 offset:47104
  s_add_u32 m0, s33, 32768
  v_mfma_f32_16x16x32_bf16 v[20:23], v[48:51], v[252:255], v[20:23]
  ds_read_b64_tr_b16 v[46:47], v3 offset:55296
  s_add_u32 s39, s51, s36
  v_mfma_f32_16x16x32_bf16 v[24:27], v[32:35], v[112:115], 0
  ds_read_b64_tr_b16 v[48:49], v3 offset:57344
  v_mfma_f32_16x16x32_bf16 v[24:27], v[36:39], v[120:123], v[24:27]
  ds_read_b64_tr_b16 v[50:51], v4 offset:0
  buffer_load_dwordx4 v9, s[12:15], s39 offen lds
  s_waitcnt lgkmcnt(2)
  v_mfma_f32_16x16x32_bf16 v[28:31], v[32:35], v[116:119], 0
  ds_read_b64_tr_b16 v[32:33], v3 offset:59392
  s_add_u32 m0, s33, 40960
  v_mfma_f32_16x16x32_bf16 v[28:31], v[36:39], v[124:127], v[28:31]
  ds_read_b64_tr_b16 v[34:35], v4 offset:2048
  s_add_u32 s39, s51, s37
  v_mfma_f32_16x16x32_bf16 v[28:31], v[40:43], v[132:135], v[28:31]
  ds_read_b64_tr_b16 v[36:37], v3 offset:61440
  v_mfma_f32_16x16x32_bf16 v[28:31], v[44:47], v[140:143], v[28:31]
  ds_read_b64_tr_b16 v[38:39], v4 offset:4096
  s_waitcnt vmcnt(6)
  s_barrier
  buffer_load_dwordx4 v9, s[12:15], s39 offen lds
  v_permlane16_swap_b32 v64, v66
  v_permlane16_swap_b32 v65, v67
  v_dot2c_f32_bf16 v16, s72, v64
  v_dot2c_f32_bf16 v17, s73, v64
  v_dot2c_f32_bf16 v20, s72, v66
  v_dot2c_f32_bf16 v21, s73, v66
  v_dot2c_f32_bf16 v18, s72, v65
  v_dot2c_f32_bf16 v19, s73, v65
  v_dot2c_f32_bf16 v22, s72, v67
  v_dot2c_f32_bf16 v23, s73, v67
  v_and_or_b32 v16, v16, v62, v63
  v_and_or_b32 v20, v20, v62, v63
  v_cvt_pk_bf16_f32 v56, v16, v17
  s_waitcnt lgkmcnt(2)
  v_mfma_f32_16x16x32_bf16 v[24:27], v[40:43], v[128:131], v[24:27]
  ds_read_b64_tr_b16 v[40:41], v3 offset:63488
  s_add_u32 m0, s33, 49152
  v_mfma_f32_16x16x32_bf16 v[24:27], v[44:47], v[136:139], v[24:27]
  ds_read_b64_tr_b16 v[42:43], v4 offset:6144
  s_add_u32 s39, s51, s41
  v_mfma_f32_16x16x32_bf16 v[24:27], v[48:51], v[144:147], v[24:27]
  ds_read_b64_tr_b16 v[44:45], v4 offset:8192
  v_mfma_f32_16x16x32_bf16 v[24:27], v[32:35], v[152:155], v[24:27]
  ds_read_b64_tr_b16 v[46:47], v4 offset:16384
  buffer_load_dwordx4 v9, s[12:15], s39 offen lds
  v_cvt_pk_bf16_f32 v57, v18, v19
  v_cvt_pk_bf16_f32 v58, v20, v21
  v_cvt_pk_bf16_f32 v59, v22, v23
  s_nop 0
  v_permlane16_swap_b32 v56, v58
  v_permlane16_swap_b32 v57, v59
  s_lshl_b32 s40, s49, 11
  s_add_u32 s40, s40, s53
  v_or_b32 v56, 1, v56
  buffer_store_dwordx4 v[56:59], v11, s[24:27], s40 offen sc1
  s_lshl1_add_u32 s38, s48, s62
  buffer_store_dword v8, v12, s[24:27], s38 offen sc1
  s_waitcnt lgkmcnt(2)
  v_mfma_f32_16x16x32_bf16 v[28:31], v[48:51], v[148:151], v[28:31]
  ds_read_b64_tr_b16 v[48:49], v4 offset:10240
  s_add_u32 m0, s33, 57344
  v_mfma_f32_16x16x32_bf16 v[28:31], v[32:35], v[156:159], v[28:31]
  ds_read_b64_tr_b16 v[50:51], v4 offset:18432
  s_add_u32 s39, s51, s42
  v_mfma_f32_16x16x32_bf16 v[28:31], v[36:39], v[164:167], v[28:31]
  ds_read_b64_tr_b16 v[32:33], v4 offset:12288
  v_mfma_f32_16x16x32_bf16 v[28:31], v[40:43], v[172:175], v[28:31]
  ds_read_b64_tr_b16 v[34:35], v4 offset:20480
  buffer_load_dwordx4 v9, s[12:15], s39 offen lds
  s_waitcnt vmcnt(9)
  v_cmp_ne_u32 vcc, s3, v68
  s_cbranch_vccnz parallel_sum__ssm_conv_h3__dense_activation_gelu__prompt_kernel_Z_pf6
parallel_sum__ssm_conv_h3__dense_activation_gelu__prompt_kernel_Z_pf6b:
  s_lshl_b32 s40, s50, 11
  s_add_u32 s40, s40, s53
  buffer_load_dwordx4 v[64:67], v11, s[24:27], s40 offen
  s_waitcnt lgkmcnt(2)
  v_mfma_f32_16x16x32_bf16 v[24:27], v[36:39], v[160:163], v[24:27]
  ds_read_b64_tr_b16 v[36:37], v4 offset:14336
  s_add_u32 m0, s33, 65536
  v_mfma_f32_16x16x32_bf16 v[24:27], v[40:43], v[168:171], v[24:27]
  ds_read_b64_tr_b16 v[38:39], v4 offset:22528
  s_add_u32 s39, s51, s43
  v_mfma_f32_16x16x32_bf16 v[24:27], v[44:47], v[176:179], v[24:27]
  ds_read_b64_tr_b16 v[40:41], v4 offset:24576
  v_mfma_f32_16x16x32_bf16 v[24:27], v[48:51], v[184:187], v[24:27]
  ds_read_b64_tr_b16 v[42:43], v3 offset:32768
  buffer_load_dwordx4 v9, s[12:15], s39 offen lds
  s_add_u32 m0, s33, 106496
  s_add_u32 s39, s52, s16
  buffer_load_dwordx4 v9, s[12:15], s39 offen lds
  s_waitcnt lgkmcnt(2)
  v_mfma_f32_16x16x32_bf16 v[28:31], v[44:47], v[180:183], v[28:31]
  ds_read_b64_tr_b16 v[44:45], v4 offset:26624
  s_add_u32 m0, s33, 114688
  v_mfma_f32_16x16x32_bf16 v[28:31], v[48:51], v[188:191], v[28:31]
  ds_read_b64_tr_b16 v[46:47], v3 offset:34816
  s_add_u32 s39, s52, s17
  v_mfma_f32_16x16x32_bf16 v[28:31], v[32:35], v[196:199], v[28:31]
  ds_read_b64_tr_b16 v[48:49], v4 offset:28672
  v_mfma_f32_16x16x32_bf16 v[28:31], v[36:39], v[204:207], v[28:31]
  ds_read_b64_tr_b16 v[50:51], v3 offset:36864
  buffer_load_dwordx4 v9, s[12:15], s39 offen lds
  s_lshl1_add_u32 s38, s51, s56
  buffer_load_dword v68, off, s[24:27], s38 sc1
  s_waitcnt lgkmcnt(2)
  v_mfma_f32_16x16x32_bf16 v[24:27], v[32:35], v[192:195], v[24:27]
  ds_read_b64_tr_b16 v[32:33], v4 offset:30720
  s_add_u32 m0, s33, 122880
  v_mfma_f32_16x16x32_bf16 v[24:27], v[36:39], v[200:203], v[24:27]
  ds_read_b64_tr_b16 v[34:35], v3 offset:38912
  s_add_u32 s39, s52, s18
  v_mfma_f32_16x16x32_bf16 v[24:27], v[40:43], v[208:211], v[24:27]
  ds_read_b64_tr_b16 v[36:37], v3 offset:24576
  v_mfma_f32_16x16x32_bf16 v[24:27], v[44:47], v[216:219], v[24:27]
  ds_read_b64_tr_b16 v[38:39], v3 offset:26624
  s_waitcnt vmcnt(11)
  s_barrier
  buffer_load_dwordx4 v9, s[12:15], s39 offen lds
  s_waitcnt lgkmcnt(2)
  v_mfma_f32_16x16x32_bf16 v[28:31], v[40:43], v[212:215], v[28:31]
  ds_read_b64_tr_b16 v[40:41], v3 offset:28672
  s_add_u32 m0, s33, 131072
  v_mfma_f32_16x16x32_bf16 v[28:31], v[44:47], v[220:223], v[28:31]
  ds_read_b64_tr_b16 v[42:43], v3 offset:30720
  s_add_u32 s39, s52, s19
  v_mfma_f32_16x16x32_bf16 v[28:31], v[48:51], v[228:231], v[28:31]
  ds_read_b64_tr_b16 v[44:45], v2 offset:0
  v_mfma_f32_16x16x32_bf16 v[28:31], v[32:35], v[236:239], v[28:31]
  ds_read_b64_tr_b16 v[46:47], v2 offset:8192
  buffer_load_dwordx4 v9, s[12:15], s39 offen lds
  s_waitcnt lgkmcnt(2)
  v_mfma_f32_16x16x32_bf16 v[24:27], v[48:51], v[224:227], v[24:27]
  ds_read_b64_tr_b16 v[48:49], v2 offset:2048
  s_add_u32 m0, s33, 139264
  v_mfma_f32_16x16x32_bf16 v[24:27], v[32:35], v[232:235], v[24:27]
  ds_read_b64_tr_b16 v[50:51], v2 offset:10240
  s_add_u32 s39, s52, s36
  v_mfma_f32_16x16x32_bf16 v[24:27], v[36:39], v[240:243], v[24:27]
  ds_read_b64_tr_b16 v[32:33], v2 offset:4096
  v_mfma_f32_16x16x32_bf16 v[24:27], v[40:43], v[248:251], v[24:27]
  ds_read_b64_tr_b16 v[34:35], v2 offset:12288
  buffer_load_dwordx4 v9, s[12:15], s39 offen lds
  s_waitcnt lgkmcnt(2)
  v_mfma_f32_16x16x32_bf16 v[28:31], v[36:39], v[244:247], v[28:31]
  ds_read_b64_tr_b16 v[36:37], v2 offset:6144
  s_add_u32 m0, s33, 147456
  v_mfma_f32_16x16x32_bf16 v[28:31], v[40:43], v[252:255], v[28:31]
  ds_read_b64_tr_b16 v[38:39], v2 offset:14336
  s_add_u32 s39, s52, s37
  v_mfma_f32_16x16x32_bf16 v[16:19], v[44:47], v[112:115], 0
  ds_read_b64_tr_b16 v[40:41], v2 offset:16384
  v_mfma_f32_16x16x32_bf16 v[16:19], v[48:51], v[120:123], v[16:19]
  ds_read_b64_tr_b16 v[42:43], v2 offset:24576
  buffer_load_dwordx4 v9, s[12:15], s39 offen lds
  s_waitcnt lgkmcnt(2)
  v_mfma_f32_16x16x32_bf16 v[20:23], v[44:47], v[116:119], 0
  ds_read_b64_tr_b16 v[44:45], v2 offset:18432
  s_add_u32 m0, s33, 155648
  v_mfma_f32_16x16x32_bf16 v[20:23], v[48:51], v[124:127], v[20:23]
  ds_read_b64_tr_b16 v[46:47], v2 offset:26624
  s_add_u32 s39, s52, s41
  v_mfma_f32_16x16x32_bf16 v[20:23], v[32:35], v[132:135], v[20:23]
  ds_read_b64_tr_b16 v[48:49], v2 offset:20480
  v_mfma_f32_16x16x32_bf16 v[20:23], v[36:39], v[140:143], v[20:23]
  ds_read_b64_tr_b16 v[50:51], v2 offset:28672
  s_waitcnt vmcnt(5)
  s_barrier
  buffer_load_dwordx4 v9, s[12:15], s39 offen lds
  v_permlane16_swap_b32 v64, v66
  v_permlane16_swap_b32 v65, v67
  v_dot2c_f32_bf16 v24, s72, v64
  v_dot2c_f32_bf16 v25, s73, v64
  v_dot2c_f32_bf16 v28, s72, v66
  v_dot2c_f32_bf16 v29, s73, v66
  v_dot2c_f32_bf16 v26, s72, v65
  v_dot2c_f32_bf16 v27, s73, v65
  v_dot2c_f32_bf16 v30, s72, v67
  v_dot2c_f32_bf16 v31, s73, v67
  v_and_or_b32 v24, v24, v62, v63
  v_and_or_b32 v28, v28, v62, v63
  v_cvt_pk_bf16_f32 v56, v24, v25
  s_waitcnt lgkmcnt(2)
  v_mfma_f32_16x16x32_bf16 v[16:19], v[32:35], v[128:131], v[16:19]
  ds_read_b64_tr_b16 v[32:33], v2 offset:22528
  s_add_u32 m0, s33, 98304
  v_mfma_f32_16x16x32_bf16 v[16:19], v[36:39], v[136:139], v[16:19]
  ds_read_b64_tr_b16 v[34:35], v2 offset:30720
  s_add_u32 s39, s52, s42
  v_mfma_f32_16x16x32_bf16 v[16:19], v[40:43], v[144:147], v[16:19]
  ds_read_b64_tr_b16 v[36:37], v2 offset:32768
  v_mfma_f32_16x16x32_bf16 v[16:19], v[44:47], v[152:155], v[16:19]
  ds_read_b64_tr_b16 v[38:39], v2 offset:40960
  buffer_load_dwordx4 v9, s[12:15], s39 offen lds
  v_cvt_pk_bf16_f32 v57, v26, v27
  v_cvt_pk_bf16_f32 v58, v28, v29
  v_cvt_pk_bf16_f32 v59, v30, v31
  s_nop 0
  v_permlane16_swap_b32 v56, v58
  v_permlane16_swap_b32 v57, v59
  buffer_load_dword v60, v61, s[24:27], 0 offen sc1
  s_lshl_b32 s40, s50, 11
  s_add_u32 s40, s40, s53
  v_or_b32 v56, 1, v56
  buffer_store_dwordx4 v[56:59], v11, s[24:27], s40 offen sc1
  s_waitcnt lgkmcnt(2)
  v_mfma_f32_16x16x32_bf16 v[20:23], v[40:43], v[148:151], v[20:23]
  ds_read_b64_tr_b16 v[40:41], v2 offset:34816
  s_add_u32 m0, s33, 90112
  v_mfma_f32_16x16x32_bf16 v[20:23], v[44:47], v[156:159], v[20:23]
  ds_read_b64_tr_b16 v[42:43], v2 offset:43008
  s_add_u32 s39, s52, s43
  v_mfma_f32_16x16x32_bf16 v[20:23], v[48:51], v[164:167], v[20:23]
  ds_read_b64_tr_b16 v[44:45], v2 offset:36864
  v_mfma_f32_16x16x32_bf16 v[20:23], v[32:35], v[172:175], v[20:23]
  ds_read_b64_tr_b16 v[46:47], v2 offset:45056
  buffer_load_dwordx4 v9, s[12:15], s39 offen lds
  s_waitcnt vmcnt(9)
  v_cmp_ne_u32 vcc, s3, v68
  s_cbranch_vccnz parallel_sum__ssm_conv_h3__dense_activation_gelu__prompt_kernel_Z_pf7
parallel_sum__ssm_conv_h3__dense_activation_gelu__prompt_kernel_Z_pf7b:
  s_lshl_b32 s40, s51, 11
  s_add_u32 s40, s40, s53
  buffer_load_dwordx4 v[64:67], v11, s[24:27], s40 offen
  s_waitcnt lgkmcnt(2)
  v_mfma_f32_16x16x32_bf16 v[16:19], v[48:51], v[160:163], v[16:19]
  ds_read_b64_tr_b16 v[48:49], v2 offset:38912
  v_mfma_f32_16x16x32_bf16 v[16:19], v[32:35], v[168:171], v[16:19]
  ds_read_b64_tr_b16 v[50:51], v2 offset:47104
  v_mfma_f32_16x16x32_bf16 v[16:19], v[36:39], v[176:179], v[16:19]
  ds_read_b64_tr_b16 v[32:33], v2 offset:49152
  v_mfma_f32_16x16x32_bf16 v[16:19], v[40:43], v[184:187], v[16:19]
  ds_read_b64_tr_b16 v[34:35], v2 offset:57344
  s_waitcnt lgkmcnt(2)
  v_mfma_f32_16x16x32_bf16 v[20:23], v[36:39], v[180:183], v[20:23]
  ds_read_b64_tr_b16 v[36:37], v2 offset:51200
  v_mfma_f32_16x16x32_bf16 v[20:23], v[40:43], v[188:191], v[20:23]
  ds_read_b64_tr_b16 v[38:39], v2 offset:59392
  v_mfma_f32_16x16x32_bf16 v[20:23], v[44:47], v[196:199], v[20:23]
  ds_read_b64_tr_b16 v[40:41], v2 offset:53248
  v_mfma_f32_16x16x32_bf16 v[20:23], v[48:51], v[204:207], v[20:23]
  ds_read_b64_tr_b16 v[42:43], v2 offset:61440
  s_lshl1_add_u32 s38, s52, s56
  buffer_load_dword v68, off, s[24:27], s38 sc1
  s_waitcnt lgkmcnt(2)
  v_mfma_f32_16x16x32_bf16 v[16:19], v[44:47], v[192:195], v[16:19]
  ds_read_b64_tr_b16 v[44:45], v2 offset:55296
  v_mfma_f32_16x16x32_bf16 v[16:19], v[48:51], v[200:203], v[16:19]
  ds_read_b64_tr_b16 v[46:47], v2 offset:63488
  v_mfma_f32_16x16x32_bf16 v[16:19], v[32:35], v[208:211], v[16:19]
  ds_read_b64_tr_b16 v[48:49], v3 offset:0
  v_mfma_f32_16x16x32_bf16 v[16:19], v[36:39], v[216:219], v[16:19]
  ds_read_b64_tr_b16 v[50:51], v3 offset:2048
  s_waitcnt lgkmcnt(2)
  v_mfma_f32_16x16x32_bf16 v[20:23], v[32:35], v[212:215], v[20:23]
  ds_read_b64_tr_b16 v[32:33], v3 offset:4096
  v_mfma_f32_16x16x32_bf16 v[20:23], v[36:39], v[220:223], v[20:23]
  ds_read_b64_tr_b16 v[34:35], v3 offset:6144
  v_mfma_f32_16x16x32_bf16 v[20:23], v[40:43], v[228:231], v[20:23]
  ds_read_b64_tr_b16 v[36:37], v3 offset:40960
  v_mfma_f32_16x16x32_bf16 v[20:23], v[44:47], v[236:239], v[20:23]
  ds_read_b64_tr_b16 v[38:39], v3 offset:49152
  s_waitcnt lgkmcnt(2)
  v_mfma_f32_16x16x32_bf16 v[16:19], v[40:43], v[224:227], v[16:19]
  ds_read_b64_tr_b16 v[40:41], v3 offset:43008
  v_mfma_f32_16x16x32_bf16 v[16:19], v[44:47], v[232:235], v[16:19]
  ds_read_b64_tr_b16 v[42:43], v3 offset:51200
  v_mfma_f32_16x16x32_bf16 v[16:19], v[48:51], v[240:243], v[16:19]
  ds_read_b64_tr_b16 v[44:45], v3 offset:45056
  v_mfma_f32_16x16x32_bf16 v[16:19], v[32:35], v[248:251], v[16:19]
  ds_read_b64_tr_b16 v[46:47], v3 offset:53248
  s_waitcnt vmcnt(7)
  s_waitcnt vmcnt(4)
  v_cmp_ne_u32 vcc, s63, v60
  s_cbranch_vccnz parallel_sum__ssm_conv_h3__dense_activation_gelu__prompt_kernel_Z_rdy_slow
parallel_sum__ssm_conv_h3__dense_activation_gelu__prompt_kernel_Z_rdy_back:
  s_barrier
  s_cmp_eq_u32 s78, 3
  s_cselect_b32 s39, 0x80000000, 0
  v_or_b32 v14, s39, v110
  s_cselect_b32 s39, 30720, 0
  v_add_u32 v15, s39, v110
  s_add_u32 m0, s8, 4608
  s_add_u32 s39, s9, 20971520
  buffer_load_dwordx4 v14, s[24:27], s39 offen offset:3072  lds
  buffer_load_dwordx4 v15, s[24:27], s39 offen offset:2048  lds
  buffer_load_dwordx4 v14, s[24:27], s39 offen offset:1024  lds
  buffer_load_dwordx4 v110, s[24:27], s39 offen offset:0  lds
  s_add_u32 m0, s8, 256
  s_waitcnt lgkmcnt(2)
  v_mfma_f32_16x16x32_bf16 v[20:23], v[48:51], v[244:247], v[20:23]
  ds_read_b64_tr_b16 v[48:49], v3 offset:47104
  v_mfma_f32_16x16x32_bf16 v[20:23], v[32:35], v[252:255], v[20:23]
  ds_read_b64_tr_b16 v[50:51], v3 offset:55296
  v_mfma_f32_16x16x32_bf16 v[24:27], v[36:39], v[112:115], 0
  ds_read_b64_tr_b16 v[32:33], v3 offset:57344
  v_mfma_f32_16x16x32_bf16 v[24:27], v[40:43], v[120:123], v[24:27]
  ds_read_b64_tr_b16 v[34:35], v4 offset:0
  buffer_load_dwordx4 v110, s[84:87], s9 offen offset:0 lds
  buffer_load_dwordx4 v14, s[84:87], s9 offen offset:1024 lds
  buffer_load_dwordx4 v15, s[84:87], s9 offen offset:2048 lds
  s_waitcnt lgkmcnt(2)
  v_mfma_f32_16x16x32_bf16 v[28:31], v[36:39], v[116:119], 0
  ds_read_b64_tr_b16 v[36:37], v3 offset:59392
  v_mfma_f32_16x16x32_bf16 v[28:31], v[40:43], v[124:127], v[28:31]
  ds_read_b64_tr_b16 v[38:39], v4 offset:2048
  v_mfma_f32_16x16x32_bf16 v[28:31], v[44:47], v[132:135], v[28:31]
  ds_read_b64_tr_b16 v[40:41], v3 offset:61440
  v_mfma_f32_16x16x32_bf16 v[28:31], v[48:51], v[140:143], v[28:31]
  ds_read_b64_tr_b16 v[42:43], v4 offset:4096
  buffer_load_dwordx4 v14, s[84:87], s9 offen offset:3072 lds
  s_mov_b32 m0, s8
  s_waitcnt vmcnt(9)
  v_permlane16_swap_b32 v64, v66
  v_permlane16_swap_b32 v65, v67
  buffer_load_dword v111, s[84:87], 0 offen lds
  s_add_u32 m0, s8, 4352
  v_dot2c_f32_bf16 v16, s72, v64
  v_dot2c_f32_bf16 v17, s73, v64
  v_dot2c_f32_bf16 v20, s72, v66
  v_dot2c_f32_bf16 v21, s73, v66
  buffer_load_dword v111, s[84:87], 0 offen lds
  v_dot2c_f32_bf16 v18, s72, v65
  v_dot2c_f32_bf16 v19, s73, v65
  v_dot2c_f32_bf16 v22, s72, v67
  v_dot2c_f32_bf16 v23, s73, v67
  v_and_or_b32 v16, v16, v62, v63
  v_and_or_b32 v20, v20, v62, v63
  v_cvt_pk_bf16_f32 v56, v16, v17
  s_waitcnt lgkmcnt(2)
  v_mfma_f32_16x16x32_bf16 v[24:27], v[44:47], v[128:131], v[24:27]
  ds_read_b64_tr_b16 v[44:45], v3 offset:63488
  v_mfma_f32_16x16x32_bf16 v[24:27], v[48:51], v[136:139], v[24:27]
  ds_read_b64_tr_b16 v[46:47], v4 offset:6144
  v_mfma_f32_16x16x32_bf16 v[24:27], v[32:35], v[144:147], v[24:27]
  ds_read_b64_tr_b16 v[48:49], v4 offset:8192
  v_mfma_f32_16x16x32_bf16 v[24:27], v[36:39], v[152:155], v[24:27]
  ds_read_b64_tr_b16 v[50:51], v4 offset:16384
  v_cvt_pk_bf16_f32 v57, v18, v19
  v_cvt_pk_bf16_f32 v58, v20, v21
  v_cvt_pk_bf16_f32 v59, v22, v23
  s_nop 0
  v_permlane16_swap_b32 v56, v58
  v_permlane16_swap_b32 v57, v59
  s_waitcnt vmcnt(10)
  v_cmp_ne_u32 vcc, s3, v68
  s_cbranch_vccnz parallel_sum__ssm_conv_h3__dense_activation_gelu__prompt_kernel_Z_pf8
parallel_sum__ssm_conv_h3__dense_activation_gelu__prompt_kernel_Z_pf8b:
  s_lshl_b32 s40, s52, 11
  s_add_u32 s40, s40, s53
  buffer_load_dwordx4 v[64:67], v11, s[24:27], s40 offen
  buffer_load_dword v75, v74, s[24:27], s10 offen sc1
  s_waitcnt lgkmcnt(2)
  v_mfma_f32_16x16x32_bf16 v[28:31], v[32:35], v[148:151], v[28:31]
  ds_read_b64_tr_b16 v[32:33], v4 offset:10240
  v_mfma_f32_16x16x32_bf16 v[28:31], v[36:39], v[156:159], v[28:31]
  ds_read_b64_tr_b16 v[34:35], v4 offset:18432
  v_mfma_f32_16x16x32_bf16 v[28:31], v[40:43], v[164:167], v[28:31]
  ds_read_b64_tr_b16 v[36:37], v4 offset:12288
  v_mfma_f32_16x16x32_bf16 v[28:31], v[44:47], v[172:175], v[28:31]
  ds_read_b64_tr_b16 v[38:39], v4 offset:20480
  s_barrier
  s_lshl_b32 s40, s51, 11
  s_add_u32 s40, s40, s53
  v_or_b32 v56, 1, v56
  buffer_store_dwordx4 v[56:59], v11, s[24:27], s40 offen sc1
  s_waitcnt lgkmcnt(2)
  v_mfma_f32_16x16x32_bf16 v[24:27], v[40:43], v[160:163], v[24:27]
  ds_read_b64_tr_b16 v[40:41], v4 offset:14336
  v_mfma_f32_16x16x32_bf16 v[24:27], v[44:47], v[168:171], v[24:27]
  ds_read_b64_tr_b16 v[42:43], v4 offset:22528
  v_mfma_f32_16x16x32_bf16 v[24:27], v[48:51], v[176:179], v[24:27]
  ds_read_b64_tr_b16 v[44:45], v4 offset:24576
  v_mfma_f32_16x16x32_bf16 v[24:27], v[32:35], v[184:187], v[24:27]
  ds_read_b64_tr_b16 v[46:47], v3 offset:32768
  s_waitcnt lgkmcnt(2)
  v_mfma_f32_16x16x32_bf16 v[28:31], v[48:51], v[180:183], v[28:31]
  ds_read_b64_tr_b16 v[48:49], v4 offset:26624
  v_mfma_f32_16x16x32_bf16 v[28:31], v[32:35], v[188:191], v[28:31]
  ds_read_b64_tr_b16 v[50:51], v3 offset:34816
  v_mfma_f32_16x16x32_bf16 v[28:31], v[36:39], v[196:199], v[28:31]
  ds_read_b64_tr_b16 v[32:33], v4 offset:28672
  v_mfma_f32_16x16x32_bf16 v[28:31], v[40:43], v[204:207], v[28:31]
  ds_read_b64_tr_b16 v[34:35], v3 offset:36864
  s_waitcnt lgkmcnt(2)
  v_mfma_f32_16x16x32_bf16 v[24:27], v[36:39], v[192:195], v[24:27]
  ds_read_b64_tr_b16 v[36:37], v4 offset:30720
  v_mfma_f32_16x16x32_bf16 v[24:27], v[40:43], v[200:203], v[24:27]
  ds_read_b64_tr_b16 v[38:39], v3 offset:38912
  v_mfma_f32_16x16x32_bf16 v[24:27], v[44:47], v[208:211], v[24:27]
  ds_read_b64_tr_b16 v[40:41], v3 offset:24576
  v_mfma_f32_16x16x32_bf16 v[24:27], v[48:51], v[216:219], v[24:27]
  ds_read_b64_tr_b16 v[42:43], v3 offset:26624
  s_waitcnt lgkmcnt(2)
  v_mfma_f32_16x16x32_bf16 v[28:31], v[44:47], v[212:215], v[28:31]
  ds_read_b64_tr_b16 v[44:45], v3 offset:28672
  v_mfma_f32_16x16x32_bf16 v[28:31], v[48:51], v[220:223], v[28:31]
  ds_read_b64_tr_b16 v[46:47], v3 offset:30720
  v_mfma_f32_16x16x32_bf16 v[28:31], v[32:35], v[228:231], v[28:31]
  v_mfma_f32_16x16x32_bf16 v[28:31], v[36:39], v[236:239], v[28:31]
  s_waitcnt lgkmcnt(0)
  v_mfma_f32_16x16x32_bf16 v[24:27], v[32:35], v[224:227], v[24:27]
  v_mfma_f32_16x16x32_bf16 v[24:27], v[36:39], v[232:235], v[24:27]
  v_mfma_f32_16x16x32_bf16 v[24:27], v[40:43], v[240:243], v[24:27]
  v_mfma_f32_16x16x32_bf16 v[24:27], v[44:47], v[248:251], v[24:27]
  v_mfma_f32_16x16x32_bf16 v[28:31], v[40:43], v[244:247], v[28:31]
  v_mfma_f32_16x16x32_bf16 v[28:31], v[44:47], v[252:255], v[28:31]
  s_waitcnt vmcnt(2)
  v_permlane16_swap_b32 v64, v66
  v_permlane16_swap_b32 v65, v67
  s_nop 5
  v_dot2c_f32_bf16 v24, s72, v64
  v_dot2c_f32_bf16 v25, s73, v64
  v_dot2c_f32_bf16 v28, s72, v66
  v_dot2c_f32_bf16 v29, s73, v66
  v_dot2c_f32_bf16 v26, s72, v65
  v_dot2c_f32_bf16 v27, s73, v65
  v_dot2c_f32_bf16 v30, s72, v67
  v_dot2c_f32_bf16 v31, s73, v67
  v_and_or_b32 v24, v24, v62, v63
  v_and_or_b32 v28, v28, v62, v63
  v_cvt_pk_bf16_f32 v56, v24, v25
  v_cvt_pk_bf16_f32 v57, v26, v27
  v_cvt_pk_bf16_f32 v58, v28, v29
  v_cvt_pk_bf16_f32 v59, v30, v31
  s_nop 0
  v_permlane16_swap_b32 v56, v58
  v_permlane16_swap_b32 v57, v59
  s_lshl_b32 s40, s52, 11
  s_add_u32 s40, s40, s53
  v_or_b32 v56, 1, v56
  buffer_store_dwordx4 v[56:59], v11, s[24:27], s40 offen sc1
  s_cmp_eq_u32 s78, 4
  s_cbranch_scc1 parallel_sum__ssm_conv_h3__dense_activation_gelu__prompt_kernel_Z_none
  s_waitcnt vmcnt(2)
  v_cmp_ne_u32 vcc, s3, v75
  s_cbranch_vccnz parallel_sum__ssm_conv_h3__dense_activation_gelu__prompt_kernel_Z_fs
parallel_sum__ssm_conv_h3__dense_activation_gelu__prompt_kernel_Z_fb:
  s_cmp_eq_u32 s78, 1
  s_cbranch_scc1 parallel_sum__ssm_conv_h3__dense_activation_gelu__prompt_kernel_Z_j1
  s_cmp_eq_u32 s78, 2
  s_cbranch_scc1 parallel_sum__ssm_conv_h3__dense_activation_gelu__prompt_kernel_Z_j2
  s_cmp_eq_u32 s78, 3
  s_cbranch_scc1 parallel_sum__ssm_conv_h3__dense_activation_gelu__prompt_kernel_Z_j3
  ds_read_b64_tr_b16 v[224:225], v6 offset:4000
  ds_read_b64_tr_b16 v[226:227], v6 offset:3968
  ds_read_b64_tr_b16 v[112:113], v5 offset:0
  ds_read_b64_tr_b16 v[114:115], v5 offset:32
  ds_read_b64_tr_b16 v[228:229], v6 offset:3872
  ds_read_b64_tr_b16 v[230:231], v6 offset:3840
  ds_read_b64_tr_b16 v[232:233], v6 offset:3744
  ds_read_b64_tr_b16 v[234:235], v6 offset:3712
  ds_read_b64_tr_b16 v[116:117], v5 offset:256
  ds_read_b64_tr_b16 v[118:119], v5 offset:288
  ds_read_b64_tr_b16 v[236:237], v6 offset:3616
  ds_read_b64_tr_b16 v[238:239], v6 offset:3584
  ds_read_b64_tr_b16 v[240:241], v6 offset:3488
  ds_read_b64_tr_b16 v[242:243], v6 offset:3456
  ds_read_b64_tr_b16 v[120:121], v5 offset:512
  ds_read_b64_tr_b16 v[122:123], v5 offset:544
  s_waitcnt lgkmcnt(12)
  v_mfma_f32_16x16x32_bf16 v[212:215], v[224:227], v[112:115], 0
  ds_read_b64_tr_b16 v[244:245], v6 offset:3360
  ds_read_b64_tr_b16 v[246:247], v6 offset:3328
  s_waitcnt lgkmcnt(12)
  v_mfma_f32_16x16x32_bf16 v[208:211], v[228:231], v[112:115], 0
  ds_read_b64_tr_b16 v[224:225], v6 offset:3232
  ds_read_b64_tr_b16 v[226:227], v6 offset:3200
  buffer_load_dwordx2 v[108:109], v53, s[24:27], s23 offen
  s_waitcnt lgkmcnt(12)
  v_mfma_f32_16x16x32_bf16 v[204:207], v[232:235], v[112:115], 0
  ds_read_b64_tr_b16 v[124:125], v5 offset:768
  ds_read_b64_tr_b16 v[126:127], v5 offset:800
  s_waitcnt lgkmcnt(12)
  v_mfma_f32_16x16x32_bf16 v[212:215], v[232:235], v[116:119], v[212:215]
  ds_read_b64_tr_b16 v[228:229], v6 offset:3104
  ds_read_b64_tr_b16 v[230:231], v6 offset:3072
  s_waitcnt lgkmcnt(12)
  v_mfma_f32_16x16x32_bf16 v[200:203], v[236:239], v[112:115], 0
  v_mfma_f32_16x16x32_bf16 v[208:211], v[236:239], v[116:119], v[208:211]
  ds_read_b64_tr_b16 v[232:233], v6 offset:2976
  ds_read_b64_tr_b16 v[234:235], v6 offset:2944
  buffer_load_dwordx4 v[64:67], v52, s[24:27], s30 offen sc1
  s_waitcnt lgkmcnt(12)
  v_mfma_f32_16x16x32_bf16 v[196:199], v[240:243], v[112:115], 0
  v_mfma_f32_16x16x32_bf16 v[204:207], v[240:243], v[116:119], v[204:207]
  ds_read_b64_tr_b16 v[128:129], v5 offset:1024
  ds_read_b64_tr_b16 v[130:131], v5 offset:1056
  s_waitcnt lgkmcnt(12)
  v_mfma_f32_16x16x32_bf16 v[212:215], v[240:243], v[120:123], v[212:215]
  ds_read_b64_tr_b16 v[236:237], v6 offset:2848
  ds_read_b64_tr_b16 v[238:239], v6 offset:2816
  s_waitcnt lgkmcnt(12)
  v_mfma_f32_16x16x32_bf16 v[200:203], v[244:247], v[116:119], v[200:203]
  v_mfma_f32_16x16x32_bf16 v[208:211], v[244:247], v[120:123], v[208:211]
  ds_read_b64_tr_b16 v[240:241], v6 offset:2720
  ds_read_b64_tr_b16 v[242:243], v6 offset:2688
  s_waitcnt lgkmcnt(12)
  v_mfma_f32_16x16x32_bf16 v[196:199], v[224:227], v[116:119], v[196:199]
  v_mfma_f32_16x16x32_bf16 v[204:207], v[224:227], v[120:123], v[204:207]
  ds_read_b64_tr_b16 v[132:133], v5 offset:1280
  ds_read_b64_tr_b16 v[134:135], v5 offset:1312
  s_waitcnt lgkmcnt(12)
  v_mfma_f32_16x16x32_bf16 v[212:215], v[224:227], v[124:127], v[212:215]
  ds_read_b64_tr_b16 v[244:245], v6 offset:2592
  ds_read_b64_tr_b16 v[246:247], v6 offset:2560
  s_waitcnt lgkmcnt(12)
  v_mfma_f32_16x16x32_bf16 v[200:203], v[228:231], v[120:123], v[200:203]
  v_mfma_f32_16x16x32_bf16 v[208:211], v[228:231], v[124:127], v[208:211]
  ds_read_b64_tr_b16 v[224:225], v6 offset:2464
  ds_read_b64_tr_b16 v[226:227], v6 offset:2432
  s_waitcnt lgkmcnt(12)
  v_mfma_f32_16x16x32_bf16 v[196:199], v[232:235], v[120:123], v[196:199]
  v_mfma_f32_16x16x32_bf16 v[204:207], v[232:235], v[124:127], v[204:207]
  ds_read_b64_tr_b16 v[136:137], v5 offset:1536
  ds_read_b64_tr_b16 v[138:139], v5 offset:1568
  s_waitcnt lgkmcnt(12)
  v_mfma_f32_16x16x32_bf16 v[212:215], v[232:235], v[128:131], v[212:215]
  ds_read_b64_tr_b16 v[228:229], v6 offset:2336
  ds_read_b64_tr_b16 v[230:231], v6 offset:2304
  s_waitcnt lgkmcnt(12)
  v_mfma_f32_16x16x32_bf16 v[200:203], v[236:239], v[124:127], v[200:203]
  v_mfma_f32_16x16x32_bf16 v[208:211], v[236:239], v[128:131], v[208:211]
  ds_read_b64_tr_b16 v[232:233], v6 offset:2208
  ds_read_b64_tr_b16 v[234:235], v6 offset:2176
  s_waitcnt lgkmcnt(12)
  v_mfma_f32_16x16x32_bf16 v[196:199], v[240:243], v[124:127], v[196:199]
  v_mfma_f32_16x16x32_bf16 v[204:207], v[240:243], v[128:131], v[204:207]
  ds_read_b64_tr_b16 v[140:141], v5 offset:1792
  ds_read_b64_tr_b16 v[142:143], v5 offset:1824
  s_waitcnt lgkmcnt(12)
  v_mfma_f32_16x16x32_bf16 v[212:215], v[240:243], v[132:135], v[212:215]
  ds_read_b64_tr_b16 v[236:237], v6 offset:2080
  ds_read_b64_tr_b16 v[238:239], v6 offset:2048
  s_waitcnt lgkmcnt(12)
  v_mfma_f32_16x16x32_bf16 v[200:203], v[244:247], v[128:131], v[200:203]
  v_mfma_f32_16x16x32_bf16 v[208:211], v[244:247], v[132:135], v[208:211]
  ds_read_b64_tr_b16 v[240:241], v6 offset:1952
  ds_read_b64_tr_b16 v[242:243], v6 offset:1920
  s_waitcnt lgkmcnt(12)
  v_mfma_f32_16x16x32_bf16 v[196:199], v[224:227], v[128:131], v[196:199]
  v_mfma_f32_16x16x32_bf16 v[204:207], v[224:227], v[132:135], v[204:207]
  ds_read_b64_tr_b16 v[144:145], v5 offset:2048
  ds_read_b64_tr_b16 v[146:147], v5 offset:2080
  s_waitcnt lgkmcnt(12)
  v_mfma_f32_16x16x32_bf16 v[212:215], v[224:227], v[136:139], v[212:215]
  ds_read_b64_tr_b16 v[244:245], v6 offset:1824
  ds_read_b64_tr_b16 v[246:247], v6 offset:1792
  s_waitcnt lgkmcnt(12)
  v_mfma_f32_16x16x32_bf16 v[200:203], v[228:231], v[132:135], v[200:203]
  v_mfma_f32_16x16x32_bf16 v[208:211], v[228:231], v[136:139], v[208:211]
  ds_read_b64_tr_b16 v[224:225], v6 offset:1696
  ds_read_b64_tr_b16 v[226:227], v6 offset:1664
  s_waitcnt lgkmcnt(12)
  v_mfma_f32_16x16x32_bf16 v[196:199], v[232:235], v[132:135], v[196:199]
  v_mfma_f32_16x16x32_bf16 v[204:207], v[232:235], v[136:139], v[204:207]
  ds_read_b64_tr_b16 v[148:149], v5 offset:2304
  ds_read_b64_tr_b16 v[150:151], v5 offset:2336
  s_waitcnt lgkmcnt(12)
  v_mfma_f32_16x16x32_bf16 v[212:215], v[232:235], v[140:143], v[212:215]
  ds_read_b64_tr_b16 v[228:229], v6 offset:1568
  ds_read_b64_tr_b16 v[230:231], v6 offset:1536
  s_waitcnt lgkmcnt(12)
  v_mfma_f32_16x16x32_bf16 v[200:203], v[236:239], v[136:139], v[200:203]
  v_mfma_f32_16x16x32_bf16 v[208:211], v[236:239], v[140:143], v[208:211]
  ds_read_b64_tr_b16 v[232:233], v6 offset:1440
  ds_read_b64_tr_b16 v[234:235], v6 offset:1408
  s_waitcnt lgkmcnt(12)
  v_mfma_f32_16x16x32_bf16 v[196:199], v[240:243], v[136:139], v[196:199]
  v_mfma_f32_16x16x32_bf16 v[204:207], v[240:243], v[140:143], v[204:207]
  ds_read_b64_tr_b16 v[152:153], v5 offset:2560
  ds_read_b64_tr_b16 v[154:155], v5 offset:2592
  buffer_load_dwordx4 v[76:79], v52, s[24:27], s11 offen sc1
  s_waitcnt lgkmcnt(12)
  v_mfma_f32_16x16x32_bf16 v[212:215], v[240:243], v[144:147], v[212:215]
  ds_read_b64_tr_b16 v[236:237], v6 offset:1312
  ds_read_b64_tr_b16 v[238:239], v6 offset:1280
  s_waitcnt lgkmcnt(12)
  v_mfma_f32_16x16x32_bf16 v[200:203], v[244:247], v[140:143], v[200:203]
  buffer_load_dwordx4 v[80:83], v52, s[24:27], s20 offen sc1
  v_mfma_f32_16x16x32_bf16 v[208:211], v[244:247], v[144:147], v[208:211]
  ds_read_b64_tr_b16 v[240:241], v6 offset:1184
  ds_read_b64_tr_b16 v[242:243], v6 offset:1152
  s_waitcnt lgkmcnt(12)
  v_mfma_f32_16x16x32_bf16 v[196:199], v[224:227], v[140:143], v[196:199]
  buffer_load_dwordx4 v[84:87], v52, s[24:27], s21 offen sc1
  v_mfma_f32_16x16x32_bf16 v[204:207], v[224:227], v[144:147], v[204:207]
  ds_read_b64_tr_b16 v[156:157], v5 offset:2816
  ds_read_b64_tr_b16 v[158:159], v5 offset:2848
  s_waitcnt lgkmcnt(12)
  v_mfma_f32_16x16x32_bf16 v[212:215], v[224:227], v[148:151], v[212:215]
  ds_read_b64_tr_b16 v[244:245], v6 offset:1056
  ds_read_b64_tr_b16 v[246:247], v6 offset:1024
  buffer_load_dwordx4 v[88:91], v52, s[24:27], s22 offen sc1
  s_waitcnt lgkmcnt(12)
  v_mfma_f32_16x16x32_bf16 v[200:203], v[228:231], v[144:147], v[200:203]
  v_mfma_f32_16x16x32_bf16 v[208:211], v[228:231], v[148:151], v[208:211]
  ds_read_b64_tr_b16 v[224:225], v6 offset:928
  ds_read_b64_tr_b16 v[226:227], v6 offset:896
  s_waitcnt lgkmcnt(12)
  v_mfma_f32_16x16x32_bf16 v[192:195], v[232:235], v[112:115], 0
  v_mfma_f32_16x16x32_bf16 v[196:199], v[232:235], v[144:147], v[196:199]
  v_mfma_f32_16x16x32_bf16 v[204:207], v[232:235], v[148:151], v[204:207]
  ds_read_b64_tr_b16 v[160:161], v5 offset:3072
  ds_read_b64_tr_b16 v[162:163], v5 offset:3104
  s_waitcnt lgkmcnt(12)
  v_mfma_f32_16x16x32_bf16 v[212:215], v[232:235], v[152:155], v[212:215]
  ds_read_b64_tr_b16 v[228:229], v6 offset:800
  ds_read_b64_tr_b16 v[230:231], v6 offset:768
  s_waitcnt lgkmcnt(12)
  v_mfma_f32_16x16x32_bf16 v[188:191], v[236:239], v[112:115], 0
  v_mfma_f32_16x16x32_bf16 v[200:203], v[236:239], v[148:151], v[200:203]
  v_mfma_f32_16x16x32_bf16 v[208:211], v[236:239], v[152:155], v[208:211]
  ds_read_b64_tr_b16 v[232:233], v6 offset:672
  ds_read_b64_tr_b16 v[234:235], v6 offset:640
  s_waitcnt lgkmcnt(12)
  v_mfma_f32_16x16x32_bf16 v[184:187], v[240:243], v[112:115], 0
  v_mfma_f32_16x16x32_bf16 v[192:195], v[240:243], v[116:119], v[192:195]
  v_mfma_f32_16x16x32_bf16 v[196:199], v[240:243], v[148:151], v[196:199]
  v_mfma_f32_16x16x32_bf16 v[204:207], v[240:243], v[152:155], v[204:207]
  ds_read_b64_tr_b16 v[164:165], v5 offset:3328
  ds_read_b64_tr_b16 v[166:167], v5 offset:3360
  s_waitcnt lgkmcnt(12)
  v_mfma_f32_16x16x32_bf16 v[212:215], v[240:243], v[156:159], v[212:215]
  ds_read_b64_tr_b16 v[236:237], v6 offset:544
  ds_read_b64_tr_b16 v[238:239], v6 offset:512
  s_waitcnt lgkmcnt(12)
  v_mfma_f32_16x16x32_bf16 v[180:183], v[244:247], v[112:115], 0
  v_mfma_f32_16x16x32_bf16 v[188:191], v[244:247], v[116:119], v[188:191]
  v_mfma_f32_16x16x32_bf16 v[200:203], v[244:247], v[152:155], v[200:203]
  v_mfma_f32_16x16x32_bf16 v[208:211], v[244:247], v[156:159], v[208:211]
  ds_read_b64_tr_b16 v[240:241], v6 offset:416
  ds_read_b64_tr_b16 v[242:243], v6 offset:384
  s_waitcnt lgkmcnt(12)
  v_mfma_f32_16x16x32_bf16 v[176:179], v[224:227], v[112:115], 0
  v_mfma_f32_16x16x32_bf16 v[184:187], v[224:227], v[116:119], v[184:187]
  v_mfma_f32_16x16x32_bf16 v[192:195], v[224:227], v[120:123], v[192:195]
  v_mfma_f32_16x16x32_bf16 v[196:199], v[224:227], v[152:155], v[196:199]
  v_mfma_f32_16x16x32_bf16 v[204:207], v[224:227], v[156:159], v[204:207]
  ds_read_b64_tr_b16 v[168:169], v5 offset:3584
  ds_read_b64_tr_b16 v[170:171], v5 offset:3616
  s_waitcnt lgkmcnt(12)
  v_mfma_f32_16x16x32_bf16 v[212:215], v[224:227], v[160:163], v[212:215]
  ds_read_b64_tr_b16 v[244:245], v6 offset:288
  ds_read_b64_tr_b16 v[246:247], v6 offset:256
  s_waitcnt lgkmcnt(12)
  v_mfma_f32_16x16x32_bf16 v[180:183], v[228:231], v[116:119], v[180:183]
  v_mfma_f32_16x16x32_bf16 v[188:191], v[228:231], v[120:123], v[188:191]
  v_mfma_f32_16x16x32_bf16 v[200:203], v[228:231], v[156:159], v[200:203]
  v_mfma_f32_16x16x32_bf16 v[208:211], v[228:231], v[160:163], v[208:211]
  ds_read_b64_tr_b16 v[224:225], v6 offset:160
  ds_read_b64_tr_b16 v[226:227], v6 offset:128
  s_waitcnt lgkmcnt(12)
  v_mfma_f32_16x16x32_bf16 v[176:179], v[232:235], v[116:119], v[176:179]
  v_mfma_f32_16x16x32_bf16 v[184:187], v[232:235], v[120:123], v[184:187]
  v_mfma_f32_16x16x32_bf16 v[192:195], v[232:235], v[124:127], v[192:195]
  v_mfma_f32_16x16x32_bf16 v[196:199], v[232:235], v[156:159], v[196:199]
  v_mfma_f32_16x16x32_bf16 v[204:207], v[232:235], v[160:163], v[204:207]
  ds_read_b64_tr_b16 v[172:173], v5 offset:3840
  ds_read_b64_tr_b16 v[174:175], v5 offset:3872
  s_waitcnt lgkmcnt(12)
  v_mfma_f32_16x16x32_bf16 v[212:215], v[232:235], v[164:167], v[212:215]
  ds_read_b64_tr_b16 v[228:229], v6 offset:32
  ds_read_b64_tr_b16 v[230:231], v6 offset:0
  s_waitcnt lgkmcnt(12)
  v_mfma_f32_16x16x32_bf16 v[180:183], v[236:239], v[120:123], v[180:183]
  v_mfma_f32_16x16x32_bf16 v[188:191], v[236:239], v[124:127], v[188:191]
  v_mfma_f32_16x16x32_bf16 v[200:203], v[236:239], v[160:163], v[200:203]
  v_mfma_f32_16x16x32_bf16 v[208:211], v[236:239], v[164:167], v[208:211]
  s_waitcnt lgkmcnt(10)
  v_mfma_f32_16x16x32_bf16 v[176:179], v[240:243], v[120:123], v[176:179]
  v_mfma_f32_16x16x32_bf16 v[184:187], v[240:243], v[124:127], v[184:187]
  v_mfma_f32_16x16x32_bf16 v[192:195], v[240:243], v[128:131], v[192:195]
  v_mfma_f32_16x16x32_bf16 v[196:199], v[240:243], v[160:163], v[196:199]
  v_mfma_f32_16x16x32_bf16 v[204:207], v[240:243], v[164:167], v[204:207]
  s_waitcnt lgkmcnt(8)
  v_mfma_f32_16x16x32_bf16 v[212:215], v[240:243], v[168:171], v[212:215]
  s_waitcnt lgkmcnt(6)
  v_mfma_f32_16x16x32_bf16 v[180:183], v[244:247], v[124:127], v[180:183]
  v_mfma_f32_16x16x32_bf16 v[188:191], v[244:247], v[128:131], v[188:191]
  v_mfma_f32_16x16x32_bf16 v[200:203], v[244:247], v[164:167], v[200:203]
  v_mfma_f32_16x16x32_bf16 v[208:211], v[244:247], v[168:171], v[208:211]
  s_waitcnt lgkmcnt(4)
  v_mfma_f32_16x16x32_bf16 v[176:179], v[224:227], v[124:127], v[176:179]
  v_mfma_f32_16x16x32_bf16 v[184:187], v[224:227], v[128:131], v[184:187]
  v_mfma_f32_16x16x32_bf16 v[192:195], v[224:227], v[132:135], v[192:195]
  v_mfma_f32_16x16x32_bf16 v[196:199], v[224:227], v[164:167], v[196:199]
  v_mfma_f32_16x16x32_bf16 v[204:207], v[224:227], v[168:171], v[204:207]
  s_waitcnt lgkmcnt(2)
  v_mfma_f32_16x16x32_bf16 v[212:215], v[224:227], v[172:175], v[212:215]
  s_waitcnt lgkmcnt(0)
  v_mfma_f32_16x16x32_bf16 v[180:183], v[228:231], v[128:131], v[180:183]
  v_mfma_f32_16x16x32_bf16 v[188:191], v[228:231], v[132:135], v[188:191]
  v_mfma_f32_16x16x32_bf16 v[200:203], v[228:231], v[168:171], v[200:203]
  v_mfma_f32_16x16x32_bf16 v[208:211], v[228:231], v[172:175], v[208:211]
  ds_read_u16 v32, v7 offset:1024
  ds_read_u16 v33, v7 offset:1152
  ds_read_u16 v34, v7 offset:1280
  ds_read_u16 v35, v7 offset:1408
  ds_read_u16 v36, v7 offset:3584
  ds_read_u16 v37, v7 offset:3712
  ds_read_u16 v38, v7 offset:3840
  ds_read_u16 v39, v7 offset:3968
  s_nop 2
  v_add_f32 v113, v179, v182 wave_ror:1 row_mask:0x1 bank_mask:0x1
  v_add_f32 v114, v183, v186 wave_ror:1 row_mask:0x1 bank_mask:0x1
  v_add_f32 v115, v187, v190 wave_ror:1 row_mask:0x1 bank_mask:0x1
  v_add_f32 v116, v191, v194 wave_ror:1 row_mask:0x1 bank_mask:0x1
  v_add_f32 v118, v199, v202 wave_ror:1 row_mask:0x1 bank_mask:0x1
  v_add_f32 v119, v203, v206 wave_ror:1 row_mask:0x1 bank_mask:0x1
  v_add_f32 v120, v207, v210 wave_ror:1 row_mask:0x1 bank_mask:0x1
  v_add_f32 v121, v211, v214 wave_ror:1 row_mask:0x1 bank_mask:0x1
  v_add_f32 v112, v179, v178 wave_shr:1 row_mask:0xf bank_mask:0xf bound_ctrl:0
  v_add_f32 v113, v183, v182 wave_shr:1 row_mask:0xf bank_mask:0xf
  v_add_f32 v114, v187, v186 wave_shr:1 row_mask:0xf bank_mask:0xf
  v_add_f32 v115, v191, v190 wave_shr:1 row_mask:0xf bank_mask:0xf
  v_add_f32 v116, v195, v194 wave_shr:1 row_mask:0xf bank_mask:0xf
  v_add_f32 v117, v199, v198 wave_shr:1 row_mask:0xf bank_mask:0xf bound_ctrl:0
  v_add_f32 v118, v203, v202 wave_shr:1 row_mask:0xf bank_mask:0xf
  v_add_f32 v119, v207, v206 wave_shr:1 row_mask:0xf bank_mask:0xf
  v_add_f32 v120, v211, v210 wave_shr:1 row_mask:0xf bank_mask:0xf
  v_add_f32 v121, v215, v214 wave_shr:1 row_mask:0xf bank_mask:0xf
  s_waitcnt lgkmcnt(0)
  v_dot2c_f32_bf16 v180, s74, v32
  v_dot2c_f32_bf16 v184, s74, v33
  v_dot2c_f32_bf16 v188, s74, v34
  v_dot2c_f32_bf16 v192, s74, v35
  v_dot2c_f32_bf16 v200, s74, v36
  v_dot2c_f32_bf16 v204, s74, v37
  v_dot2c_f32_bf16 v208, s74, v38
  v_dot2c_f32_bf16 v212, s74, v39
  v_add_f32 v129, v112, v181 wave_ror:1 row_mask:0x1 bank_mask:0x1
  v_add_f32 v130, v113, v185 wave_ror:1 row_mask:0x1 bank_mask:0x1
  v_add_f32 v131, v114, v189 wave_ror:1 row_mask:0x1 bank_mask:0x1
  v_add_f32 v132, v115, v193 wave_ror:1 row_mask:0x1 bank_mask:0x1
  v_add_f32 v134, v117, v201 wave_ror:1 row_mask:0x1 bank_mask:0x1
  v_add_f32 v135, v118, v205 wave_ror:1 row_mask:0x1 bank_mask:0x1
  v_add_f32 v136, v119, v209 wave_ror:1 row_mask:0x1 bank_mask:0x1
  v_add_f32 v137, v120, v213 wave_ror:1 row_mask:0x1 bank_mask:0x1
  v_add_f32 v128, v112, v177 wave_shr:1 row_mask:0xf bank_mask:0xf bound_ctrl:0
  v_add_f32 v129, v113, v181 wave_shr:1 row_mask:0xf bank_mask:0xf
  v_add_f32 v130, v114, v185 wave_shr:1 row_mask:0xf bank_mask:0xf
  v_add_f32 v131, v115, v189 wave_shr:1 row_mask:0xf bank_mask:0xf
  v_add_f32 v132, v116, v193 wave_shr:1 row_mask:0xf bank_mask:0xf
  v_add_f32 v133, v117, v197 wave_shr:1 row_mask:0xf bank_mask:0xf bound_ctrl:0
  v_add_f32 v134, v118, v201 wave_shr:1 row_mask:0xf bank_mask:0xf
  v_add_f32 v135, v119, v205 wave_shr:1 row_mask:0xf bank_mask:0xf
  v_add_f32 v136, v120, v209 wave_shr:1 row_mask:0xf bank_mask:0xf
  v_add_f32 v137, v121, v213 wave_shr:1 row_mask:0xf bank_mask:0xf
  v_add_f32 v145, v128, v180 wave_ror:1 row_mask:0x1 bank_mask:0x1
  v_add_f32 v146, v129, v184 wave_ror:1 row_mask:0x1 bank_mask:0x1
  v_add_f32 v147, v130, v188 wave_ror:1 row_mask:0x1 bank_mask:0x1
  v_add_f32 v148, v131, v192 wave_ror:1 row_mask:0x1 bank_mask:0x1
  v_add_f32 v150, v133, v200 wave_ror:1 row_mask:0x1 bank_mask:0x1
  v_add_f32 v151, v134, v204 wave_ror:1 row_mask:0x1 bank_mask:0x1
  v_add_f32 v152, v135, v208 wave_ror:1 row_mask:0x1 bank_mask:0x1
  v_add_f32 v153, v136, v212 wave_ror:1 row_mask:0x1 bank_mask:0x1
  v_add_f32 v145, v129, v180 wave_shr:1 row_mask:0xf bank_mask:0xf
  v_add_f32 v146, v130, v184 wave_shr:1 row_mask:0xf bank_mask:0xf
  v_add_f32 v147, v131, v188 wave_shr:1 row_mask:0xf bank_mask:0xf
  v_add_f32 v148, v132, v192 wave_shr:1 row_mask:0xf bank_mask:0xf
  v_add_f32 v150, v134, v200 wave_shr:1 row_mask:0xf bank_mask:0xf
  v_add_f32 v151, v135, v204 wave_shr:1 row_mask:0xf bank_mask:0xf
  v_add_f32 v152, v136, v208 wave_shr:1 row_mask:0xf bank_mask:0xf
  v_add_f32 v153, v137, v212 wave_shr:1 row_mask:0xf bank_mask:0xf
  ds_write2st64_b32 v10, v145, v146 offset0:0 offset1:1
  ds_write2st64_b32 v10, v147, v148 offset0:2 offset1:3
  ds_write2st64_b32 v10, v150, v151 offset0:4 offset1:5
  ds_write2st64_b32 v10, v152, v153 offset0:6 offset1:7
  s_branch parallel_sum__ssm_conv_h3__dense_activation_gelu__prompt_kernel_Z_cfin
parallel_sum__ssm_conv_h3__dense_activation_gelu__prompt_kernel_Z_j1:
  ds_read_b64_tr_b16 v[224:225], v6 offset:3488
  ds_read_b64_tr_b16 v[226:227], v6 offset:3456
  ds_read_b64_tr_b16 v[112:113], v5 offset:0
  ds_read_b64_tr_b16 v[114:115], v5 offset:32
  ds_read_b64_tr_b16 v[228:229], v6 offset:3360
  ds_read_b64_tr_b16 v[230:231], v6 offset:3328
  ds_read_b64_tr_b16 v[232:233], v6 offset:3232
  ds_read_b64_tr_b16 v[234:235], v6 offset:3200
  ds_read_b64_tr_b16 v[116:117], v5 offset:256
  ds_read_b64_tr_b16 v[118:119], v5 offset:288
  ds_read_b64_tr_b16 v[236:237], v6 offset:3104
  ds_read_b64_tr_b16 v[238:239], v6 offset:3072
  ds_read_b64_tr_b16 v[240:241], v6 offset:2976
  ds_read_b64_tr_b16 v[242:243], v6 offset:2944
  ds_read_b64_tr_b16 v[120:121], v5 offset:512
  ds_read_b64_tr_b16 v[122:123], v5 offset:544
  s_waitcnt lgkmcnt(12)
  v_mfma_f32_16x16x32_bf16 v[212:215], v[224:227], v[112:115], 0
  ds_read_b64_tr_b16 v[244:245], v6 offset:2848
  ds_read_b64_tr_b16 v[246:247], v6 offset:2816
  s_waitcnt lgkmcnt(12)
  v_mfma_f32_16x16x32_bf16 v[208:211], v[228:231], v[112:115], 0
  ds_read_b64_tr_b16 v[224:225], v6 offset:2720
  ds_read_b64_tr_b16 v[226:227], v6 offset:2688
  buffer_load_dwordx2 v[108:109], v53, s[24:27], s23 offen
  s_waitcnt lgkmcnt(12)
  v_mfma_f32_16x16x32_bf16 v[204:207], v[232:235], v[112:115], 0
  ds_read_b64_tr_b16 v[124:125], v5 offset:768
  ds_read_b64_tr_b16 v[126:127], v5 offset:800
  s_waitcnt lgkmcnt(12)
  v_mfma_f32_16x16x32_bf16 v[212:215], v[232:235], v[116:119], v[212:215]
  ds_read_b64_tr_b16 v[228:229], v6 offset:2592
  ds_read_b64_tr_b16 v[230:231], v6 offset:2560
  s_waitcnt lgkmcnt(12)
  v_mfma_f32_16x16x32_bf16 v[200:203], v[236:239], v[112:115], 0
  v_mfma_f32_16x16x32_bf16 v[208:211], v[236:239], v[116:119], v[208:211]
  ds_read_b64_tr_b16 v[232:233], v6 offset:2464
  ds_read_b64_tr_b16 v[234:235], v6 offset:2432
  buffer_load_dwordx4 v[64:67], v52, s[24:27], s30 offen sc1
  s_waitcnt lgkmcnt(12)
  v_mfma_f32_16x16x32_bf16 v[196:199], v[240:243], v[112:115], 0
  v_mfma_f32_16x16x32_bf16 v[204:207], v[240:243], v[116:119], v[204:207]
  ds_read_b64_tr_b16 v[128:129], v5 offset:1024
  ds_read_b64_tr_b16 v[130:131], v5 offset:1056
  s_waitcnt lgkmcnt(12)
  v_mfma_f32_16x16x32_bf16 v[212:215], v[240:243], v[120:123], v[212:215]
  ds_read_b64_tr_b16 v[236:237], v6 offset:2336
  ds_read_b64_tr_b16 v[238:239], v6 offset:2304
  s_waitcnt lgkmcnt(12)
  v_mfma_f32_16x16x32_bf16 v[200:203], v[244:247], v[116:119], v[200:203]
  v_mfma_f32_16x16x32_bf16 v[208:211], v[244:247], v[120:123], v[208:211]
  ds_read_b64_tr_b16 v[240:241], v6 offset:2208
  ds_read_b64_tr_b16 v[242:243], v6 offset:2176
  s_waitcnt lgkmcnt(12)
  v_mfma_f32_16x16x32_bf16 v[196:199], v[224:227], v[116:119], v[196:199]
  v_mfma_f32_16x16x32_bf16 v[204:207], v[224:227], v[120:123], v[204:207]
  ds_read_b64_tr_b16 v[132:133], v5 offset:1280
  ds_read_b64_tr_b16 v[134:135], v5 offset:1312
  s_waitcnt lgkmcnt(12)
  v_mfma_f32_16x16x32_bf16 v[212:215], v[224:227], v[124:127], v[212:215]
  ds_read_b64_tr_b16 v[244:245], v6 offset:2080
  ds_read_b64_tr_b16 v[246:247], v6 offset:2048
  s_waitcnt lgkmcnt(12)
  v_mfma_f32_16x16x32_bf16 v[200:203], v[228:231], v[120:123], v[200:203]
  v_mfma_f32_16x16x32_bf16 v[208:211], v[228:231], v[124:127], v[208:211]
  ds_read_b64_tr_b16 v[224:225], v6 offset:1952
  ds_read_b64_tr_b16 v[226:227], v6 offset:1920
  s_waitcnt lgkmcnt(12)
  v_mfma_f32_16x16x32_bf16 v[196:199], v[232:235], v[120:123], v[196:199]
  v_mfma_f32_16x16x32_bf16 v[204:207], v[232:235], v[124:127], v[204:207]
  ds_read_b64_tr_b16 v[136:137], v5 offset:1536
  ds_read_b64_tr_b16 v[138:139], v5 offset:1568
  s_waitcnt lgkmcnt(12)
  v_mfma_f32_16x16x32_bf16 v[212:215], v[232:235], v[128:131], v[212:215]
  ds_read_b64_tr_b16 v[228:229], v6 offset:1824
  ds_read_b64_tr_b16 v[230:231], v6 offset:1792
  s_waitcnt lgkmcnt(12)
  v_mfma_f32_16x16x32_bf16 v[200:203], v[236:239], v[124:127], v[200:203]
  v_mfma_f32_16x16x32_bf16 v[208:211], v[236:239], v[128:131], v[208:211]
  ds_read_b64_tr_b16 v[232:233], v6 offset:1696
  ds_read_b64_tr_b16 v[234:235], v6 offset:1664
  s_waitcnt lgkmcnt(12)
  v_mfma_f32_16x16x32_bf16 v[196:199], v[240:243], v[124:127], v[196:199]
  v_mfma_f32_16x16x32_bf16 v[204:207], v[240:243], v[128:131], v[204:207]
  ds_read_b64_tr_b16 v[140:141], v5 offset:1792
  ds_read_b64_tr_b16 v[142:143], v5 offset:1824
  s_waitcnt lgkmcnt(12)
  v_mfma_f32_16x16x32_bf16 v[212:215], v[240:243], v[132:135], v[212:215]
  ds_read_b64_tr_b16 v[236:237], v6 offset:1568
  ds_read_b64_tr_b16 v[238:239], v6 offset:1536
  s_waitcnt lgkmcnt(12)
  v_mfma_f32_16x16x32_bf16 v[200:203], v[244:247], v[128:131], v[200:203]
  v_mfma_f32_16x16x32_bf16 v[208:211], v[244:247], v[132:135], v[208:211]
  ds_read_b64_tr_b16 v[240:241], v6 offset:1440
  ds_read_b64_tr_b16 v[242:243], v6 offset:1408
  s_waitcnt lgkmcnt(12)
  v_mfma_f32_16x16x32_bf16 v[192:195], v[224:227], v[112:115], 0
  v_mfma_f32_16x16x32_bf16 v[196:199], v[224:227], v[128:131], v[196:199]
  v_mfma_f32_16x16x32_bf16 v[204:207], v[224:227], v[132:135], v[204:207]
  ds_read_b64_tr_b16 v[144:145], v5 offset:2048
  ds_read_b64_tr_b16 v[146:147], v5 offset:2080
  s_waitcnt lgkmcnt(12)
  v_mfma_f32_16x16x32_bf16 v[212:215], v[224:227], v[136:139], v[212:215]
  ds_read_b64_tr_b16 v[244:245], v6 offset:1312
  ds_read_b64_tr_b16 v[246:247], v6 offset:1280
  s_waitcnt lgkmcnt(12)
  v_mfma_f32_16x16x32_bf16 v[188:191], v[228:231], v[112:115], 0
  v_mfma_f32_16x16x32_bf16 v[200:203], v[228:231], v[132:135], v[200:203]
  v_mfma_f32_16x16x32_bf16 v[208:211], v[228:231], v[136:139], v[208:211]
  ds_read_b64_tr_b16 v[224:225], v6 offset:1184
  ds_read_b64_tr_b16 v[226:227], v6 offset:1152
  s_waitcnt lgkmcnt(12)
  v_mfma_f32_16x16x32_bf16 v[184:187], v[232:235], v[112:115], 0
  v_mfma_f32_16x16x32_bf16 v[192:195], v[232:235], v[116:119], v[192:195]
  v_mfma_f32_16x16x32_bf16 v[196:199], v[232:235], v[132:135], v[196:199]
  v_mfma_f32_16x16x32_bf16 v[204:207], v[232:235], v[136:139], v[204:207]
  ds_read_b64_tr_b16 v[148:149], v5 offset:2304
  ds_read_b64_tr_b16 v[150:151], v5 offset:2336
  s_waitcnt lgkmcnt(12)
  v_mfma_f32_16x16x32_bf16 v[212:215], v[232:235], v[140:143], v[212:215]
  ds_read_b64_tr_b16 v[228:229], v6 offset:1056
  ds_read_b64_tr_b16 v[230:231], v6 offset:1024
  buffer_load_dwordx4 v[76:79], v52, s[24:27], s11 offen sc1
  s_waitcnt lgkmcnt(12)
  v_mfma_f32_16x16x32_bf16 v[180:183], v[236:239], v[112:115], 0
  v_mfma_f32_16x16x32_bf16 v[188:191], v[236:239], v[116:119], v[188:191]
  buffer_load_dwordx4 v[80:83], v52, s[24:27], s20 offen sc1
  v_mfma_f32_16x16x32_bf16 v[200:203], v[236:239], v[136:139], v[200:203]
  v_mfma_f32_16x16x32_bf16 v[208:211], v[236:239], v[140:143], v[208:211]
  ds_read_b64_tr_b16 v[232:233], v6 offset:928
  ds_read_b64_tr_b16 v[234:235], v6 offset:896
  buffer_load_dwordx4 v[84:87], v52, s[24:27], s21 offen sc1
  s_waitcnt lgkmcnt(12)
  v_mfma_f32_16x16x32_bf16 v[176:179], v[240:243], v[112:115], 0
  v_mfma_f32_16x16x32_bf16 v[184:187], v[240:243], v[116:119], v[184:187]
  buffer_load_dwordx4 v[88:91], v52, s[24:27], s22 offen sc1
  v_mfma_f32_16x16x32_bf16 v[192:195], v[240:243], v[120:123], v[192:195]
  v_mfma_f32_16x16x32_bf16 v[196:199], v[240:243], v[136:139], v[196:199]
  v_mfma_f32_16x16x32_bf16 v[204:207], v[240:243], v[140:143], v[204:207]
  ds_read_b64_tr_b16 v[152:153], v5 offset:2560
  ds_read_b64_tr_b16 v[154:155], v5 offset:2592
  s_waitcnt lgkmcnt(12)
  v_mfma_f32_16x16x32_bf16 v[212:215], v[240:243], v[144:147], v[212:215]
  ds_read_b64_tr_b16 v[236:237], v6 offset:800
  ds_read_b64_tr_b16 v[238:239], v6 offset:768
  s_waitcnt lgkmcnt(12)
  v_mfma_f32_16x16x32_bf16 v[180:183], v[244:247], v[116:119], v[180:183]
  v_mfma_f32_16x16x32_bf16 v[188:191], v[244:247], v[120:123], v[188:191]
  v_mfma_f32_16x16x32_bf16 v[200:203], v[244:247], v[140:143], v[200:203]
  v_mfma_f32_16x16x32_bf16 v[208:211], v[244:247], v[144:147], v[208:211]
  ds_read_b64_tr_b16 v[240:241], v6 offset:672
  ds_read_b64_tr_b16 v[242:243], v6 offset:640
  s_waitcnt lgkmcnt(12)
  v_mfma_f32_16x16x32_bf16 v[176:179], v[224:227], v[116:119], v[176:179]
  v_mfma_f32_16x16x32_bf16 v[184:187], v[224:227], v[120:123], v[184:187]
  v_mfma_f32_16x16x32_bf16 v[192:195], v[224:227], v[124:127], v[192:195]
  v_mfma_f32_16x16x32_bf16 v[196:199], v[224:227], v[140:143], v[196:199]
  v_mfma_f32_16x16x32_bf16 v[204:207], v[224:227], v[144:147], v[204:207]
  ds_read_b64_tr_b16 v[156:157], v5 offset:2816
  ds_read_b64_tr_b16 v[158:159], v5 offset:2848
  s_waitcnt lgkmcnt(12)
  v_mfma_f32_16x16x32_bf16 v[212:215], v[224:227], v[148:151], v[212:215]
  ds_read_b64_tr_b16 v[244:245], v6 offset:544
  ds_read_b64_tr_b16 v[246:247], v6 offset:512
  s_waitcnt lgkmcnt(12)
  v_mfma_f32_16x16x32_bf16 v[180:183], v[228:231], v[120:123], v[180:183]
  v_mfma_f32_16x16x32_bf16 v[188:191], v[228:231], v[124:127], v[188:191]
  v_mfma_f32_16x16x32_bf16 v[200:203], v[228:231], v[144:147], v[200:203]
  v_mfma_f32_16x16x32_bf16 v[208:211], v[228:231], v[148:151], v[208:211]
  ds_read_b64_tr_b16 v[224:225], v6 offset:416
  ds_read_b64_tr_b16 v[226:227], v6 offset:384
  s_waitcnt lgkmcnt(12)
  v_mfma_f32_16x16x32_bf16 v[176:179], v[232:235], v[120:123], v[176:179]
  v_mfma_f32_16x16x32_bf16 v[184:187], v[232:235], v[124:127], v[184:187]
  v_mfma_f32_16x16x32_bf16 v[192:195], v[232:235], v[128:131], v[192:195]
  v_mfma_f32_16x16x32_bf16 v[196:199], v[232:235], v[144:147], v[196:199]
  v_mfma_f32_16x16x32_bf16 v[204:207], v[232:235], v[148:151], v[204:207]
  ds_read_b64_tr_b16 v[160:161], v5 offset:3072
  ds_read_b64_tr_b16 v[162:163], v5 offset:3104
  s_waitcnt lgkmcnt(12)
  v_mfma_f32_16x16x32_bf16 v[212:215], v[232:235], v[152:155], v[212:215]
  ds_read_b64_tr_b16 v[228:229], v6 offset:288
  ds_read_b64_tr_b16 v[230:231], v6 offset:256
  s_waitcnt lgkmcnt(12)
  v_mfma_f32_16x16x32_bf16 v[180:183], v[236:239], v[124:127], v[180:183]
  v_mfma_f32_16x16x32_bf16 v[188:191], v[236:239], v[128:131], v[188:191]
  v_mfma_f32_16x16x32_bf16 v[200:203], v[236:239], v[148:151], v[200:203]
  v_mfma_f32_16x16x32_bf16 v[208:211], v[236:239], v[152:155], v[208:211]
  ds_read_b64_tr_b16 v[232:233], v6 offset:160
  ds_read_b64_tr_b16 v[234:235], v6 offset:128
  s_waitcnt lgkmcnt(12)
  v_mfma_f32_16x16x32_bf16 v[176:179], v[240:243], v[124:127], v[176:179]
  v_mfma_f32_16x16x32_bf16 v[184:187], v[240:243], v[128:131], v[184:187]
  v_mfma_f32_16x16x32_bf16 v[192:195], v[240:243], v[132:135], v[192:195]
  v_mfma_f32_16x16x32_bf16 v[196:199], v[240:243], v[148:151], v[196:199]
  v_mfma_f32_16x16x32_bf16 v[204:207], v[240:243], v[152:155], v[204:207]
  ds_read_b64_tr_b16 v[164:165], v5 offset:3328
  ds_read_b64_tr_b16 v[166:167], v5 offset:3360
  s_waitcnt lgkmcnt(12)
  v_mfma_f32_16x16x32_bf16 v[212:215], v[240:243], v[156:159], v[212:215]
  ds_read_b64_tr_b16 v[236:237], v6 offset:32
  ds_read_b64_tr_b16 v[238:239], v6 offset:0
  s_waitcnt lgkmcnt(12)
  v_mfma_f32_16x16x32_bf16 v[180:183], v[244:247], v[128:131], v[180:183]
  v_mfma_f32_16x16x32_bf16 v[188:191], v[244:247], v[132:135], v[188:191]
  v_mfma_f32_16x16x32_bf16 v[200:203], v[244:247], v[152:155], v[200:203]
  v_mfma_f32_16x16x32_bf16 v[208:211], v[244:247], v[156:159], v[208:211]
  s_waitcnt lgkmcnt(10)
  v_mfma_f32_16x16x32_bf16 v[176:179], v[224:227], v[128:131], v[176:179]
  v_mfma_f32_16x16x32_bf16 v[184:187], v[224:227], v[132:135], v[184:187]
  v_mfma_f32_16x16x32_bf16 v[192:195], v[224:227], v[136:139], v[192:195]
  v_mfma_f32_16x16x32_bf16 v[196:199], v[224:227], v[152:155], v[196:199]
  v_mfma_f32_16x16x32_bf16 v[204:207], v[224:227], v[156:159], v[204:207]
  s_waitcnt lgkmcnt(8)
  v_mfma_f32_16x16x32_bf16 v[212:215], v[224:227], v[160:163], v[212:215]
  s_waitcnt lgkmcnt(6)
  v_mfma_f32_16x16x32_bf16 v[180:183], v[228:231], v[132:135], v[180:183]
  v_mfma_f32_16x16x32_bf16 v[188:191], v[228:231], v[136:139], v[188:191]
  v_mfma_f32_16x16x32_bf16 v[200:203], v[228:231], v[156:159], v[200:203]
  v_mfma_f32_16x16x32_bf16 v[208:211], v[228:231], v[160:163], v[208:211]
  s_waitcnt lgkmcnt(4)
  v_mfma_f32_16x16x32_bf16 v[176:179], v[232:235], v[132:135], v[176:179]
  v_mfma_f32_16x16x32_bf16 v[184:187], v[232:235], v[136:139], v[184:187]
  v_mfma_f32_16x16x32_bf16 v[192:195], v[232:235], v[140:143], v[192:195]
  v_mfma_f32_16x16x32_bf16 v[196:199], v[232:235], v[156:159], v[196:199]
  v_mfma_f32_16x16x32_bf16 v[204:207], v[232:235], v[160:163], v[204:207]
  s_waitcnt lgkmcnt(2)
  v_mfma_f32_16x16x32_bf16 v[212:215], v[232:235], v[164:167], v[212:215]
  s_waitcnt lgkmcnt(0)
  v_mfma_f32_16x16x32_bf16 v[180:183], v[236:239], v[136:139], v[180:183]
  v_mfma_f32_16x16x32_bf16 v[188:191], v[236:239], v[140:143], v[188:191]
  v_mfma_f32_16x16x32_bf16 v[200:203], v[236:239], v[160:163], v[200:203]
  v_mfma_f32_16x16x32_bf16 v[208:211], v[236:239], v[164:167], v[208:211]
  ds_read_u16 v32, v7 offset:1536
  ds_read_u16 v33, v7 offset:1664
  ds_read_u16 v34, v7 offset:1792
  ds_read_u16 v35, v7 offset:1920
  ds_read_u16 v36, v7 offset:3072
  ds_read_u16 v37, v7 offset:3200
  ds_read_u16 v38, v7 offset:3328
  ds_read_u16 v39, v7 offset:3456
  s_nop 2
  v_add_f32 v113, v179, v182 wave_ror:1 row_mask:0x1 bank_mask:0x1
  v_add_f32 v114, v183, v186 wave_ror:1 row_mask:0x1 bank_mask:0x1
  v_add_f32 v115, v187, v190 wave_ror:1 row_mask:0x1 bank_mask:0x1
  v_add_f32 v116, v191, v194 wave_ror:1 row_mask:0x1 bank_mask:0x1
  v_add_f32 v118, v199, v202 wave_ror:1 row_mask:0x1 bank_mask:0x1
  v_add_f32 v119, v203, v206 wave_ror:1 row_mask:0x1 bank_mask:0x1
  v_add_f32 v120, v207, v210 wave_ror:1 row_mask:0x1 bank_mask:0x1
  v_add_f32 v121, v211, v214 wave_ror:1 row_mask:0x1 bank_mask:0x1
  v_add_f32 v112, v179, v178 wave_shr:1 row_mask:0xf bank_mask:0xf bound_ctrl:0
  v_add_f32 v113, v183, v182 wave_shr:1 row_mask:0xf bank_mask:0xf
  v_add_f32 v114, v187, v186 wave_shr:1 row_mask:0xf bank_mask:0xf
  v_add_f32 v115, v191, v190 wave_shr:1 row_mask:0xf bank_mask:0xf
  v_add_f32 v116, v195, v194 wave_shr:1 row_mask:0xf bank_mask:0xf
  v_add_f32 v117, v199, v198 wave_shr:1 row_mask:0xf bank_mask:0xf bound_ctrl:0
  v_add_f32 v118, v203, v202 wave_shr:1 row_mask:0xf bank_mask:0xf
  v_add_f32 v119, v207, v206 wave_shr:1 row_mask:0xf bank_mask:0xf
  v_add_f32 v120, v211, v210 wave_shr:1 row_mask:0xf bank_mask:0xf
  v_add_f32 v121, v215, v214 wave_shr:1 row_mask:0xf bank_mask:0xf
  s_waitcnt lgkmcnt(0)
  v_dot2c_f32_bf16 v180, s74, v32
  v_dot2c_f32_bf16 v184, s74, v33
  v_dot2c_f32_bf16 v188, s74, v34
  v_dot2c_f32_bf16 v192, s74, v35
  v_dot2c_f32_bf16 v200, s74, v36
  v_dot2c_f32_bf16 v204, s74, v37
  v_dot2c_f32_bf16 v208, s74, v38
  v_dot2c_f32_bf16 v212, s74, v39
  v_add_f32 v129, v112, v181 wave_ror:1 row_mask:0x1 bank_mask:0x1
  v_add_f32 v130, v113, v185 wave_ror:1 row_mask:0x1 bank_mask:0x1
  v_add_f32 v131, v114, v189 wave_ror:1 row_mask:0x1 bank_mask:0x1
  v_add_f32 v132, v115, v193 wave_ror:1 row_mask:0x1 bank_mask:0x1
  v_add_f32 v134, v117, v201 wave_ror:1 row_mask:0x1 bank_mask:0x1
  v_add_f32 v135, v118, v205 wave_ror:1 row_mask:0x1 bank_mask:0x1
  v_add_f32 v136, v119, v209 wave_ror:1 row_mask:0x1 bank_mask:0x1
  v_add_f32 v137, v120, v213 wave_ror:1 row_mask:0x1 bank_mask:0x1
  v_add_f32 v128, v112, v177 wave_shr:1 row_mask:0xf bank_mask:0xf bound_ctrl:0
  v_add_f32 v129, v113, v181 wave_shr:1 row_mask:0xf bank_mask:0xf
  v_add_f32 v130, v114, v185 wave_shr:1 row_mask:0xf bank_mask:0xf
  v_add_f32 v131, v115, v189 wave_shr:1 row_mask:0xf bank_mask:0xf
  v_add_f32 v132, v116, v193 wave_shr:1 row_mask:0xf bank_mask:0xf
  v_add_f32 v133, v117, v197 wave_shr:1 row_mask:0xf bank_mask:0xf bound_ctrl:0
  v_add_f32 v134, v118, v201 wave_shr:1 row_mask:0xf bank_mask:0xf
  v_add_f32 v135, v119, v205 wave_shr:1 row_mask:0xf bank_mask:0xf
  v_add_f32 v136, v120, v209 wave_shr:1 row_mask:0xf bank_mask:0xf
  v_add_f32 v137, v121, v213 wave_shr:1 row_mask:0xf bank_mask:0xf
  v_add_f32 v145, v128, v180 wave_ror:1 row_mask:0x1 bank_mask:0x1
  v_add_f32 v146, v129, v184 wave_ror:1 row_mask:0x1 bank_mask:0x1
  v_add_f32 v147, v130, v188 wave_ror:1 row_mask:0x1 bank_mask:0x1
  v_add_f32 v148, v131, v192 wave_ror:1 row_mask:0x1 bank_mask:0x1
  v_add_f32 v150, v133, v200 wave_ror:1 row_mask:0x1 bank_mask:0x1
  v_add_f32 v151, v134, v204 wave_ror:1 row_mask:0x1 bank_mask:0x1
  v_add_f32 v152, v135, v208 wave_ror:1 row_mask:0x1 bank_mask:0x1
  v_add_f32 v153, v136, v212 wave_ror:1 row_mask:0x1 bank_mask:0x1
  v_add_f32 v145, v129, v180 wave_shr:1 row_mask:0xf bank_mask:0xf
  v_add_f32 v146, v130, v184 wave_shr:1 row_mask:0xf bank_mask:0xf
  v_add_f32 v147, v131, v188 wave_shr:1 row_mask:0xf bank_mask:0xf
  v_add_f32 v148, v132, v192 wave_shr:1 row_mask:0xf bank_mask:0xf
  v_add_f32 v150, v134, v200 wave_shr:1 row_mask:0xf bank_mask:0xf
  v_add_f32 v151, v135, v204 wave_shr:1 row_mask:0xf bank_mask:0xf
  v_add_f32 v152, v136, v208 wave_shr:1 row_mask:0xf bank_mask:0xf
  v_add_f32 v153, v137, v212 wave_shr:1 row_mask:0xf bank_mask:0xf
  ds_write2st64_b32 v10, v145, v146 offset0:0 offset1:1
  ds_write2st64_b32 v10, v147, v148 offset0:2 offset1:3
  ds_write2st64_b32 v10, v150, v151 offset0:4 offset1:5
  ds_write2st64_b32 v10, v152, v153 offset0:6 offset1:7
  s_branch parallel_sum__ssm_conv_h3__dense_activation_gelu__prompt_kernel_Z_cfin
parallel_sum__ssm_conv_h3__dense_activation_gelu__prompt_kernel_Z_j3:
  ds_read_b64_tr_b16 v[144:145], v6 offset:928
  ds_read_b64_tr_b16 v[146:147], v6 offset:896
  ds_read_b64_tr_b16 v[112:113], v5 offset:0
  ds_read_b64_tr_b16 v[114:115], v5 offset:32
  ds_read_b64_tr_b16 v[148:149], v6 offset:2976
  ds_read_b64_tr_b16 v[150:151], v6 offset:2944
  ds_read_b64_tr_b16 v[128:129], v5 offset:2048
  ds_read_b64_tr_b16 v[130:131], v5 offset:2080
  ds_read_b64_tr_b16 v[152:153], v6 offset:800
  ds_read_b64_tr_b16 v[154:155], v6 offset:768
  ds_read_b64_tr_b16 v[156:157], v6 offset:2848
  ds_read_b64_tr_b16 v[158:159], v6 offset:2816
  ds_read_b64_tr_b16 v[160:161], v6 offset:672
  ds_read_b64_tr_b16 v[162:163], v6 offset:640
  ds_read_b64_tr_b16 v[164:165], v6 offset:2720
  ds_read_b64_tr_b16 v[166:167], v6 offset:2688
  buffer_load_dwordx2 v[108:109], v53, s[24:27], s23 offen
  buffer_load_dwordx4 v[64:67], v52, s[24:27], s30 offen sc1
  s_lshl_b32 s44, s4, 16
  s_and_b32 s45, s4, 0xffff0000
  s_lshl_b32 s46, s5, 16
  s_and_b32 s47, s5, 0xffff0000
  s_lshl_b32 s48, s6, 16
  s_and_b32 s49, s6, 0xffff0000
  s_lshl_b32 s50, s7, 16
  s_and_b32 s51, s7, 0xffff0000
  s_waitcnt lgkmcnt(12)
  v_mfma_f32_16x16x32_bf16 v[204:207], v[144:147], v[112:115], 0
  ds_read_b64_tr_b16 v[116:117], v5 offset:256
  ds_read_b64_tr_b16 v[118:119], v5 offset:288
  ds_read_b64_tr_b16 v[132:133], v5 offset:2304
  ds_read_b64_tr_b16 v[134:135], v5 offset:2336
  buffer_load_dwordx4 v[68:71], v54, s[24:27], s30 offen sc1
  s_waitcnt lgkmcnt(12)
  v_mfma_f32_16x16x32_bf16 v[236:239], v[148:151], v[128:131], 0
  ds_read_b64_tr_b16 v[144:145], v6 offset:544
  ds_read_b64_tr_b16 v[146:147], v6 offset:512
  s_waitcnt lgkmcnt(12)
  v_mfma_f32_16x16x32_bf16 v[200:203], v[152:155], v[112:115], 0
  ds_read_b64_tr_b16 v[148:149], v6 offset:2592
  ds_read_b64_tr_b16 v[150:151], v6 offset:2560
  s_waitcnt lgkmcnt(12)
  v_mfma_f32_16x16x32_bf16 v[232:235], v[156:159], v[128:131], 0
  ds_read_b64_tr_b16 v[152:153], v6 offset:416
  ds_read_b64_tr_b16 v[154:155], v6 offset:384
  s_waitcnt lgkmcnt(12)
  v_mfma_f32_16x16x32_bf16 v[196:199], v[160:163], v[112:115], 0
  ds_read_b64_tr_b16 v[156:157], v6 offset:2464
  ds_read_b64_tr_b16 v[158:159], v6 offset:2432
  s_waitcnt lgkmcnt(12)
  v_mfma_f32_16x16x32_bf16 v[228:231], v[164:167], v[128:131], 0
  ds_read_b64_tr_b16 v[120:121], v5 offset:512
  ds_read_b64_tr_b16 v[122:123], v5 offset:544
  s_waitcnt lgkmcnt(12)
  v_mfma_f32_16x16x32_bf16 v[204:207], v[160:163], v[116:119], v[204:207]
  ds_read_b64_tr_b16 v[136:137], v5 offset:2560
  ds_read_b64_tr_b16 v[138:139], v5 offset:2592
  s_waitcnt lgkmcnt(12)
  v_mfma_f32_16x16x32_bf16 v[236:239], v[164:167], v[132:135], v[236:239]
  ds_read_b64_tr_b16 v[160:161], v6 offset:288
  ds_read_b64_tr_b16 v[162:163], v6 offset:256
  buffer_load_dwordx4 v[76:79], v52, s[24:27], s11 offen sc1
  s_waitcnt lgkmcnt(12)
  v_mfma_f32_16x16x32_bf16 v[192:195], v[144:147], v[112:115], 0
  ds_read_b64_tr_b16 v[164:165], v6 offset:2336
  ds_read_b64_tr_b16 v[166:167], v6 offset:2304
  s_waitcnt lgkmcnt(12)
  v_mfma_f32_16x16x32_bf16 v[224:227], v[148:151], v[128:131], 0
  v_mfma_f32_16x16x32_bf16 v[200:203], v[144:147], v[116:119], v[200:203]
  buffer_load_dwordx4 v[80:83], v52, s[24:27], s20 offen sc1
  v_mfma_f32_16x16x32_bf16 v[232:235], v[148:151], v[132:135], v[232:235]
  ds_read_b64_tr_b16 v[144:145], v6 offset:160
  ds_read_b64_tr_b16 v[146:147], v6 offset:128
  s_waitcnt lgkmcnt(12)
  v_mfma_f32_16x16x32_bf16 v[188:191], v[152:155], v[112:115], 0
  ds_read_b64_tr_b16 v[148:149], v6 offset:2208
  ds_read_b64_tr_b16 v[150:151], v6 offset:2176
  s_waitcnt lgkmcnt(12)
  v_mfma_f32_16x16x32_bf16 v[220:223], v[156:159], v[128:131], 0
  buffer_load_dwordx4 v[84:87], v52, s[24:27], s21 offen sc1
  v_mfma_f32_16x16x32_bf16 v[196:199], v[152:155], v[116:119], v[196:199]
  v_mfma_f32_16x16x32_bf16 v[228:231], v[156:159], v[132:135], v[228:231]
  ds_read_b64_tr_b16 v[124:125], v5 offset:768
  ds_read_b64_tr_b16 v[126:127], v5 offset:800
  s_waitcnt lgkmcnt(12)
  v_mfma_f32_16x16x32_bf16 v[204:207], v[152:155], v[120:123], v[204:207]
  ds_read_b64_tr_b16 v[140:141], v5 offset:2816
  ds_read_b64_tr_b16 v[142:143], v5 offset:2848
  buffer_load_dwordx4 v[88:91], v52, s[24:27], s22 offen sc1
  s_waitcnt lgkmcnt(12)
  v_mfma_f32_16x16x32_bf16 v[236:239], v[156:159], v[136:139], v[236:239]
  ds_read_b64_tr_b16 v[152:153], v6 offset:32
  ds_read_b64_tr_b16 v[154:155], v6 offset:0
  s_waitcnt lgkmcnt(12)
  v_mfma_f32_16x16x32_bf16 v[184:187], v[160:163], v[112:115], 0
  ds_read_b64_tr_b16 v[156:157], v6 offset:2080
  ds_read_b64_tr_b16 v[158:159], v6 offset:2048
  s_waitcnt lgkmcnt(12)
  v_mfma_f32_16x16x32_bf16 v[216:219], v[164:167], v[128:131], 0
  buffer_load_dwordx4 v[16:19], v54, s[24:27], s11 offen sc1
  v_mfma_f32_16x16x32_bf16 v[192:195], v[160:163], v[116:119], v[192:195]
  v_mfma_f32_16x16x32_bf16 v[224:227], v[164:167], v[132:135], v[224:227]
  v_mfma_f32_16x16x32_bf16 v[200:203], v[160:163], v[120:123], v[200:203]
  buffer_load_dwordx4 v[20:23], v54, s[24:27], s20 offen sc1
  v_mfma_f32_16x16x32_bf16 v[232:235], v[164:167], v[136:139], v[232:235]
  s_waitcnt lgkmcnt(10)
  v_mfma_f32_16x16x32_bf16 v[180:183], v[144:147], v[112:115], 0
  s_waitcnt lgkmcnt(8)
  v_mfma_f32_16x16x32_bf16 v[212:215], v[148:151], v[128:131], 0
  buffer_load_dwordx4 v[24:27], v54, s[24:27], s21 offen sc1
  v_mfma_f32_16x16x32_bf16 v[188:191], v[144:147], v[116:119], v[188:191]
  v_mfma_f32_16x16x32_bf16 v[220:223], v[148:151], v[132:135], v[220:223]
  v_mfma_f32_16x16x32_bf16 v[196:199], v[144:147], v[120:123], v[196:199]
  buffer_load_dwordx4 v[28:31], v54, s[24:27], s22 offen sc1
  v_mfma_f32_16x16x32_bf16 v[228:231], v[148:151], v[136:139], v[228:231]
  s_waitcnt lgkmcnt(6)
  v_mfma_f32_16x16x32_bf16 v[204:207], v[144:147], v[124:127], v[204:207]
  s_waitcnt lgkmcnt(4)
  v_mfma_f32_16x16x32_bf16 v[236:239], v[148:151], v[140:143], v[236:239]
  s_waitcnt lgkmcnt(2)
  v_mfma_f32_16x16x32_bf16 v[176:179], v[152:155], v[112:115], 0
  s_waitcnt lgkmcnt(0)
  v_mfma_f32_16x16x32_bf16 v[208:211], v[156:159], v[128:131], 0
  v_mfma_f32_16x16x32_bf16 v[184:187], v[152:155], v[116:119], v[184:187]
  v_mfma_f32_16x16x32_bf16 v[216:219], v[156:159], v[132:135], v[216:219]
  v_mfma_f32_16x16x32_bf16 v[192:195], v[152:155], v[120:123], v[192:195]
  v_mfma_f32_16x16x32_bf16 v[224:227], v[156:159], v[136:139], v[224:227]
  v_mfma_f32_16x16x32_bf16 v[200:203], v[152:155], v[124:127], v[200:203]
  v_mfma_f32_16x16x32_bf16 v[232:235], v[156:159], v[140:143], v[232:235]
  ds_read_u16 v32, v7 offset:0
  ds_read_u16 v33, v7 offset:128
  ds_read_u16 v34, v7 offset:256
  ds_read_u16 v35, v7 offset:384
  ds_read_u16 v36, v7 offset:512
  ds_read_u16 v37, v7 offset:640
  ds_read_u16 v38, v7 offset:768
  ds_read_u16 v39, v7 offset:896
  ds_read_u16 v40, v7 offset:2048
  ds_read_u16 v41, v7 offset:2176
  ds_read_u16 v42, v7 offset:2304
  ds_read_u16 v43, v7 offset:2432
  ds_read_u16 v44, v7 offset:2560
  ds_read_u16 v45, v7 offset:2688
  ds_read_u16 v46, v7 offset:2816
  ds_read_u16 v47, v7 offset:2944
  s_nop 2
  v_add_f32 v113, v179, v182 wave_ror:1 row_mask:0x1 bank_mask:0x1
  v_add_f32 v114, v183, v186 wave_ror:1 row_mask:0x1 bank_mask:0x1
  v_add_f32 v115, v187, v190 wave_ror:1 row_mask:0x1 bank_mask:0x1
  v_add_f32 v116, v191, v194 wave_ror:1 row_mask:0x1 bank_mask:0x1
  v_add_f32 v117, v195, v198 wave_ror:1 row_mask:0x1 bank_mask:0x1
  v_add_f32 v118, v199, v202 wave_ror:1 row_mask:0x1 bank_mask:0x1
  v_add_f32 v119, v203, v206 wave_ror:1 row_mask:0x1 bank_mask:0x1
  v_add_f32 v121, v211, v214 wave_ror:1 row_mask:0x1 bank_mask:0x1
  v_add_f32 v122, v215, v218 wave_ror:1 row_mask:0x1 bank_mask:0x1
  v_add_f32 v123, v219, v222 wave_ror:1 row_mask:0x1 bank_mask:0x1
  v_add_f32 v124, v223, v226 wave_ror:1 row_mask:0x1 bank_mask:0x1
  v_add_f32 v125, v227, v230 wave_ror:1 row_mask:0x1 bank_mask:0x1
  v_add_f32 v126, v231, v234 wave_ror:1 row_mask:0x1 bank_mask:0x1
  v_add_f32 v127, v235, v238 wave_ror:1 row_mask:0x1 bank_mask:0x1
  v_add_f32 v112, v179, v178 wave_shr:1 row_mask:0xf bank_mask:0xf bound_ctrl:0
  v_add_f32 v113, v183, v182 wave_shr:1 row_mask:0xf bank_mask:0xf
  v_add_f32 v114, v187, v186 wave_shr:1 row_mask:0xf bank_mask:0xf
  v_add_f32 v115, v191, v190 wave_shr:1 row_mask:0xf bank_mask:0xf
  v_add_f32 v116, v195, v194 wave_shr:1 row_mask:0xf bank_mask:0xf
  v_add_f32 v117, v199, v198 wave_shr:1 row_mask:0xf bank_mask:0xf
  v_add_f32 v118, v203, v202 wave_shr:1 row_mask:0xf bank_mask:0xf
  v_add_f32 v119, v207, v206 wave_shr:1 row_mask:0xf bank_mask:0xf
  v_add_f32 v120, v211, v210 wave_shr:1 row_mask:0xf bank_mask:0xf bound_ctrl:0
  v_add_f32 v121, v215, v214 wave_shr:1 row_mask:0xf bank_mask:0xf
  v_add_f32 v122, v219, v218 wave_shr:1 row_mask:0xf bank_mask:0xf
  v_add_f32 v123, v223, v222 wave_shr:1 row_mask:0xf bank_mask:0xf
  v_add_f32 v124, v227, v226 wave_shr:1 row_mask:0xf bank_mask:0xf
  v_add_f32 v125, v231, v230 wave_shr:1 row_mask:0xf bank_mask:0xf
  v_add_f32 v126, v235, v234 wave_shr:1 row_mask:0xf bank_mask:0xf
  v_add_f32 v127, v239, v238 wave_shr:1 row_mask:0xf bank_mask:0xf
  s_waitcnt lgkmcnt(0)
  v_dot2c_f32_bf16 v176, s74, v32
  v_dot2c_f32_bf16 v180, s74, v33
  v_dot2c_f32_bf16 v184, s74, v34
  v_dot2c_f32_bf16 v188, s74, v35
  v_dot2c_f32_bf16 v192, s74, v36
  v_dot2c_f32_bf16 v196, s74, v37
  v_dot2c_f32_bf16 v200, s74, v38
  v_dot2c_f32_bf16 v204, s74, v39
  v_dot2c_f32_bf16 v208, s79, v40
  v_dot2c_f32_bf16 v212, s79, v41
  v_dot2c_f32_bf16 v216, s79, v42
  v_dot2c_f32_bf16 v220, s79, v43
  v_dot2c_f32_bf16 v224, s79, v44
  v_dot2c_f32_bf16 v228, s79, v45
  v_dot2c_f32_bf16 v232, s79, v46
  v_dot2c_f32_bf16 v236, s79, v47
  v_add_f32 v129, v112, v181 wave_ror:1 row_mask:0x1 bank_mask:0x1
  v_add_f32 v130, v113, v185 wave_ror:1 row_mask:0x1 bank_mask:0x1
  v_add_f32 v131, v114, v189 wave_ror:1 row_mask:0x1 bank_mask:0x1
  v_add_f32 v132, v115, v193 wave_ror:1 row_mask:0x1 bank_mask:0x1
  v_add_f32 v133, v116, v197 wave_ror:1 row_mask:0x1 bank_mask:0x1
  v_add_f32 v134, v117, v201 wave_ror:1 row_mask:0x1 bank_mask:0x1
  v_add_f32 v135, v118, v205 wave_ror:1 row_mask:0x1 bank_mask:0x1
  v_add_f32 v137, v120, v213 wave_ror:1 row_mask:0x1 bank_mask:0x1
  v_add_f32 v138, v121, v217 wave_ror:1 row_mask:0x1 bank_mask:0x1
  v_add_f32 v139, v122, v221 wave_ror:1 row_mask:0x1 bank_mask:0x1
  v_add_f32 v140, v123, v225 wave_ror:1 row_mask:0x1 bank_mask:0x1
  v_add_f32 v141, v124, v229 wave_ror:1 row_mask:0x1 bank_mask:0x1
  v_add_f32 v142, v125, v233 wave_ror:1 row_mask:0x1 bank_mask:0x1
  v_add_f32 v143, v126, v237 wave_ror:1 row_mask:0x1 bank_mask:0x1
  v_add_f32 v128, v112, v177 wave_shr:1 row_mask:0xf bank_mask:0xf bound_ctrl:0
  v_add_f32 v129, v113, v181 wave_shr:1 row_mask:0xf bank_mask:0xf
  v_add_f32 v130, v114, v185 wave_shr:1 row_mask:0xf bank_mask:0xf
  v_add_f32 v131, v115, v189 wave_shr:1 row_mask:0xf bank_mask:0xf
  v_add_f32 v132, v116, v193 wave_shr:1 row_mask:0xf bank_mask:0xf
  v_add_f32 v133, v117, v197 wave_shr:1 row_mask:0xf bank_mask:0xf
  v_add_f32 v134, v118, v201 wave_shr:1 row_mask:0xf bank_mask:0xf
  v_add_f32 v135, v119, v205 wave_shr:1 row_mask:0xf bank_mask:0xf
  v_add_f32 v136, v120, v209 wave_shr:1 row_mask:0xf bank_mask:0xf bound_ctrl:0
  v_add_f32 v137, v121, v213 wave_shr:1 row_mask:0xf bank_mask:0xf
  v_add_f32 v138, v122, v217 wave_shr:1 row_mask:0xf bank_mask:0xf
  v_add_f32 v139, v123, v221 wave_shr:1 row_mask:0xf bank_mask:0xf
  v_add_f32 v140, v124, v225 wave_shr:1 row_mask:0xf bank_mask:0xf
  v_add_f32 v141, v125, v229 wave_shr:1 row_mask:0xf bank_mask:0xf
  v_add_f32 v142, v126, v233 wave_shr:1 row_mask:0xf bank_mask:0xf
  v_add_f32 v143, v127, v237 wave_shr:1 row_mask:0xf bank_mask:0xf
  v_add_f32 v145, v128, v180 wave_ror:1 row_mask:0x1 bank_mask:0x1
  v_add_f32 v146, v129, v184 wave_ror:1 row_mask:0x1 bank_mask:0x1
  v_add_f32 v147, v130, v188 wave_ror:1 row_mask:0x1 bank_mask:0x1
  v_add_f32 v148, v131, v192 wave_ror:1 row_mask:0x1 bank_mask:0x1
  v_add_f32 v149, v132, v196 wave_ror:1 row_mask:0x1 bank_mask:0x1
  v_add_f32 v150, v133, v200 wave_ror:1 row_mask:0x1 bank_mask:0x1
  v_add_f32 v151, v134, v204 wave_ror:1 row_mask:0x1 bank_mask:0x1
  v_add_f32 v153, v136, v212 wave_ror:1 row_mask:0x1 bank_mask:0x1
  v_add_f32 v154, v137, v216 wave_ror:1 row_mask:0x1 bank_mask:0x1
  v_add_f32 v155, v138, v220 wave_ror:1 row_mask:0x1 bank_mask:0x1
  v_add_f32 v156, v139, v224 wave_ror:1 row_mask:0x1 bank_mask:0x1
  v_add_f32 v157, v140, v228 wave_ror:1 row_mask:0x1 bank_mask:0x1
  v_add_f32 v158, v141, v232 wave_ror:1 row_mask:0x1 bank_mask:0x1
  v_add_f32 v159, v142, v236 wave_ror:1 row_mask:0x1 bank_mask:0x1
  v_add_f32 v144, v128, v176 wave_shr:1 row_mask:0xf bank_mask:0xf bound_ctrl:0
  v_add_f32 v145, v129, v180 wave_shr:1 row_mask:0xf bank_mask:0xf
  v_add_f32 v146, v130, v184 wave_shr:1 row_mask:0xf bank_mask:0xf
  v_add_f32 v147, v131, v188 wave_shr:1 row_mask:0xf bank_mask:0xf
  v_add_f32 v148, v132, v192 wave_shr:1 row_mask:0xf bank_mask:0xf
  v_add_f32 v149, v133, v196 wave_shr:1 row_mask:0xf bank_mask:0xf
  v_add_f32 v150, v134, v200 wave_shr:1 row_mask:0xf bank_mask:0xf
  v_add_f32 v151, v135, v204 wave_shr:1 row_mask:0xf bank_mask:0xf
  v_add_f32 v152, v136, v208 wave_shr:1 row_mask:0xf bank_mask:0xf bound_ctrl:0
  v_add_f32 v153, v137, v212 wave_shr:1 row_mask:0xf bank_mask:0xf
  v_add_f32 v154, v138, v216 wave_shr:1 row_mask:0xf bank_mask:0xf
  v_add_f32 v155, v139, v220 wave_shr:1 row_mask:0xf bank_mask:0xf
  v_add_f32 v156, v140, v224 wave_shr:1 row_mask:0xf bank_mask:0xf
  v_add_f32 v157, v141, v228 wave_shr:1 row_mask:0xf bank_mask:0xf
  v_add_f32 v158, v142, v232 wave_shr:1 row_mask:0xf bank_mask:0xf
  v_add_f32 v159, v143, v236 wave_shr:1 row_mask:0xf bank_mask:0xf
  ds_write2st64_b32 v10, v144, v145 offset0:0 offset1:1
  ds_write2st64_b32 v10, v146, v147 offset0:2 offset1:3
  ds_write2st64_b32 v10, v148, v149 offset0:4 offset1:5
  ds_write2st64_b32 v10, v150, v151 offset0:6 offset1:7
  ds_write2st64_b32 v10, v152, v153 offset0:8 offset1:9
  ds_write2st64_b32 v10, v154, v155 offset0:10 offset1:11
  ds_write2st64_b32 v10, v156, v157 offset0:12 offset1:13
  ds_write2st64_b32 v10, v158, v159 offset0:14 offset1:15
  s_branch parallel_sum__ssm_conv_h3__dense_activation_gelu__prompt_kernel_Z_cfin
parallel_sum__ssm_conv_h3__dense_activation_gelu__prompt_kernel_Z_j2:
  ds_read_b64_tr_b16 v[224:225], v6 offset:2976
  ds_read_b64_tr_b16 v[226:227], v6 offset:2944
  ds_read_b64_tr_b16 v[112:113], v5 offset:0
  ds_read_b64_tr_b16 v[114:115], v5 offset:32
  ds_read_b64_tr_b16 v[228:229], v6 offset:2848
  ds_read_b64_tr_b16 v[230:231], v6 offset:2816
  ds_read_b64_tr_b16 v[232:233], v6 offset:2720
  ds_read_b64_tr_b16 v[234:235], v6 offset:2688
  ds_read_b64_tr_b16 v[116:117], v5 offset:256
  ds_read_b64_tr_b16 v[118:119], v5 offset:288
  ds_read_b64_tr_b16 v[236:237], v6 offset:2592
  ds_read_b64_tr_b16 v[238:239], v6 offset:2560
  ds_read_b64_tr_b16 v[240:241], v6 offset:2464
  ds_read_b64_tr_b16 v[242:243], v6 offset:2432
  ds_read_b64_tr_b16 v[120:121], v5 offset:512
  ds_read_b64_tr_b16 v[122:123], v5 offset:544
  s_waitcnt lgkmcnt(12)
  v_mfma_f32_16x16x32_bf16 v[208:211], v[224:227], v[112:115], 0
  ds_read_b64_tr_b16 v[244:245], v6 offset:2336
  ds_read_b64_tr_b16 v[246:247], v6 offset:2304
  s_waitcnt lgkmcnt(12)
  v_mfma_f32_16x16x32_bf16 v[204:207], v[228:231], v[112:115], 0
  ds_read_b64_tr_b16 v[224:225], v6 offset:2208
  ds_read_b64_tr_b16 v[226:227], v6 offset:2176
  buffer_load_dwordx2 v[108:109], v53, s[24:27], s23 offen
  s_waitcnt lgkmcnt(12)
  v_mfma_f32_16x16x32_bf16 v[200:203], v[232:235], v[112:115], 0
  ds_read_b64_tr_b16 v[124:125], v5 offset:768
  ds_read_b64_tr_b16 v[126:127], v5 offset:800
  s_waitcnt lgkmcnt(12)
  v_mfma_f32_16x16x32_bf16 v[208:211], v[232:235], v[116:119], v[208:211]
  ds_read_b64_tr_b16 v[228:229], v6 offset:2080
  ds_read_b64_tr_b16 v[230:231], v6 offset:2048
  s_waitcnt lgkmcnt(12)
  v_mfma_f32_16x16x32_bf16 v[196:199], v[236:239], v[112:115], 0
  v_mfma_f32_16x16x32_bf16 v[204:207], v[236:239], v[116:119], v[204:207]
  ds_read_b64_tr_b16 v[232:233], v6 offset:1952
  ds_read_b64_tr_b16 v[234:235], v6 offset:1920
  buffer_load_dwordx4 v[64:67], v52, s[24:27], s30 offen sc1
  s_waitcnt lgkmcnt(12)
  v_mfma_f32_16x16x32_bf16 v[192:195], v[240:243], v[112:115], 0
  v_mfma_f32_16x16x32_bf16 v[200:203], v[240:243], v[116:119], v[200:203]
  ds_read_b64_tr_b16 v[128:129], v5 offset:1024
  ds_read_b64_tr_b16 v[130:131], v5 offset:1056
  s_waitcnt lgkmcnt(12)
  v_mfma_f32_16x16x32_bf16 v[208:211], v[240:243], v[120:123], v[208:211]
  ds_read_b64_tr_b16 v[236:237], v6 offset:1824
  ds_read_b64_tr_b16 v[238:239], v6 offset:1792
  s_waitcnt lgkmcnt(12)
  v_mfma_f32_16x16x32_bf16 v[188:191], v[244:247], v[112:115], 0
  v_mfma_f32_16x16x32_bf16 v[196:199], v[244:247], v[116:119], v[196:199]
  v_mfma_f32_16x16x32_bf16 v[204:207], v[244:247], v[120:123], v[204:207]
  ds_read_b64_tr_b16 v[240:241], v6 offset:1696
  ds_read_b64_tr_b16 v[242:243], v6 offset:1664
  s_waitcnt lgkmcnt(12)
  v_mfma_f32_16x16x32_bf16 v[184:187], v[224:227], v[112:115], 0
  v_mfma_f32_16x16x32_bf16 v[192:195], v[224:227], v[116:119], v[192:195]
  v_mfma_f32_16x16x32_bf16 v[200:203], v[224:227], v[120:123], v[200:203]
  ds_read_b64_tr_b16 v[132:133], v5 offset:1280
  ds_read_b64_tr_b16 v[134:135], v5 offset:1312
  s_waitcnt lgkmcnt(12)
  v_mfma_f32_16x16x32_bf16 v[208:211], v[224:227], v[124:127], v[208:211]
  ds_read_b64_tr_b16 v[244:245], v6 offset:1568
  ds_read_b64_tr_b16 v[246:247], v6 offset:1536
  s_waitcnt lgkmcnt(12)
  v_mfma_f32_16x16x32_bf16 v[180:183], v[228:231], v[112:115], 0
  v_mfma_f32_16x16x32_bf16 v[188:191], v[228:231], v[116:119], v[188:191]
  v_mfma_f32_16x16x32_bf16 v[196:199], v[228:231], v[120:123], v[196:199]
  v_mfma_f32_16x16x32_bf16 v[204:207], v[228:231], v[124:127], v[204:207]
  ds_read_b64_tr_b16 v[224:225], v6 offset:1440
  ds_read_b64_tr_b16 v[226:227], v6 offset:1408
  s_waitcnt lgkmcnt(12)
  v_mfma_f32_16x16x32_bf16 v[176:179], v[232:235], v[112:115], 0
  v_mfma_f32_16x16x32_bf16 v[184:187], v[232:235], v[116:119], v[184:187]
  v_mfma_f32_16x16x32_bf16 v[192:195], v[232:235], v[120:123], v[192:195]
  v_mfma_f32_16x16x32_bf16 v[200:203], v[232:235], v[124:127], v[200:203]
  ds_read_b64_tr_b16 v[136:137], v5 offset:1536
  ds_read_b64_tr_b16 v[138:139], v5 offset:1568
  s_waitcnt lgkmcnt(12)
  v_mfma_f32_16x16x32_bf16 v[208:211], v[232:235], v[128:131], v[208:211]
  ds_read_b64_tr_b16 v[228:229], v6 offset:1312
  ds_read_b64_tr_b16 v[230:231], v6 offset:1280
  s_waitcnt lgkmcnt(12)
  v_mfma_f32_16x16x32_bf16 v[180:183], v[236:239], v[116:119], v[180:183]
  v_mfma_f32_16x16x32_bf16 v[188:191], v[236:239], v[120:123], v[188:191]
  v_mfma_f32_16x16x32_bf16 v[196:199], v[236:239], v[124:127], v[196:199]
  buffer_load_dwordx4 v[76:79], v52, s[24:27], s11 offen sc1
  v_mfma_f32_16x16x32_bf16 v[204:207], v[236:239], v[128:131], v[204:207]
  ds_read_b64_tr_b16 v[232:233], v6 offset:1184
  ds_read_b64_tr_b16 v[234:235], v6 offset:1152
  s_waitcnt lgkmcnt(12)
  v_mfma_f32_16x16x32_bf16 v[176:179], v[240:243], v[116:119], v[176:179]
  buffer_load_dwordx4 v[80:83], v52, s[24:27], s20 offen sc1
  v_mfma_f32_16x16x32_bf16 v[184:187], v[240:243], v[120:123], v[184:187]
  v_mfma_f32_16x16x32_bf16 v[192:195], v[240:243], v[124:127], v[192:195]
  buffer_load_dwordx4 v[84:87], v52, s[24:27], s21 offen sc1
  v_mfma_f32_16x16x32_bf16 v[200:203], v[240:243], v[128:131], v[200:203]
  ds_read_b64_tr_b16 v[140:141], v5 offset:1792
  ds_read_b64_tr_b16 v[142:143], v5 offset:1824
  s_waitcnt lgkmcnt(12)
  v_mfma_f32_16x16x32_bf16 v[208:211], v[240:243], v[132:135], v[208:211]
  ds_read_b64_tr_b16 v[236:237], v6 offset:1056
  ds_read_b64_tr_b16 v[238:239], v6 offset:1024
  buffer_load_dwordx4 v[88:91], v52, s[24:27], s22 offen sc1
  s_waitcnt lgkmcnt(12)
  v_mfma_f32_16x16x32_bf16 v[180:183], v[244:247], v[120:123], v[180:183]
  v_mfma_f32_16x16x32_bf16 v[188:191], v[244:247], v[124:127], v[188:191]
  v_mfma_f32_16x16x32_bf16 v[196:199], v[244:247], v[128:131], v[196:199]
  v_mfma_f32_16x16x32_bf16 v[204:207], v[244:247], v[132:135], v[204:207]
  ds_read_b64_tr_b16 v[240:241], v6 offset:928
  ds_read_b64_tr_b16 v[242:243], v6 offset:896
  s_waitcnt lgkmcnt(12)
  v_mfma_f32_16x16x32_bf16 v[176:179], v[224:227], v[120:123], v[176:179]
  v_mfma_f32_16x16x32_bf16 v[184:187], v[224:227], v[124:127], v[184:187]
  v_mfma_f32_16x16x32_bf16 v[192:195], v[224:227], v[128:131], v[192:195]
  v_mfma_f32_16x16x32_bf16 v[200:203], v[224:227], v[132:135], v[200:203]
  ds_read_b64_tr_b16 v[144:145], v5 offset:2048
  ds_read_b64_tr_b16 v[146:147], v5 offset:2080
  s_waitcnt lgkmcnt(12)
  v_mfma_f32_16x16x32_bf16 v[208:211], v[224:227], v[136:139], v[208:211]
  ds_read_b64_tr_b16 v[244:245], v6 offset:800
  ds_read_b64_tr_b16 v[246:247], v6 offset:768
  s_waitcnt lgkmcnt(12)
  v_mfma_f32_16x16x32_bf16 v[180:183], v[228:231], v[124:127], v[180:183]
  v_mfma_f32_16x16x32_bf16 v[188:191], v[228:231], v[128:131], v[188:191]
  v_mfma_f32_16x16x32_bf16 v[196:199], v[228:231], v[132:135], v[196:199]
  v_mfma_f32_16x16x32_bf16 v[204:207], v[228:231], v[136:139], v[204:207]
  ds_read_b64_tr_b16 v[224:225], v6 offset:672
  ds_read_b64_tr_b16 v[226:227], v6 offset:640
  s_waitcnt lgkmcnt(12)
  v_mfma_f32_16x16x32_bf16 v[176:179], v[232:235], v[124:127], v[176:179]
  v_mfma_f32_16x16x32_bf16 v[184:187], v[232:235], v[128:131], v[184:187]
  v_mfma_f32_16x16x32_bf16 v[192:195], v[232:235], v[132:135], v[192:195]
  v_mfma_f32_16x16x32_bf16 v[200:203], v[232:235], v[136:139], v[200:203]
  ds_read_b64_tr_b16 v[148:149], v5 offset:2304
  ds_read_b64_tr_b16 v[150:151], v5 offset:2336
  s_waitcnt lgkmcnt(12)
  v_mfma_f32_16x16x32_bf16 v[208:211], v[232:235], v[140:143], v[208:211]
  ds_read_b64_tr_b16 v[228:229], v6 offset:544
  ds_read_b64_tr_b16 v[230:231], v6 offset:512
  s_waitcnt lgkmcnt(12)
  v_mfma_f32_16x16x32_bf16 v[180:183], v[236:239], v[128:131], v[180:183]
  v_mfma_f32_16x16x32_bf16 v[188:191], v[236:239], v[132:135], v[188:191]
  v_mfma_f32_16x16x32_bf16 v[196:199], v[236:239], v[136:139], v[196:199]
  v_mfma_f32_16x16x32_bf16 v[204:207], v[236:239], v[140:143], v[204:207]
  ds_read_b64_tr_b16 v[232:233], v6 offset:416
  ds_read_b64_tr_b16 v[234:235], v6 offset:384
  s_waitcnt lgkmcnt(12)
  v_mfma_f32_16x16x32_bf16 v[176:179], v[240:243], v[128:131], v[176:179]
  v_mfma_f32_16x16x32_bf16 v[184:187], v[240:243], v[132:135], v[184:187]
  v_mfma_f32_16x16x32_bf16 v[192:195], v[240:243], v[136:139], v[192:195]
  v_mfma_f32_16x16x32_bf16 v[200:203], v[240:243], v[140:143], v[200:203]
  ds_read_b64_tr_b16 v[152:153], v5 offset:2560
  ds_read_b64_tr_b16 v[154:155], v5 offset:2592
  s_waitcnt lgkmcnt(12)
  v_mfma_f32_16x16x32_bf16 v[208:211], v[240:243], v[144:147], v[208:211]
  ds_read_b64_tr_b16 v[236:237], v6 offset:288
  ds_read_b64_tr_b16 v[238:239], v6 offset:256
  s_waitcnt lgkmcnt(12)
  v_mfma_f32_16x16x32_bf16 v[180:183], v[244:247], v[132:135], v[180:183]
  v_mfma_f32_16x16x32_bf16 v[188:191], v[244:247], v[136:139], v[188:191]
  v_mfma_f32_16x16x32_bf16 v[196:199], v[244:247], v[140:143], v[196:199]
  v_mfma_f32_16x16x32_bf16 v[204:207], v[244:247], v[144:147], v[204:207]
  ds_read_b64_tr_b16 v[240:241], v6 offset:160
  ds_read_b64_tr_b16 v[242:243], v6 offset:128
  s_waitcnt lgkmcnt(12)
  v_mfma_f32_16x16x32_bf16 v[176:179], v[224:227], v[132:135], v[176:179]
  v_mfma_f32_16x16x32_bf16 v[184:187], v[224:227], v[136:139], v[184:187]
  v_mfma_f32_16x16x32_bf16 v[192:195], v[224:227], v[140:143], v[192:195]
  v_mfma_f32_16x16x32_bf16 v[200:203], v[224:227], v[144:147], v[200:203]
  ds_read_b64_tr_b16 v[156:157], v5 offset:2816
  ds_read_b64_tr_b16 v[158:159], v5 offset:2848
  s_waitcnt lgkmcnt(12)
  v_mfma_f32_16x16x32_bf16 v[208:211], v[224:227], v[148:151], v[208:211]
  ds_read_b64_tr_b16 v[244:245], v6 offset:32
  ds_read_b64_tr_b16 v[246:247], v6 offset:0
  s_waitcnt lgkmcnt(12)
  v_mfma_f32_16x16x32_bf16 v[180:183], v[228:231], v[136:139], v[180:183]
  v_mfma_f32_16x16x32_bf16 v[188:191], v[228:231], v[140:143], v[188:191]
  v_mfma_f32_16x16x32_bf16 v[196:199], v[228:231], v[144:147], v[196:199]
  v_mfma_f32_16x16x32_bf16 v[204:207], v[228:231], v[148:151], v[204:207]
  s_waitcnt lgkmcnt(10)
  v_mfma_f32_16x16x32_bf16 v[176:179], v[232:235], v[136:139], v[176:179]
  v_mfma_f32_16x16x32_bf16 v[184:187], v[232:235], v[140:143], v[184:187]
  v_mfma_f32_16x16x32_bf16 v[192:195], v[232:235], v[144:147], v[192:195]
  v_mfma_f32_16x16x32_bf16 v[200:203], v[232:235], v[148:151], v[200:203]
  s_waitcnt lgkmcnt(8)
  v_mfma_f32_16x16x32_bf16 v[208:211], v[232:235], v[152:155], v[208:211]
  s_waitcnt lgkmcnt(6)
  v_mfma_f32_16x16x32_bf16 v[180:183], v[236:239], v[140:143], v[180:183]
  v_mfma_f32_16x16x32_bf16 v[188:191], v[236:239], v[144:147], v[188:191]
  v_mfma_f32_16x16x32_bf16 v[196:199], v[236:239], v[148:151], v[196:199]
  v_mfma_f32_16x16x32_bf16 v[204:207], v[236:239], v[152:155], v[204:207]
  s_waitcnt lgkmcnt(4)
  v_mfma_f32_16x16x32_bf16 v[176:179], v[240:243], v[140:143], v[176:179]
  v_mfma_f32_16x16x32_bf16 v[184:187], v[240:243], v[144:147], v[184:187]
  v_mfma_f32_16x16x32_bf16 v[192:195], v[240:243], v[148:151], v[192:195]
  v_mfma_f32_16x16x32_bf16 v[200:203], v[240:243], v[152:155], v[200:203]
  s_waitcnt lgkmcnt(2)
  v_mfma_f32_16x16x32_bf16 v[208:211], v[240:243], v[156:159], v[208:211]
  s_waitcnt lgkmcnt(0)
  v_mfma_f32_16x16x32_bf16 v[180:183], v[244:247], v[144:147], v[180:183]
  v_mfma_f32_16x16x32_bf16 v[188:191], v[244:247], v[148:151], v[188:191]
  v_mfma_f32_16x16x32_bf16 v[196:199], v[244:247], v[152:155], v[196:199]
  v_mfma_f32_16x16x32_bf16 v[204:207], v[244:247], v[156:159], v[204:207]
  ds_read_u16 v32, v7 offset:2048
  ds_read_u16 v33, v7 offset:2176
  ds_read_u16 v34, v7 offset:2304
  ds_read_u16 v35, v7 offset:2432
  ds_read_u16 v36, v7 offset:2560
  ds_read_u16 v37, v7 offset:2688
  ds_read_u16 v38, v7 offset:2816
  ds_read_u16 v39, v7 offset:2944
  s_nop 2
  v_add_f32 v113, v179, v182 wave_ror:1 row_mask:0x1 bank_mask:0x1
  v_add_f32 v114, v183, v186 wave_ror:1 row_mask:0x1 bank_mask:0x1
  v_add_f32 v115, v187, v190 wave_ror:1 row_mask:0x1 bank_mask:0x1
  v_add_f32 v116, v191, v194 wave_ror:1 row_mask:0x1 bank_mask:0x1
  v_add_f32 v117, v195, v198 wave_ror:1 row_mask:0x1 bank_mask:0x1
  v_add_f32 v118, v199, v202 wave_ror:1 row_mask:0x1 bank_mask:0x1
  v_add_f32 v119, v203, v206 wave_ror:1 row_mask:0x1 bank_mask:0x1
  v_add_f32 v120, v207, v210 wave_ror:1 row_mask:0x1 bank_mask:0x1
  v_add_f32 v112, v179, v178 wave_shr:1 row_mask:0xf bank_mask:0xf bound_ctrl:0
  v_add_f32 v113, v183, v182 wave_shr:1 row_mask:0xf bank_mask:0xf
  v_add_f32 v114, v187, v186 wave_shr:1 row_mask:0xf bank_mask:0xf
  v_add_f32 v115, v191, v190 wave_shr:1 row_mask:0xf bank_mask:0xf
  v_add_f32 v116, v195, v194 wave_shr:1 row_mask:0xf bank_mask:0xf
  v_add_f32 v117, v199, v198 wave_shr:1 row_mask:0xf bank_mask:0xf
  v_add_f32 v118, v203, v202 wave_shr:1 row_mask:0xf bank_mask:0xf
  v_add_f32 v119, v207, v206 wave_shr:1 row_mask:0xf bank_mask:0xf
  v_add_f32 v120, v211, v210 wave_shr:1 row_mask:0xf bank_mask:0xf
  s_waitcnt lgkmcnt(0)
  v_dot2c_f32_bf16 v180, s74, v32
  v_dot2c_f32_bf16 v184, s74, v33
  v_dot2c_f32_bf16 v188, s74, v34
  v_dot2c_f32_bf16 v192, s74, v35
  v_dot2c_f32_bf16 v196, s74, v36
  v_dot2c_f32_bf16 v200, s74, v37
  v_dot2c_f32_bf16 v204, s74, v38
  v_dot2c_f32_bf16 v208, s74, v39
  v_add_f32 v129, v112, v181 wave_ror:1 row_mask:0x1 bank_mask:0x1
  v_add_f32 v130, v113, v185 wave_ror:1 row_mask:0x1 bank_mask:0x1
  v_add_f32 v131, v114, v189 wave_ror:1 row_mask:0x1 bank_mask:0x1
  v_add_f32 v132, v115, v193 wave_ror:1 row_mask:0x1 bank_mask:0x1
  v_add_f32 v133, v116, v197 wave_ror:1 row_mask:0x1 bank_mask:0x1
  v_add_f32 v134, v117, v201 wave_ror:1 row_mask:0x1 bank_mask:0x1
  v_add_f32 v135, v118, v205 wave_ror:1 row_mask:0x1 bank_mask:0x1
  v_add_f32 v136, v119, v209 wave_ror:1 row_mask:0x1 bank_mask:0x1
  v_add_f32 v128, v112, v177 wave_shr:1 row_mask:0xf bank_mask:0xf bound_ctrl:0
  v_add_f32 v129, v113, v181 wave_shr:1 row_mask:0xf bank_mask:0xf
  v_add_f32 v130, v114, v185 wave_shr:1 row_mask:0xf bank_mask:0xf
  v_add_f32 v131, v115, v189 wave_shr:1 row_mask:0xf bank_mask:0xf
  v_add_f32 v132, v116, v193 wave_shr:1 row_mask:0xf bank_mask:0xf
  v_add_f32 v133, v117, v197 wave_shr:1 row_mask:0xf bank_mask:0xf
  v_add_f32 v134, v118, v201 wave_shr:1 row_mask:0xf bank_mask:0xf
  v_add_f32 v135, v119, v205 wave_shr:1 row_mask:0xf bank_mask:0xf
  v_add_f32 v136, v120, v209 wave_shr:1 row_mask:0xf bank_mask:0xf
  v_add_f32 v145, v128, v180 wave_ror:1 row_mask:0x1 bank_mask:0x1
  v_add_f32 v146, v129, v184 wave_ror:1 row_mask:0x1 bank_mask:0x1
  v_add_f32 v147, v130, v188 wave_ror:1 row_mask:0x1 bank_mask:0x1
  v_add_f32 v148, v131, v192 wave_ror:1 row_mask:0x1 bank_mask:0x1
  v_add_f32 v149, v132, v196 wave_ror:1 row_mask:0x1 bank_mask:0x1
  v_add_f32 v150, v133, v200 wave_ror:1 row_mask:0x1 bank_mask:0x1
  v_add_f32 v151, v134, v204 wave_ror:1 row_mask:0x1 bank_mask:0x1
  v_add_f32 v152, v135, v208 wave_ror:1 row_mask:0x1 bank_mask:0x1
  v_add_f32 v145, v129, v180 wave_shr:1 row_mask:0xf bank_mask:0xf
  v_add_f32 v146, v130, v184 wave_shr:1 row_mask:0xf bank_mask:0xf
  v_add_f32 v147, v131, v188 wave_shr:1 row_mask:0xf bank_mask:0xf
  v_add_f32 v148, v132, v192 wave_shr:1 row_mask:0xf bank_mask:0xf
  v_add_f32 v149, v133, v196 wave_shr:1 row_mask:0xf bank_mask:0xf
  v_add_f32 v150, v134, v200 wave_shr:1 row_mask:0xf bank_mask:0xf
  v_add_f32 v151, v135, v204 wave_shr:1 row_mask:0xf bank_mask:0xf
  v_add_f32 v152, v136, v208 wave_shr:1 row_mask:0xf bank_mask:0xf
  ds_write2st64_b32 v10, v145, v146 offset0:0 offset1:1
  ds_write2st64_b32 v10, v147, v148 offset0:2 offset1:3
  ds_write2st64_b32 v10, v149, v150 offset0:4 offset1:5
  ds_write2st64_b32 v10, v151, v152 offset0:6 offset1:7
parallel_sum__ssm_conv_h3__dense_activation_gelu__prompt_kernel_Z_cfin:
  s_waitcnt vmcnt(0)
  v_bitop3_b32 v75, v76, v80, v84 bitop3:0x80
  v_bitop3_b32 v75, v75, v88, 1 bitop3:0x80
  v_cmp_eq_u32 vcc, 0, v75
  s_or_b32 s75, vcc_lo, vcc_hi
  s_cbranch_scc0 parallel_sum__ssm_conv_h3__dense_activation_gelu__prompt_kernel_Z_kx
  buffer_load_dwordx4 v[76:79], v52, s[24:27], s11 offen sc1
  buffer_load_dwordx4 v[80:83], v52, s[24:27], s20 offen sc1
  buffer_load_dwordx4 v[84:87], v52, s[24:27], s21 offen sc1
  buffer_load_dwordx4 v[88:91], v52, s[24:27], s22 offen sc1
parallel_sum__ssm_conv_h3__dense_activation_gelu__prompt_kernel_Z_kx:
  s_cmp_eq_u32 s57, 0
  s_cbranch_scc1 parallel_sum__ssm_conv_h3__dense_activation_gelu__prompt_kernel_Z_ky
  v_bitop3_b32 v75, v16, v20, v24 bitop3:0x80
  v_bitop3_b32 v75, v75, v28, 1 bitop3:0x80
  v_cmp_eq_u32 vcc, 0, v75
  s_or_b32 s76, vcc_lo, vcc_hi
  s_cbranch_scc0 parallel_sum__ssm_conv_h3__dense_activation_gelu__prompt_kernel_Z_ky
  buffer_load_dwordx4 v[16:19], v54, s[24:27], s11 offen sc1
  buffer_load_dwordx4 v[20:23], v54, s[24:27], s20 offen sc1
  buffer_load_dwordx4 v[24:27], v54, s[24:27], s21 offen sc1
  buffer_load_dwordx4 v[28:31], v54, s[24:27], s22 offen sc1
parallel_sum__ssm_conv_h3__dense_activation_gelu__prompt_kernel_Z_ky:
  s_cmp_ge_u32 s31, 4
  s_cselect_b32 s39, 0x10000, 0
  s_or_b32 s28, s75, s39
  s_cbranch_scc1 parallel_sum__ssm_conv_h3__dense_activation_gelu__prompt_kernel_Z_q1
  v_lshlrev_b32 v100, 16, v64
  v_and_b32 v101, 0xffff0000, v64
  v_lshlrev_b32 v102, 16, v65
  v_and_b32 v103, 0xffff0000, v65
  v_lshlrev_b32 v104, 16, v66
  v_and_b32 v105, 0xffff0000, v66
  v_lshlrev_b32 v106, 16, v67
  v_and_b32 v107, 0xffff0000, v67
  v_add_f32 v92, s64, v100
  v_add_f32 v93, s65, v101
  v_add_f32 v94, s66, v102
  v_add_f32 v95, s67, v103
  v_add_f32 v96, s68, v104
  v_add_f32 v97, s69, v105
  v_add_f32 v98, s70, v106
  v_add_f32 v99, s71, v107
  v_fma_f32 v100, v100, v108, v109
  v_fma_f32 v101, v101, v108, v109
  v_fma_f32 v102, v102, v108, v109
  v_fma_f32 v103, v103, v108, v109
  v_fma_f32 v104, v104, v108, v109
  v_fma_f32 v105, v105, v108, v109
  v_fma_f32 v106, v106, v108, v109
  v_fma_f32 v107, v107, v108, v109
  v_dot2c_f32_bf16 v92, s72, v76
  v_dot2c_f32_bf16 v93, s73, v76
  v_dot2c_f32_bf16 v94, s72, v77
  v_dot2c_f32_bf16 v95, s73, v77
  v_dot2c_f32_bf16 v96, s72, v78
  v_dot2c_f32_bf16 v97, s73, v78
  v_dot2c_f32_bf16 v98, s72, v79
  v_dot2c_f32_bf16 v99, s73, v79
  v_dot2c_f32_bf16 v92, s72, v80
  v_dot2c_f32_bf16 v93, s73, v80
  v_dot2c_f32_bf16 v94, s72, v81
  v_dot2c_f32_bf16 v95, s73, v81
  v_dot2c_f32_bf16 v96, s72, v82
  v_dot2c_f32_bf16 v97, s73, v82
  v_dot2c_f32_bf16 v98, s72, v83
  v_dot2c_f32_bf16 v99, s73, v83
  v_dot2c_f32_bf16 v92, s72, v84
  v_dot2c_f32_bf16 v93, s73, v84
  v_dot2c_f32_bf16 v94, s72, v85
  v_dot2c_f32_bf16 v95, s73, v85
  v_dot2c_f32_bf16 v96, s72, v86
  v_dot2c_f32_bf16 v97, s73, v86
  v_dot2c_f32_bf16 v98, s72, v87
  v_dot2c_f32_bf16 v99, s73, v87
  v_dot2c_f32_bf16 v92, s72, v88
  v_dot2c_f32_bf16 v93, s73, v88
  v_dot2c_f32_bf16 v94, s72, v89
  v_dot2c_f32_bf16 v95, s73, v89
  v_dot2c_f32_bf16 v96, s72, v90
  v_dot2c_f32_bf16 v97, s73, v90
  v_dot2c_f32_bf16 v98, s72, v91
  v_dot2c_f32_bf16 v99, s73, v91
  s_nop 2
parallel_sum__ssm_conv_h3__dense_activation_gelu__prompt_kernel_Z_q1:
  s_cmp_eq_u32 s57, 0
  s_cselect_b32 s39, 1, s76
  s_cmp_lg_u32 s39, 0
  s_cbranch_scc1 parallel_sum__ssm_conv_h3__dense_activation_gelu__prompt_kernel_Z_q2
  v_lshlrev_b32 v40, 16, v68
  v_and_b32 v41, 0xffff0000, v68
  v_lshlrev_b32 v42, 16, v69
  v_and_b32 v43, 0xffff0000, v69
  v_lshlrev_b32 v44, 16, v70
  v_and_b32 v45, 0xffff0000, v70
  v_lshlrev_b32 v46, 16, v71
  v_and_b32 v47, 0xffff0000, v71
  v_add_f32 v32, s44, v40
  v_add_f32 v33, s45, v41
  v_add_f32 v34, s46, v42
  v_add_f32 v35, s47, v43
  v_add_f32 v36, s48, v44
  v_add_f32 v37, s49, v45
  v_add_f32 v38, s50, v46
  v_add_f32 v39, s51, v47
  v_fma_f32 v40, v40, v108, v109
  v_fma_f32 v41, v41, v108, v109
  v_fma_f32 v42, v42, v108, v109
  v_fma_f32 v43, v43, v108, v109
  v_fma_f32 v44, v44, v108, v109
  v_fma_f32 v45, v45, v108, v109
  v_fma_f32 v46, v46, v108, v109
  v_fma_f32 v47, v47, v108, v109
  v_dot2c_f32_bf16 v32, s72, v16
  v_dot2c_f32_bf16 v33, s73, v16
  v_dot2c_f32_bf16 v34, s72, v17
  v_dot2c_f32_bf16 v35, s73, v17
  v_dot2c_f32_bf16 v36, s72, v18
  v_dot2c_f32_bf16 v37, s73, v18
  v_dot2c_f32_bf16 v38, s72, v19
  v_dot2c_f32_bf16 v39, s73, v19
  v_dot2c_f32_bf16 v32, s72, v20
  v_dot2c_f32_bf16 v33, s73, v20
  v_dot2c_f32_bf16 v34, s72, v21
  v_dot2c_f32_bf16 v35, s73, v21
  v_dot2c_f32_bf16 v36, s72, v22
  v_dot2c_f32_bf16 v37, s73, v22
  v_dot2c_f32_bf16 v38, s72, v23
  v_dot2c_f32_bf16 v39, s73, v23
  v_dot2c_f32_bf16 v32, s72, v24
  v_dot2c_f32_bf16 v33, s73, v24
  v_dot2c_f32_bf16 v34, s72, v25
  v_dot2c_f32_bf16 v35, s73, v25
  v_dot2c_f32_bf16 v36, s72, v26
  v_dot2c_f32_bf16 v37, s73, v26
  v_dot2c_f32_bf16 v38, s72, v27
  v_dot2c_f32_bf16 v39, s73, v27
  v_dot2c_f32_bf16 v32, s72, v28
  v_dot2c_f32_bf16 v33, s73, v28
  v_dot2c_f32_bf16 v34, s72, v29
  v_dot2c_f32_bf16 v35, s73, v29
  v_dot2c_f32_bf16 v36, s72, v30
  v_dot2c_f32_bf16 v37, s73, v30
  v_dot2c_f32_bf16 v38, s72, v31
  v_dot2c_f32_bf16 v39, s73, v31
  s_nop 2
parallel_sum__ssm_conv_h3__dense_activation_gelu__prompt_kernel_Z_q2:
  s_waitcnt lgkmcnt(0)
  s_barrier
  s_lshl_b32 s40, s94, 8
  v_lshl_add_u32 v14, v1, 2, s40
  ds_read2st64_b32 v[192:193], v14 offset0:0 offset1:34
  ds_read2st64_b32 v[194:195], v14 offset0:68 offset1:102
  ds_read2st64_b32 v[196:197], v14 offset0:136 offset1:170
  ds_read2st64_b32 v[198:199], v14 offset0:204 offset1:238
  s_cmp_lg_u32 s57, 0
  s_cbranch_scc1 parallel_sum__ssm_conv_h3__dense_activation_gelu__prompt_kernel_Z_two
  s_cmp_eq_u32 s28, 0
  s_cbranch_scc1 parallel_sum__ssm_conv_h3__dense_activation_gelu__prompt_kernel_Z_a3
  s_cmp_eq_u32 s75, 0
  s_cbranch_scc1 parallel_sum__ssm_conv_h3__dense_activation_gelu__prompt_kernel_Z_a2
  s_mov_b32 s38, 32768
parallel_sum__ssm_conv_h3__dense_activation_gelu__prompt_kernel_Z_alp:
  s_waitcnt vmcnt(0)
  v_bitop3_b32 v75, v76, v80, v84 bitop3:0x80
  v_bitop3_b32 v75, v75, v88, 1 bitop3:0x80
  v_cmp_eq_u32 vcc, 0, v75
  s_sub_u32 s38, s38, 1
  s_cbranch_scc1 parallel_sum__ssm_conv_h3__dense_activation_gelu__prompt_kernel_Z_a2
  s_cbranch_vccz parallel_sum__ssm_conv_h3__dense_activation_gelu__prompt_kernel_Z_a2
  buffer_load_dwordx4 v[76:79], v52, s[24:27], s11 offen sc1
  buffer_load_dwordx4 v[80:83], v52, s[24:27], s20 offen sc1
  buffer_load_dwordx4 v[84:87], v52, s[24:27], s21 offen sc1
  buffer_load_dwordx4 v[88:91], v52, s[24:27], s22 offen sc1
  s_branch parallel_sum__ssm_conv_h3__dense_activation_gelu__prompt_kernel_Z_alp
parallel_sum__ssm_conv_h3__dense_activation_gelu__prompt_kernel_Z_a2:
  v_lshlrev_b32 v100, 16, v64
  v_and_b32 v101, 0xffff0000, v64
  v_lshlrev_b32 v102, 16, v65
  v_and_b32 v103, 0xffff0000, v65
  v_lshlrev_b32 v104, 16, v66
  v_and_b32 v105, 0xffff0000, v66
  v_lshlrev_b32 v106, 16, v67
  v_and_b32 v107, 0xffff0000, v67
  v_add_f32 v92, s64, v100
  v_add_f32 v93, s65, v101
  v_add_f32 v94, s66, v102
  v_add_f32 v95, s67, v103
  v_add_f32 v96, s68, v104
  v_add_f32 v97, s69, v105
  v_add_f32 v98, s70, v106
  v_add_f32 v99, s71, v107
  v_fma_f32 v100, v100, v108, v109
  v_fma_f32 v101, v101, v108, v109
  v_fma_f32 v102, v102, v108, v109
  v_fma_f32 v103, v103, v108, v109
  v_fma_f32 v104, v104, v108, v109
  v_fma_f32 v105, v105, v108, v109
  v_fma_f32 v106, v106, v108, v109
  v_fma_f32 v107, v107, v108, v109
  v_dot2c_f32_bf16 v92, s72, v76
  v_dot2c_f32_bf16 v93, s73, v76
  v_dot2c_f32_bf16 v94, s72, v77
  v_dot2c_f32_bf16 v95, s73, v77
  v_dot2c_f32_bf16 v96, s72, v78
  v_dot2c_f32_bf16 v97, s73, v78
  v_dot2c_f32_bf16 v98, s72, v79
  v_dot2c_f32_bf16 v99, s73, v79
  v_dot2c_f32_bf16 v92, s72, v80
  v_dot2c_f32_bf16 v93, s73, v80
  v_dot2c_f32_bf16 v94, s72, v81
  v_dot2c_f32_bf16 v95, s73, v81
  v_dot2c_f32_bf16 v96, s72, v82
  v_dot2c_f32_bf16 v97, s73, v82
  v_dot2c_f32_bf16 v98, s72, v83
  v_dot2c_f32_bf16 v99, s73, v83
  v_dot2c_f32_bf16 v92, s72, v84
  v_dot2c_f32_bf16 v93, s73, v84
  v_dot2c_f32_bf16 v94, s72, v85
  v_dot2c_f32_bf16 v95, s73, v85
  v_dot2c_f32_bf16 v96, s72, v86
  v_dot2c_f32_bf16 v97, s73, v86
  v_dot2c_f32_bf16 v98, s72, v87
  v_dot2c_f32_bf16 v99, s73, v87
  v_dot2c_f32_bf16 v92, s72, v88
  v_dot2c_f32_bf16 v93, s73, v88
  v_dot2c_f32_bf16 v94, s72, v89
  v_dot2c_f32_bf16 v95, s73, v89
  v_dot2c_f32_bf16 v96, s72, v90
  v_dot2c_f32_bf16 v97, s73, v90
  v_dot2c_f32_bf16 v98, s72, v91
  v_dot2c_f32_bf16 v99, s73, v91
  s_nop 2
parallel_sum__ssm_conv_h3__dense_activation_gelu__prompt_kernel_Z_a3:
  s_waitcnt lgkmcnt(0)
  v_pk_fma_f32 v[92:93], v[100:101], v[192:193], v[92:93]
  v_pk_fma_f32 v[94:95], v[102:103], v[194:195], v[94:95]
  v_pk_fma_f32 v[96:97], v[104:105], v[196:197], v[96:97]
  v_pk_fma_f32 v[98:99], v[106:107], v[198:199], v[98:99]
  v_cvt_pk_bf16_f32 v64, v92, v93
  v_cvt_pk_bf16_f32 v65, v94, v95
  v_cvt_pk_bf16_f32 v66, v96, v97
  v_cvt_pk_bf16_f32 v67, v98, v99
  buffer_store_dwordx4 v[64:67], v72, s[80:83], 0 offen
  s_endpgm
parallel_sum__ssm_conv_h3__dense_activation_gelu__prompt_kernel_Z_two:
  s_lshl_b32 s40, s95, 8
  v_lshl_add_u32 v14, v1, 2, s40
  ds_read2st64_b32 v[216:217], v14 offset0:0 offset1:34
  ds_read2st64_b32 v[218:219], v14 offset0:68 offset1:102
  ds_read2st64_b32 v[220:221], v14 offset0:136 offset1:170
  ds_read2st64_b32 v[222:223], v14 offset0:204 offset1:238
  s_cmp_lg_u32 s28, 0
  s_cbranch_scc1 parallel_sum__ssm_conv_h3__dense_activation_gelu__prompt_kernel_Z_xslow
parallel_sum__ssm_conv_h3__dense_activation_gelu__prompt_kernel_Z_xback:
  s_waitcnt lgkmcnt(0)
  v_pk_fma_f32 v[92:93], v[100:101], v[192:193], v[92:93]
  v_pk_fma_f32 v[94:95], v[102:103], v[194:195], v[94:95]
  v_pk_fma_f32 v[96:97], v[104:105], v[196:197], v[96:97]
  v_pk_fma_f32 v[98:99], v[106:107], v[198:199], v[98:99]
  v_cvt_pk_bf16_f32 v64, v92, v93
  v_cvt_pk_bf16_f32 v65, v94, v95
  v_cvt_pk_bf16_f32 v66, v96, v97
  v_cvt_pk_bf16_f32 v67, v98, v99
  s_cmp_eq_u32 s76, 0
  s_cbranch_scc1 parallel_sum__ssm_conv_h3__dense_activation_gelu__prompt_kernel_Z_b3
  s_mov_b32 s38, 32768
parallel_sum__ssm_conv_h3__dense_activation_gelu__prompt_kernel_Z_blp:
  s_waitcnt vmcnt(0)
  v_bitop3_b32 v75, v16, v20, v24 bitop3:0x80
  v_bitop3_b32 v75, v75, v28, 1 bitop3:0x80
  v_cmp_eq_u32 vcc, 0, v75
  s_sub_u32 s38, s38, 1
  s_cbranch_scc1 parallel_sum__ssm_conv_h3__dense_activation_gelu__prompt_kernel_Z_b2
  s_cbranch_vccz parallel_sum__ssm_conv_h3__dense_activation_gelu__prompt_kernel_Z_b2
  buffer_load_dwordx4 v[16:19], v54, s[24:27], s11 offen sc1
  buffer_load_dwordx4 v[20:23], v54, s[24:27], s20 offen sc1
  buffer_load_dwordx4 v[24:27], v54, s[24:27], s21 offen sc1
  buffer_load_dwordx4 v[28:31], v54, s[24:27], s22 offen sc1
  s_branch parallel_sum__ssm_conv_h3__dense_activation_gelu__prompt_kernel_Z_blp
parallel_sum__ssm_conv_h3__dense_activation_gelu__prompt_kernel_Z_b2:
  v_lshlrev_b32 v40, 16, v68
  v_and_b32 v41, 0xffff0000, v68
  v_lshlrev_b32 v42, 16, v69
  v_and_b32 v43, 0xffff0000, v69
  v_lshlrev_b32 v44, 16, v70
  v_and_b32 v45, 0xffff0000, v70
  v_lshlrev_b32 v46, 16, v71
  v_and_b32 v47, 0xffff0000, v71
  v_add_f32 v32, s44, v40
  v_add_f32 v33, s45, v41
  v_add_f32 v34, s46, v42
  v_add_f32 v35, s47, v43
  v_add_f32 v36, s48, v44
  v_add_f32 v37, s49, v45
  v_add_f32 v38, s50, v46
  v_add_f32 v39, s51, v47
  v_fma_f32 v40, v40, v108, v109
  v_fma_f32 v41, v41, v108, v109
  v_fma_f32 v42, v42, v108, v109
  v_fma_f32 v43, v43, v108, v109
  v_fma_f32 v44, v44, v108, v109
  v_fma_f32 v45, v45, v108, v109
  v_fma_f32 v46, v46, v108, v109
  v_fma_f32 v47, v47, v108, v109
  v_dot2c_f32_bf16 v32, s72, v16
  v_dot2c_f32_bf16 v33, s73, v16
  v_dot2c_f32_bf16 v34, s72, v17
  v_dot2c_f32_bf16 v35, s73, v17
  v_dot2c_f32_bf16 v36, s72, v18
  v_dot2c_f32_bf16 v37, s73, v18
  v_dot2c_f32_bf16 v38, s72, v19
  v_dot2c_f32_bf16 v39, s73, v19
  v_dot2c_f32_bf16 v32, s72, v20
  v_dot2c_f32_bf16 v33, s73, v20
  v_dot2c_f32_bf16 v34, s72, v21
  v_dot2c_f32_bf16 v35, s73, v21
  v_dot2c_f32_bf16 v36, s72, v22
  v_dot2c_f32_bf16 v37, s73, v22
  v_dot2c_f32_bf16 v38, s72, v23
  v_dot2c_f32_bf16 v39, s73, v23
  v_dot2c_f32_bf16 v32, s72, v24
  v_dot2c_f32_bf16 v33, s73, v24
  v_dot2c_f32_bf16 v34, s72, v25
  v_dot2c_f32_bf16 v35, s73, v25
  v_dot2c_f32_bf16 v36, s72, v26
  v_dot2c_f32_bf16 v37, s73, v26
  v_dot2c_f32_bf16 v38, s72, v27
  v_dot2c_f32_bf16 v39, s73, v27
  v_dot2c_f32_bf16 v32, s72, v28
  v_dot2c_f32_bf16 v33, s73, v28
  v_dot2c_f32_bf16 v34, s72, v29
  v_dot2c_f32_bf16 v35, s73, v29
  v_dot2c_f32_bf16 v36, s72, v30
  v_dot2c_f32_bf16 v37, s73, v30
  v_dot2c_f32_bf16 v38, s72, v31
  v_dot2c_f32_bf16 v39, s73, v31
  s_nop 2
parallel_sum__ssm_conv_h3__dense_activation_gelu__prompt_kernel_Z_b3:
  buffer_store_dwordx4 v[64:67], v72, s[80:83], 0 offen
  v_pk_fma_f32 v[32:33], v[40:41], v[216:217], v[32:33]
  v_pk_fma_f32 v[34:35], v[42:43], v[218:219], v[34:35]
  v_pk_fma_f32 v[36:37], v[44:45], v[220:221], v[36:37]
  v_pk_fma_f32 v[38:39], v[46:47], v[222:223], v[38:39]
  v_cvt_pk_bf16_f32 v68, v32, v33
  v_cvt_pk_bf16_f32 v69, v34, v35
  v_cvt_pk_bf16_f32 v70, v36, v37
  v_cvt_pk_bf16_f32 v71, v38, v39
  buffer_store_dwordx4 v[68:71], v73, s[80:83], 0 offen
  s_endpgm
parallel_sum__ssm_conv_h3__dense_activation_gelu__prompt_kernel_Z_xslow:
  s_cmp_eq_u32 s75, 0
  s_cbranch_scc1 parallel_sum__ssm_conv_h3__dense_activation_gelu__prompt_kernel_Z_x2
  s_mov_b32 s38, 32768
parallel_sum__ssm_conv_h3__dense_activation_gelu__prompt_kernel_Z_xlp:
  s_waitcnt vmcnt(0)
  v_bitop3_b32 v75, v76, v80, v84 bitop3:0x80
  v_bitop3_b32 v75, v75, v88, 1 bitop3:0x80
  v_cmp_eq_u32 vcc, 0, v75
  s_sub_u32 s38, s38, 1
  s_cbranch_scc1 parallel_sum__ssm_conv_h3__dense_activation_gelu__prompt_kernel_Z_x2
  s_cbranch_vccz parallel_sum__ssm_conv_h3__dense_activation_gelu__prompt_kernel_Z_x2
  buffer_load_dwordx4 v[76:79], v52, s[24:27], s11 offen sc1
  buffer_load_dwordx4 v[80:83], v52, s[24:27], s20 offen sc1
  buffer_load_dwordx4 v[84:87], v52, s[24:27], s21 offen sc1
  buffer_load_dwordx4 v[88:91], v52, s[24:27], s22 offen sc1
  s_branch parallel_sum__ssm_conv_h3__dense_activation_gelu__prompt_kernel_Z_xlp
parallel_sum__ssm_conv_h3__dense_activation_gelu__prompt_kernel_Z_x2:
  v_lshlrev_b32 v100, 16, v64
  v_and_b32 v101, 0xffff0000, v64
  v_lshlrev_b32 v102, 16, v65
  v_and_b32 v103, 0xffff0000, v65
  v_lshlrev_b32 v104, 16, v66
  v_and_b32 v105, 0xffff0000, v66
  v_lshlrev_b32 v106, 16, v67
  v_and_b32 v107, 0xffff0000, v67
  v_add_f32 v92, s64, v100
  v_add_f32 v93, s65, v101
  v_add_f32 v94, s66, v102
  v_add_f32 v95, s67, v103
  v_add_f32 v96, s68, v104
  v_add_f32 v97, s69, v105
  v_add_f32 v98, s70, v106
  v_add_f32 v99, s71, v107
  v_fma_f32 v100, v100, v108, v109
  v_fma_f32 v101, v101, v108, v109
  v_fma_f32 v102, v102, v108, v109
  v_fma_f32 v103, v103, v108, v109
  v_fma_f32 v104, v104, v108, v109
  v_fma_f32 v105, v105, v108, v109
  v_fma_f32 v106, v106, v108, v109
  v_fma_f32 v107, v107, v108, v109
  v_dot2c_f32_bf16 v92, s72, v76
  v_dot2c_f32_bf16 v93, s73, v76
  v_dot2c_f32_bf16 v94, s72, v77
  v_dot2c_f32_bf16 v95, s73, v77
  v_dot2c_f32_bf16 v96, s72, v78
  v_dot2c_f32_bf16 v97, s73, v78
  v_dot2c_f32_bf16 v98, s72, v79
  v_dot2c_f32_bf16 v99, s73, v79
  v_dot2c_f32_bf16 v92, s72, v80
  v_dot2c_f32_bf16 v93, s73, v80
  v_dot2c_f32_bf16 v94, s72, v81
  v_dot2c_f32_bf16 v95, s73, v81
  v_dot2c_f32_bf16 v96, s72, v82
  v_dot2c_f32_bf16 v97, s73, v82
  v_dot2c_f32_bf16 v98, s72, v83
  v_dot2c_f32_bf16 v99, s73, v83
  v_dot2c_f32_bf16 v92, s72, v84
  v_dot2c_f32_bf16 v93, s73, v84
  v_dot2c_f32_bf16 v94, s72, v85
  v_dot2c_f32_bf16 v95, s73, v85
  v_dot2c_f32_bf16 v96, s72, v86
  v_dot2c_f32_bf16 v97, s73, v86
  v_dot2c_f32_bf16 v98, s72, v87
  v_dot2c_f32_bf16 v99, s73, v87
  v_dot2c_f32_bf16 v92, s72, v88
  v_dot2c_f32_bf16 v93, s73, v88
  v_dot2c_f32_bf16 v94, s72, v89
  v_dot2c_f32_bf16 v95, s73, v89
  v_dot2c_f32_bf16 v96, s72, v90
  v_dot2c_f32_bf16 v97, s73, v90
  v_dot2c_f32_bf16 v98, s72, v91
  v_dot2c_f32_bf16 v99, s73, v91
  s_nop 2
  s_branch parallel_sum__ssm_conv_h3__dense_activation_gelu__prompt_kernel_Z_xback
parallel_sum__ssm_conv_h3__dense_activation_gelu__prompt_kernel_Z_none:
  s_endpgm
parallel_sum__ssm_conv_h3__dense_activation_gelu__prompt_kernel_Z_rdy_slow:
  s_mov_b32 s38, 32768
parallel_sum__ssm_conv_h3__dense_activation_gelu__prompt_kernel_Z_rdy_lp:
  buffer_load_dword v60, v61, s[24:27], 0 offen sc1
  s_sub_u32 s38, s38, 1
  s_waitcnt vmcnt(0)
  s_cbranch_scc1 parallel_sum__ssm_conv_h3__dense_activation_gelu__prompt_kernel_Z_rdy_back
  v_cmp_ne_u32 vcc, s63, v60
  s_cbranch_vccnz parallel_sum__ssm_conv_h3__dense_activation_gelu__prompt_kernel_Z_rdy_lp
  s_branch parallel_sum__ssm_conv_h3__dense_activation_gelu__prompt_kernel_Z_rdy_back
parallel_sum__ssm_conv_h3__dense_activation_gelu__prompt_kernel_Z_tok_slow:
  s_mov_b32 s38, 32768
parallel_sum__ssm_conv_h3__dense_activation_gelu__prompt_kernel_Z_tok_lp:
  buffer_load_dword v8, off, s[88:91], 0 sc1
  s_sub_u32 s38, s38, 1
  s_waitcnt vmcnt(0)
  s_cbranch_scc1 parallel_sum__ssm_conv_h3__dense_activation_gelu__prompt_kernel_Z_tok_back
  v_readfirstlane_b32 s3, v8
  s_cmp_eq_u32 s3, 0
  s_cbranch_scc1 parallel_sum__ssm_conv_h3__dense_activation_gelu__prompt_kernel_Z_tok_lp
  s_branch parallel_sum__ssm_conv_h3__dense_activation_gelu__prompt_kernel_Z_tok_back
parallel_sum__ssm_conv_h3__dense_activation_gelu__prompt_kernel_Z_xt0:
  s_and_b32 s3, s2, 8
  s_lshl_b32 s3, s3, 2
  v_lshrrev_b32 v15, 3, v0
  v_xor_b32 v15, s3, v15
  v_lshl_or_b32 v15, v0, 11, v15
  v_and_b32 v15, 0x3fff, v15
  v_lshlrev_b32 v15, 4, v15
  s_lshl_b32 s3, s29, 10
  s_add_u32 s3, s3, 29360128
  buffer_store_dwordx4 v[76:79], v15, s[24:27], s3 offen sc1
  s_add_u32 s3, s3, 262144
  buffer_store_dwordx4 v[80:83], v15, s[24:27], s3 offen sc1
  s_add_u32 s3, s3, 262144
  buffer_store_dwordx4 v[84:87], v15, s[24:27], s3 offen sc1
  s_branch parallel_sum__ssm_conv_h3__dense_activation_gelu__prompt_kernel_Z_xt0b
parallel_sum__ssm_conv_h3__dense_activation_gelu__prompt_kernel_Z_xt1:
  s_and_b32 s3, s2, 8
  s_lshl_b32 s3, s3, 2
  v_lshrrev_b32 v15, 3, v0
  v_xor_b32 v15, s3, v15
  v_lshl_or_b32 v15, v0, 11, v15
  v_and_b32 v15, 0x3fff, v15
  v_lshlrev_b32 v15, 4, v15
  s_lshl_b32 s3, s29, 10
  s_add_u32 s3, s3, 30146560
  buffer_store_dwordx4 v[88:91], v15, s[24:27], s3 offen sc1
  s_add_u32 s3, s3, 262144
  buffer_store_dwordx4 v[92:95], v15, s[24:27], s3 offen sc1
  s_add_u32 s3, s3, 262144
  buffer_store_dwordx4 v[96:99], v15, s[24:27], s3 offen sc1
  s_branch parallel_sum__ssm_conv_h3__dense_activation_gelu__prompt_kernel_Z_xt1b
parallel_sum__ssm_conv_h3__dense_activation_gelu__prompt_kernel_Z_xt2:
  s_and_b32 s3, s2, 8
  s_lshl_b32 s3, s3, 2
  v_lshrrev_b32 v15, 3, v0
  v_xor_b32 v15, s3, v15
  v_lshl_or_b32 v15, v0, 11, v15
  v_and_b32 v15, 0x3fff, v15
  v_lshlrev_b32 v15, 4, v15
  s_lshl_b32 s3, s29, 10
  s_add_u32 s3, s3, 30932992
  buffer_store_dwordx4 v[100:103], v15, s[24:27], s3 offen sc1
  s_add_u32 s3, s3, 262144
  buffer_store_dwordx4 v[104:107], v15, s[24:27], s3 offen sc1
  s_add_u32 s3, s3, 262144
  buffer_store_dwordx4 v[108:111], v15, s[24:27], s3 offen sc1
  s_branch parallel_sum__ssm_conv_h3__dense_activation_gelu__prompt_kernel_Z_xt2b
parallel_sum__ssm_conv_h3__dense_activation_gelu__prompt_kernel_Z_u2:
  s_add_u32 m0, s30, 8192
  v_add_u32 v15, s35, v68
  buffer_load_dwordx4 v15, s[64:67], 0 offen lds
  s_add_u32 m0, s30, 24576
  s_nop 0
  buffer_load_dwordx4 v15, s[68:71], 0 offen lds
  s_branch parallel_sum__ssm_conv_h3__dense_activation_gelu__prompt_kernel_Z_u2b
parallel_sum__ssm_conv_h3__dense_activation_gelu__prompt_kernel_Z_pf4:
  s_bitcmp1_b32 s28, 0
  s_cbranch_scc1 parallel_sum__ssm_conv_h3__dense_activation_gelu__prompt_kernel_Z_pf4b
  s_lshl1_add_u32 s38, s48, s56
  s_mov_b32 s40, 32768
parallel_sum__ssm_conv_h3__dense_activation_gelu__prompt_kernel_Z_pf4l:
  buffer_load_dword v68, off, s[24:27], s38 sc1
  s_sub_u32 s40, s40, 1
  s_waitcnt vmcnt(0)
  s_cbranch_scc1 parallel_sum__ssm_conv_h3__dense_activation_gelu__prompt_kernel_Z_pf4b
  v_cmp_ne_u32 vcc, s3, v68
  s_cbranch_vccnz parallel_sum__ssm_conv_h3__dense_activation_gelu__prompt_kernel_Z_pf4l
  s_branch parallel_sum__ssm_conv_h3__dense_activation_gelu__prompt_kernel_Z_pf4b
parallel_sum__ssm_conv_h3__dense_activation_gelu__prompt_kernel_Z_pf5:
  s_lshl1_add_u32 s38, s49, s56
  s_mov_b32 s40, 32768
parallel_sum__ssm_conv_h3__dense_activation_gelu__prompt_kernel_Z_pf5l:
  buffer_load_dword v68, off, s[24:27], s38 sc1
  s_sub_u32 s40, s40, 1
  s_waitcnt vmcnt(0)
  s_cbranch_scc1 parallel_sum__ssm_conv_h3__dense_activation_gelu__prompt_kernel_Z_pf5b
  v_cmp_ne_u32 vcc, s3, v68
  s_cbranch_vccnz parallel_sum__ssm_conv_h3__dense_activation_gelu__prompt_kernel_Z_pf5l
  s_branch parallel_sum__ssm_conv_h3__dense_activation_gelu__prompt_kernel_Z_pf5b
parallel_sum__ssm_conv_h3__dense_activation_gelu__prompt_kernel_Z_pf6:
  s_lshl1_add_u32 s38, s50, s56
  s_mov_b32 s40, 32768
parallel_sum__ssm_conv_h3__dense_activation_gelu__prompt_kernel_Z_pf6l:
  buffer_load_dword v68, off, s[24:27], s38 sc1
  s_sub_u32 s40, s40, 1
  s_waitcnt vmcnt(0)
  s_cbranch_scc1 parallel_sum__ssm_conv_h3__dense_activation_gelu__prompt_kernel_Z_pf6b
  v_cmp_ne_u32 vcc, s3, v68
  s_cbranch_vccnz parallel_sum__ssm_conv_h3__dense_activation_gelu__prompt_kernel_Z_pf6l
  s_branch parallel_sum__ssm_conv_h3__dense_activation_gelu__prompt_kernel_Z_pf6b
parallel_sum__ssm_conv_h3__dense_activation_gelu__prompt_kernel_Z_pf7:
  s_lshl1_add_u32 s38, s51, s56
  s_mov_b32 s40, 32768
parallel_sum__ssm_conv_h3__dense_activation_gelu__prompt_kernel_Z_pf7l:
  buffer_load_dword v68, off, s[24:27], s38 sc1
  s_sub_u32 s40, s40, 1
  s_waitcnt vmcnt(0)
  s_cbranch_scc1 parallel_sum__ssm_conv_h3__dense_activation_gelu__prompt_kernel_Z_pf7b
  v_cmp_ne_u32 vcc, s3, v68
  s_cbranch_vccnz parallel_sum__ssm_conv_h3__dense_activation_gelu__prompt_kernel_Z_pf7l
  s_branch parallel_sum__ssm_conv_h3__dense_activation_gelu__prompt_kernel_Z_pf7b
parallel_sum__ssm_conv_h3__dense_activation_gelu__prompt_kernel_Z_pf8:
  s_lshl1_add_u32 s38, s52, s56
  s_mov_b32 s40, 32768
parallel_sum__ssm_conv_h3__dense_activation_gelu__prompt_kernel_Z_pf8l:
  buffer_load_dword v68, off, s[24:27], s38 sc1
  s_sub_u32 s40, s40, 1
  s_waitcnt vmcnt(0)
  s_cbranch_scc1 parallel_sum__ssm_conv_h3__dense_activation_gelu__prompt_kernel_Z_pf8b
  v_cmp_ne_u32 vcc, s3, v68
  s_cbranch_vccnz parallel_sum__ssm_conv_h3__dense_activation_gelu__prompt_kernel_Z_pf8l
  s_branch parallel_sum__ssm_conv_h3__dense_activation_gelu__prompt_kernel_Z_pf8b
parallel_sum__ssm_conv_h3__dense_activation_gelu__prompt_kernel_Z_fs:
  s_mov_b32 s38, 32768
parallel_sum__ssm_conv_h3__dense_activation_gelu__prompt_kernel_Z_fl:
  buffer_load_dword v75, v74, s[24:27], s10 offen sc1
  s_sub_u32 s38, s38, 1
  s_waitcnt vmcnt(0)
  s_cbranch_scc1 parallel_sum__ssm_conv_h3__dense_activation_gelu__prompt_kernel_Z_fb
  v_cmp_ne_u32 vcc, s3, v75
  s_cbranch_vccnz parallel_sum__ssm_conv_h3__dense_activation_gelu__prompt_kernel_Z_fl
  s_branch parallel_sum__ssm_conv_h3__dense_activation_gelu__prompt_kernel_Z_fb
parallel_sum__ssm_conv_h3__dense_activation_gelu__prompt_kernel_mk:
  s_mov_b32 s39, 28311552
  s_load_dword s3, s[24:25], s39
  v_min_u32 v14, 1, v1
  v_lshlrev_b32 v14, 31, v14
  s_waitcnt lgkmcnt(0)
  s_add_u32 s3, s3, 1
  s_addc_u32 s3, s3, 0
  v_mov_b32 v12, s3
  buffer_store_dword v12, v14, s[88:91], 0 offen sc1
  buffer_store_dword v12, v14, s[24:27], s39 offen sc1
  s_branch parallel_sum__ssm_conv_h3__dense_activation_gelu__prompt_kernel_mkb
parallel_sum__ssm_conv_h3__dense_activation_gelu__prompt_kernel_exit:
  s_endpgm
.section .rodata,"a"
.p2align 6
.amdhsa_kernel parallel_sum__ssm_conv_h3__dense_activation_gelu__prompt_kernel
  .amdhsa_next_free_vgpr 256
  .amdhsa_next_free_sgpr 100
  .amdhsa_accum_offset 256
  .amdhsa_group_segment_fixed_size 0
  .amdhsa_kernarg_size 112
  .amdhsa_user_sgpr_count 2
  .amdhsa_user_sgpr_kernarg_segment_ptr 1
  .amdhsa_system_sgpr_workgroup_id_x 1
.end_amdhsa_kernel
```
